```python
import torch

def _softmax(x, axis=-1):
    return torch.softmax(x, dim=axis)
def _gelu(x):
    return torch.nn.functional.gelu(x, approximate="tanh")
def _silu(x):
    return torch.nn.functional.silu(x)
def _sigmoid(x):
    return torch.sigmoid(x)
def _layernorm(x, axis=-1, eps=1e-5):
    m = x.mean(dim=axis, keepdim=True)
    v = x.var(dim=axis, keepdim=True, unbiased=False)
    return (x - m) / torch.sqrt(v + eps)
def _scatter_add(tgt, idx, src, axis=0):
    return tgt.clone().index_add_(axis, idx, src)
def _segment_sum(src, seg, n):
    out = torch.zeros((n,) + src.shape[1:], dtype=src.dtype)
    return out.index_add_(0, seg, src)
def _pad(x, pw):
    flat = tuple(v for pair in reversed(pw) for v in pair)
    return torch.nn.functional.pad(x, flat)

kernel_name = 'gated_mix__mha_block_cached__swiglu_ffn__decode'

def setup_inputs():

    _w = (lambda a: (lambda t: t.to(torch.bfloat16) if t.is_floating_point() else t)(torch.as_tensor(a)))
    def _A_setup():
        B, Sq, D = 4, 1, 512
        H, Sk, Dh = 32, 8192, 128
        return {
            "x": _w((lambda *s: torch.randn(*s, dtype=torch.bfloat16) * 0.05)(B, Sq, D)),
            "k_cache": _w((lambda *s: torch.randn(*s, dtype=torch.bfloat16) * 6.4)(B, H, Sk, Dh)),
            "v_cache": _w((lambda *s: torch.randn(*s, dtype=torch.bfloat16) * 1.6)(B, H, Sk, Dh)),
            "wq": _w((lambda *s: torch.randn(*s, dtype=torch.bfloat16) * 6.4)(D, H * Dh) * (D ** -0.5)),
            "wo": _w((lambda *s: torch.randn(*s, dtype=torch.bfloat16) * 1.6)(H * Dh, D) * ((H * Dh) ** -0.5)),
        }
    _A_in = _A_setup()

    def _B_setup():
        B, S, D, F = 4, 1, 512, 1376
        return {
            "x": _w((lambda *s: torch.randn(*s, dtype=torch.bfloat16) * 0.05)(B, S, D)),
            "w_gate": _w((lambda *s: torch.randn(*s, dtype=torch.bfloat16) * 0.2)(D, F)),
            "w_up": _w((lambda *s: torch.randn(*s, dtype=torch.bfloat16) * 0.2)(D, F)),
            "w_down": _w((lambda *s: torch.randn(*s, dtype=torch.bfloat16) * 0.2)(F, D)),
        }
    _B_in = _B_setup()

    return {
        "A_x": _A_in["x"],
        "A_k_cache": _A_in["k_cache"],
        "A_v_cache": _A_in["v_cache"],
        "A_wq": _A_in["wq"],
        "A_wo": _A_in["wo"],
        "B_x": _B_in["x"],
        "B_w_gate": _B_in["w_gate"],
        "B_w_up": _B_in["w_up"],
        "B_w_down": _B_in["w_down"],
        "gate_w": _w((lambda *s: torch.randn(*s, dtype=torch.bfloat16) * 0.05)(512) * 16.0),
    }

def reference(A_x, A_k_cache, A_v_cache, A_wq, A_wo, B_x, B_w_gate, B_w_up, B_w_down, gate_w):
    def _A_ref(x, k_cache, v_cache, wq, wo):
        B, Sq, D = x.shape
        H, Dh = 32, 128
        q = (lambda x, *d: x.permute(*d))((x @ wq).reshape(B, Sq, H, Dh), 0, 2, 1, 3)
        scores = torch.einsum("bhqd,bhkd->bhqk", q, k_cache) * (Dh ** -0.5)
        p = _softmax(scores, axis=-1)
        o = torch.einsum("bhqk,bhkd->bhqd", p, v_cache)
        return (lambda x, *d: x.permute(*d))(o, 0, 2, 1, 3).reshape(B, Sq, H * Dh) @ wo

    def _B_ref(x, w_gate, w_up, w_down):
        g = _silu(x @ w_gate)
        u = x @ w_up
        return (g * u) @ w_down

    x = A_x
    g = _sigmoid((x * gate_w).sum(-1, keepdims=True))
    a = _A_ref(x, A_k_cache, A_v_cache, A_wq, A_wo)
    b = _B_ref(x, B_w_gate, B_w_up, B_w_down)
    return g * a + (1 - g) * b
```

```asm
; @launch grid=(256,1,1) block=(576,1,1) lds=57856
.amdgcn_target "amdgcn-amd-amdhsa--gfx950"
.text
.globl gated_mix__mha_block_cached__swiglu_ffn__decode_kernel
.p2align 8
.type gated_mix__mha_block_cached__swiglu_ffn__decode_kernel,@function
gated_mix__mha_block_cached__swiglu_ffn__decode_kernel:
    s_cmp_ge_u32 s2, 256
    s_cbranch_scc1 L_end
    s_load_dwordx16 s[16:31], s[0:1], 0
    s_load_dwordx2 s[12:13], s[0:1], 96
    s_load_dwordx8 s[84:91], s[0:1], 64
    v_lshrrev_b32 v1, 6, v0
    v_and_b32 v0, 63, v0
    v_readfirstlane_b32 s3, v1
    s_and_b32 s4, s2, 31
    s_lshr_b32 s5, s2, 6
    s_bfe_u32 s6, s2, 0x10005
    s_lshl_b32 s7, s5, 5
    s_add_u32 s7, s7, s4
    s_lshl_b32 s8, s7, 21
    s_lshl_b32 s9, s6, 15
    s_add_u32 s8, s8, s9
    s_sub_u32 s34, 0x200000, s9
    s_mov_b32 s38, s34
    s_mov_b32 s60, 0xffff0000
    s_mov_b32 s61, 0x3db504f3
    s_mov_b32 s62, 0x3fb8aa3b
    s_mov_b32 s35, 0x20000
    s_mov_b32 s39, 0x20000
    s_mov_b32 s43, 0x20000
    s_mov_b32 s47, 0x20000
    s_mov_b32 s51, 0x20000
    s_mov_b32 s55, 0x20000
    s_mov_b32 s95, 0x20000
    s_mov_b32 s50, 4096
    s_mov_b32 s54, 0x400000
    s_mov_b32 s94, 16384
    s_cmp_eq_u32 s3, 8
    s_cbranch_scc1 L_side
    s_setprio 3
    v_lshlrev_b32 v2, 4, v0
    s_lshl_b32 s9, s3, 12
    v_add_u32 v2, s9, v2
    v_lshrrev_b32 v5, 4, v0
    v_and_b32 v6, 15, v0
    s_bfe_u32 s14, s2, 65541
    s_lshl_b32 s14, s14, 2
    s_xor_b32 s14, s14, s3
    s_bfe_u32 s15, s2, 0x10006
    s_lshl_b32 s58, s15, 4
    s_xor_b32 s59, s58, 16
    s_lshl_b32 s15, s15, 16
    s_lshl_b32 s9, s5, 10
    s_lshl_b32 s10, s14, 7
    s_add_u32 s9, s9, s10
    v_lshlrev_b32 v7, 5, v5
    v_add_u32 v7, s9, v7
    s_lshl_b32 s9, s14, 19
    v_lshlrev_b32 v3, 17, v5
    v_lshl_add_u32 v3, v6, 4, v3
    v_add_u32 v3, s9, v3
    s_mul_i32 s63, s3, 0
    s_add_u32 s63, s63, 57856
    s_lshl_b32 s10, s4, 8
    s_lshl_b32 s11, s4, 17
    s_waitcnt lgkmcnt(0)
    s_add_u32 s36, s20, s8
    s_addc_u32 s37, s21, 0
    s_mov_b32 s48, s16
    s_mov_b32 s49, s17
    s_add_u32 s40, s22, s10
    s_addc_u32 s41, s23, 0
    s_sub_u32 s42, 0x400000, s10
    s_add_u32 s32, s18, s8
    s_addc_u32 s33, s19, 0
    buffer_load_dwordx4 v[44:47], v7, s[48:51], s58 offen
    buffer_load_dwordx4 v[48:51], v7, s[48:51], s59 offen
    s_mov_b32 s56, 0
    buffer_load_dwordx4 v[52:55], v2, s[36:39], s56 offen offset:0 nt
    s_xor_b32 s57, s15, 0
    buffer_load_dwordx4 v[100:103], v3, s[40:43], s57 offen
    buffer_load_dwordx4 v[56:59], v2, s[36:39], s56 offen offset:1024 nt
    s_xor_b32 s57, s15, 8192
    buffer_load_dwordx4 v[104:107], v3, s[40:43], s57 offen
    buffer_load_dwordx4 v[60:63], v2, s[36:39], s56 offen offset:2048 nt
    s_xor_b32 s57, s15, 16384
    buffer_load_dwordx4 v[108:111], v3, s[40:43], s57 offen
    s_xor_b32 s57, s15, 24576
    buffer_load_dwordx4 v[112:115], v3, s[40:43], s57 offen
    buffer_load_dwordx4 v[64:67], v2, s[36:39], s56 offen offset:3072 nt
    s_xor_b32 s57, s15, 32768
    buffer_load_dwordx4 v[116:119], v3, s[40:43], s57 offen
    s_mov_b32 s56, 65536
    buffer_load_dwordx4 v[68:71], v2, s[36:39], s56 offen offset:0 nt
    s_xor_b32 s57, s15, 40960
    buffer_load_dwordx4 v[120:123], v3, s[40:43], s57 offen
    buffer_load_dwordx4 v[72:75], v2, s[36:39], s56 offen offset:1024 nt
    s_xor_b32 s57, s15, 49152
    buffer_load_dwordx4 v[124:127], v3, s[40:43], s57 offen
    s_xor_b32 s57, s15, 57344
    buffer_load_dwordx4 v[128:131], v3, s[40:43], s57 offen
    buffer_load_dwordx4 v[76:79], v2, s[36:39], s56 offen offset:2048 nt
    s_xor_b32 s57, s15, 65536
    buffer_load_dwordx4 v[132:135], v3, s[40:43], s57 offen
    buffer_load_dwordx4 v[80:83], v2, s[36:39], s56 offen offset:3072 nt
    s_xor_b32 s57, s15, 73728
    buffer_load_dwordx4 v[136:139], v3, s[40:43], s57 offen
    s_mov_b32 s56, 131072
    buffer_load_dwordx4 v[84:87], v2, s[36:39], s56 offen offset:0 nt
    s_xor_b32 s57, s15, 81920
    buffer_load_dwordx4 v[140:143], v3, s[40:43], s57 offen
    s_xor_b32 s57, s15, 90112
    buffer_load_dwordx4 v[144:147], v3, s[40:43], s57 offen
    buffer_load_dwordx4 v[88:91], v2, s[36:39], s56 offen offset:1024 nt
    s_xor_b32 s57, s15, 98304
    buffer_load_dwordx4 v[148:151], v3, s[40:43], s57 offen
    buffer_load_dwordx4 v[92:95], v2, s[36:39], s56 offen offset:2048 nt
    s_xor_b32 s57, s15, 106496
    buffer_load_dwordx4 v[152:155], v3, s[40:43], s57 offen
    buffer_load_dwordx4 v[96:99], v2, s[36:39], s56 offen offset:3072 nt
    s_xor_b32 s57, s15, 114688
    buffer_load_dwordx4 v[156:159], v3, s[40:43], s57 offen
    s_xor_b32 s57, s15, 122880
    buffer_load_dwordx4 v[160:163], v3, s[40:43], s57 offen
    s_setprio 0
    s_add_u32 s44, s24, s11
    s_addc_u32 s45, s25, 0
    s_mov_b32 s46, 0x20000
    s_mov_b32 s52, s12
    s_mov_b32 s53, s13
    s_lshl_b32 s9, s5, 3
    s_add_u32 s9, s9, s3
    s_lshl_b32 s9, s9, 15
    s_lshl_b32 s10, s4, 1
    s_add_u32 s10, s10, s6
    s_lshl_b32 s68, s10, 8
    s_add_u32 s68, s68, s9
    s_lshl_b32 s69, s5, 6
    s_add_u32 s69, s69, s10
    s_lshl_b32 s69, s69, 7
    s_add_u32 s69, s69, 1310720
    v_and_b32 v8, 7, v0
    v_lshlrev_b32 v3, 4, v8
    v_lshrrev_b32 v9, 5, v0
    v_lshl_add_u32 v3, v9, 7, v3
    v_lshrrev_b32 v4, 3, v0
    v_lshlrev_b32 v4, 14, v4
    v_lshl_add_u32 v4, v8, 4, v4
    s_lshl_b32 s9, s3, 7
    v_add_u32 v4, s9, v4
    s_lshl_b32 s9, s3, 9
    v_lshlrev_b32 v1, 5, v6
    v_lshl_add_u32 v1, v5, 3, v1
    v_add_u32 v1, s9, v1
    s_mov_b32 s57, 4096
    s_mov_b32 s58, 8192
    s_mov_b32 s59, 12288
    s_mov_b32 s56, 0
    s_mov_b32 s101, s56
    s_waitcnt vmcnt(21)
    v_lshlrev_b32 v30, 16, v44
    v_and_b32 v31, s60, v44
    v_lshlrev_b32 v22, 16, v100
    v_and_b32 v23, s60, v100
    v_lshlrev_b32 v24, 16, v101
    v_and_b32 v25, s60, v101
    v_lshlrev_b32 v26, 16, v102
    v_and_b32 v27, s60, v102
    v_lshlrev_b32 v28, 16, v103
    v_and_b32 v29, s60, v103
    v_pk_mul_f32 v[14:15], v[22:23], v[30:31] op_sel_hi:[1,0]
    v_pk_mul_f32 v[16:17], v[24:25], v[30:31] op_sel_hi:[1,0]
    v_pk_mul_f32 v[18:19], v[26:27], v[30:31] op_sel_hi:[1,0]
    v_pk_mul_f32 v[20:21], v[28:29], v[30:31] op_sel_hi:[1,0]
    v_lshlrev_b32 v22, 16, v104
    v_and_b32 v23, s60, v104
    v_lshlrev_b32 v24, 16, v105
    v_and_b32 v25, s60, v105
    v_lshlrev_b32 v26, 16, v106
    v_and_b32 v27, s60, v106
    v_lshlrev_b32 v28, 16, v107
    v_and_b32 v29, s60, v107
    v_pk_fma_f32 v[14:15], v[22:23], v[30:31], v[14:15] op_sel:[0,1,0] op_sel_hi:[1,1,1]
    v_pk_fma_f32 v[16:17], v[24:25], v[30:31], v[16:17] op_sel:[0,1,0] op_sel_hi:[1,1,1]
    v_pk_fma_f32 v[18:19], v[26:27], v[30:31], v[18:19] op_sel:[0,1,0] op_sel_hi:[1,1,1]
    v_pk_fma_f32 v[20:21], v[28:29], v[30:31], v[20:21] op_sel:[0,1,0] op_sel_hi:[1,1,1]
    v_lshlrev_b32 v30, 16, v45
    v_and_b32 v31, s60, v45
    v_lshlrev_b32 v22, 16, v108
    v_and_b32 v23, s60, v108
    v_lshlrev_b32 v24, 16, v109
    v_and_b32 v25, s60, v109
    v_lshlrev_b32 v26, 16, v110
    v_and_b32 v27, s60, v110
    v_lshlrev_b32 v28, 16, v111
    v_and_b32 v29, s60, v111
    v_pk_fma_f32 v[14:15], v[22:23], v[30:31], v[14:15] op_sel_hi:[1,0,1]
    v_pk_fma_f32 v[16:17], v[24:25], v[30:31], v[16:17] op_sel_hi:[1,0,1]
    v_pk_fma_f32 v[18:19], v[26:27], v[30:31], v[18:19] op_sel_hi:[1,0,1]
    v_pk_fma_f32 v[20:21], v[28:29], v[30:31], v[20:21] op_sel_hi:[1,0,1]
    v_lshlrev_b32 v22, 16, v112
    v_and_b32 v23, s60, v112
    v_lshlrev_b32 v24, 16, v113
    v_and_b32 v25, s60, v113
    v_lshlrev_b32 v26, 16, v114
    v_and_b32 v27, s60, v114
    v_lshlrev_b32 v28, 16, v115
    v_and_b32 v29, s60, v115
    v_pk_fma_f32 v[14:15], v[22:23], v[30:31], v[14:15] op_sel:[0,1,0] op_sel_hi:[1,1,1]
    v_pk_fma_f32 v[16:17], v[24:25], v[30:31], v[16:17] op_sel:[0,1,0] op_sel_hi:[1,1,1]
    v_pk_fma_f32 v[18:19], v[26:27], v[30:31], v[18:19] op_sel:[0,1,0] op_sel_hi:[1,1,1]
    v_pk_fma_f32 v[20:21], v[28:29], v[30:31], v[20:21] op_sel:[0,1,0] op_sel_hi:[1,1,1]
    s_waitcnt vmcnt(14)
    v_lshlrev_b32 v30, 16, v46
    v_and_b32 v31, s60, v46
    v_lshlrev_b32 v22, 16, v116
    v_and_b32 v23, s60, v116
    v_lshlrev_b32 v24, 16, v117
    v_and_b32 v25, s60, v117
    v_lshlrev_b32 v26, 16, v118
    v_and_b32 v27, s60, v118
    v_lshlrev_b32 v28, 16, v119
    v_and_b32 v29, s60, v119
    v_pk_fma_f32 v[14:15], v[22:23], v[30:31], v[14:15] op_sel_hi:[1,0,1]
    v_pk_fma_f32 v[16:17], v[24:25], v[30:31], v[16:17] op_sel_hi:[1,0,1]
    v_pk_fma_f32 v[18:19], v[26:27], v[30:31], v[18:19] op_sel_hi:[1,0,1]
    v_pk_fma_f32 v[20:21], v[28:29], v[30:31], v[20:21] op_sel_hi:[1,0,1]
    v_lshlrev_b32 v22, 16, v120
    v_and_b32 v23, s60, v120
    v_lshlrev_b32 v24, 16, v121
    v_and_b32 v25, s60, v121
    v_lshlrev_b32 v26, 16, v122
    v_and_b32 v27, s60, v122
    v_lshlrev_b32 v28, 16, v123
    v_and_b32 v29, s60, v123
    v_pk_fma_f32 v[14:15], v[22:23], v[30:31], v[14:15] op_sel:[0,1,0] op_sel_hi:[1,1,1]
    v_pk_fma_f32 v[16:17], v[24:25], v[30:31], v[16:17] op_sel:[0,1,0] op_sel_hi:[1,1,1]
    v_pk_fma_f32 v[18:19], v[26:27], v[30:31], v[18:19] op_sel:[0,1,0] op_sel_hi:[1,1,1]
    v_pk_fma_f32 v[20:21], v[28:29], v[30:31], v[20:21] op_sel:[0,1,0] op_sel_hi:[1,1,1]
    v_lshlrev_b32 v30, 16, v47
    v_and_b32 v31, s60, v47
    v_lshlrev_b32 v22, 16, v124
    v_and_b32 v23, s60, v124
    v_lshlrev_b32 v24, 16, v125
    v_and_b32 v25, s60, v125
    v_lshlrev_b32 v26, 16, v126
    v_and_b32 v27, s60, v126
    v_lshlrev_b32 v28, 16, v127
    v_and_b32 v29, s60, v127
    v_pk_fma_f32 v[14:15], v[22:23], v[30:31], v[14:15] op_sel_hi:[1,0,1]
    v_pk_fma_f32 v[16:17], v[24:25], v[30:31], v[16:17] op_sel_hi:[1,0,1]
    v_pk_fma_f32 v[18:19], v[26:27], v[30:31], v[18:19] op_sel_hi:[1,0,1]
    v_pk_fma_f32 v[20:21], v[28:29], v[30:31], v[20:21] op_sel_hi:[1,0,1]
    v_lshlrev_b32 v22, 16, v128
    v_and_b32 v23, s60, v128
    v_lshlrev_b32 v24, 16, v129
    v_and_b32 v25, s60, v129
    v_lshlrev_b32 v26, 16, v130
    v_and_b32 v27, s60, v130
    v_lshlrev_b32 v28, 16, v131
    v_and_b32 v29, s60, v131
    v_pk_fma_f32 v[14:15], v[22:23], v[30:31], v[14:15] op_sel:[0,1,0] op_sel_hi:[1,1,1]
    v_pk_fma_f32 v[16:17], v[24:25], v[30:31], v[16:17] op_sel:[0,1,0] op_sel_hi:[1,1,1]
    v_pk_fma_f32 v[18:19], v[26:27], v[30:31], v[18:19] op_sel:[0,1,0] op_sel_hi:[1,1,1]
    v_pk_fma_f32 v[20:21], v[28:29], v[30:31], v[20:21] op_sel:[0,1,0] op_sel_hi:[1,1,1]
    s_waitcnt vmcnt(7)
    v_lshlrev_b32 v30, 16, v48
    v_and_b32 v31, s60, v48
    v_lshlrev_b32 v22, 16, v132
    v_and_b32 v23, s60, v132
    v_lshlrev_b32 v24, 16, v133
    v_and_b32 v25, s60, v133
    v_lshlrev_b32 v26, 16, v134
    v_and_b32 v27, s60, v134
    v_lshlrev_b32 v28, 16, v135
    v_and_b32 v29, s60, v135
    v_pk_fma_f32 v[14:15], v[22:23], v[30:31], v[14:15] op_sel_hi:[1,0,1]
    v_pk_fma_f32 v[16:17], v[24:25], v[30:31], v[16:17] op_sel_hi:[1,0,1]
    v_pk_fma_f32 v[18:19], v[26:27], v[30:31], v[18:19] op_sel_hi:[1,0,1]
    v_pk_fma_f32 v[20:21], v[28:29], v[30:31], v[20:21] op_sel_hi:[1,0,1]
    v_lshlrev_b32 v22, 16, v136
    v_and_b32 v23, s60, v136
    v_lshlrev_b32 v24, 16, v137
    v_and_b32 v25, s60, v137
    v_lshlrev_b32 v26, 16, v138
    v_and_b32 v27, s60, v138
    v_lshlrev_b32 v28, 16, v139
    v_and_b32 v29, s60, v139
    v_pk_fma_f32 v[14:15], v[22:23], v[30:31], v[14:15] op_sel:[0,1,0] op_sel_hi:[1,1,1]
    v_pk_fma_f32 v[16:17], v[24:25], v[30:31], v[16:17] op_sel:[0,1,0] op_sel_hi:[1,1,1]
    v_pk_fma_f32 v[18:19], v[26:27], v[30:31], v[18:19] op_sel:[0,1,0] op_sel_hi:[1,1,1]
    v_pk_fma_f32 v[20:21], v[28:29], v[30:31], v[20:21] op_sel:[0,1,0] op_sel_hi:[1,1,1]
    v_lshlrev_b32 v30, 16, v49
    v_and_b32 v31, s60, v49
    v_lshlrev_b32 v22, 16, v140
    v_and_b32 v23, s60, v140
    v_lshlrev_b32 v24, 16, v141
    v_and_b32 v25, s60, v141
    v_lshlrev_b32 v26, 16, v142
    v_and_b32 v27, s60, v142
    v_lshlrev_b32 v28, 16, v143
    v_and_b32 v29, s60, v143
    v_pk_fma_f32 v[14:15], v[22:23], v[30:31], v[14:15] op_sel_hi:[1,0,1]
    v_pk_fma_f32 v[16:17], v[24:25], v[30:31], v[16:17] op_sel_hi:[1,0,1]
    v_pk_fma_f32 v[18:19], v[26:27], v[30:31], v[18:19] op_sel_hi:[1,0,1]
    v_pk_fma_f32 v[20:21], v[28:29], v[30:31], v[20:21] op_sel_hi:[1,0,1]
    v_lshlrev_b32 v22, 16, v144
    v_and_b32 v23, s60, v144
    v_lshlrev_b32 v24, 16, v145
    v_and_b32 v25, s60, v145
    v_lshlrev_b32 v26, 16, v146
    v_and_b32 v27, s60, v146
    v_lshlrev_b32 v28, 16, v147
    v_and_b32 v29, s60, v147
    v_pk_fma_f32 v[14:15], v[22:23], v[30:31], v[14:15] op_sel:[0,1,0] op_sel_hi:[1,1,1]
    v_pk_fma_f32 v[16:17], v[24:25], v[30:31], v[16:17] op_sel:[0,1,0] op_sel_hi:[1,1,1]
    v_pk_fma_f32 v[18:19], v[26:27], v[30:31], v[18:19] op_sel:[0,1,0] op_sel_hi:[1,1,1]
    v_pk_fma_f32 v[20:21], v[28:29], v[30:31], v[20:21] op_sel:[0,1,0] op_sel_hi:[1,1,1]
    buffer_load_dwordx4 v[32:35], v2, s[32:35], s56 offen offset:0 nt
    buffer_load_dwordx4 v[36:39], v2, s[32:35], s56 offen offset:1024 nt
    buffer_load_dwordx4 v[40:43], v2, s[32:35], s56 offen offset:2048 nt
    s_waitcnt vmcnt(3)
    v_lshlrev_b32 v30, 16, v50
    v_and_b32 v31, s60, v50
    v_lshlrev_b32 v22, 16, v148
    v_and_b32 v23, s60, v148
    v_lshlrev_b32 v24, 16, v149
    v_and_b32 v25, s60, v149
    v_lshlrev_b32 v26, 16, v150
    v_and_b32 v27, s60, v150
    v_lshlrev_b32 v28, 16, v151
    v_and_b32 v29, s60, v151
    v_pk_fma_f32 v[14:15], v[22:23], v[30:31], v[14:15] op_sel_hi:[1,0,1]
    v_pk_fma_f32 v[16:17], v[24:25], v[30:31], v[16:17] op_sel_hi:[1,0,1]
    v_pk_fma_f32 v[18:19], v[26:27], v[30:31], v[18:19] op_sel_hi:[1,0,1]
    v_pk_fma_f32 v[20:21], v[28:29], v[30:31], v[20:21] op_sel_hi:[1,0,1]
    v_lshlrev_b32 v22, 16, v152
    v_and_b32 v23, s60, v152
    v_lshlrev_b32 v24, 16, v153
    v_and_b32 v25, s60, v153
    v_lshlrev_b32 v26, 16, v154
    v_and_b32 v27, s60, v154
    v_lshlrev_b32 v28, 16, v155
    v_and_b32 v29, s60, v155
    v_pk_fma_f32 v[14:15], v[22:23], v[30:31], v[14:15] op_sel:[0,1,0] op_sel_hi:[1,1,1]
    v_pk_fma_f32 v[16:17], v[24:25], v[30:31], v[16:17] op_sel:[0,1,0] op_sel_hi:[1,1,1]
    v_pk_fma_f32 v[18:19], v[26:27], v[30:31], v[18:19] op_sel:[0,1,0] op_sel_hi:[1,1,1]
    v_pk_fma_f32 v[20:21], v[28:29], v[30:31], v[20:21] op_sel:[0,1,0] op_sel_hi:[1,1,1]
    v_lshlrev_b32 v30, 16, v51
    v_and_b32 v31, s60, v51
    v_lshlrev_b32 v22, 16, v156
    v_and_b32 v23, s60, v156
    v_lshlrev_b32 v24, 16, v157
    v_and_b32 v25, s60, v157
    v_lshlrev_b32 v26, 16, v158
    v_and_b32 v27, s60, v158
    v_lshlrev_b32 v28, 16, v159
    v_and_b32 v29, s60, v159
    v_pk_fma_f32 v[14:15], v[22:23], v[30:31], v[14:15] op_sel_hi:[1,0,1]
    v_pk_fma_f32 v[16:17], v[24:25], v[30:31], v[16:17] op_sel_hi:[1,0,1]
    v_pk_fma_f32 v[18:19], v[26:27], v[30:31], v[18:19] op_sel_hi:[1,0,1]
    v_pk_fma_f32 v[20:21], v[28:29], v[30:31], v[20:21] op_sel_hi:[1,0,1]
    v_lshlrev_b32 v22, 16, v160
    v_and_b32 v23, s60, v160
    v_lshlrev_b32 v24, 16, v161
    v_and_b32 v25, s60, v161
    v_lshlrev_b32 v26, 16, v162
    v_and_b32 v27, s60, v162
    v_lshlrev_b32 v28, 16, v163
    v_and_b32 v29, s60, v163
    v_pk_fma_f32 v[14:15], v[22:23], v[30:31], v[14:15] op_sel:[0,1,0] op_sel_hi:[1,1,1]
    v_pk_fma_f32 v[16:17], v[24:25], v[30:31], v[16:17] op_sel:[0,1,0] op_sel_hi:[1,1,1]
    v_pk_fma_f32 v[18:19], v[26:27], v[30:31], v[18:19] op_sel:[0,1,0] op_sel_hi:[1,1,1]
    v_pk_fma_f32 v[20:21], v[28:29], v[30:31], v[20:21] op_sel:[0,1,0] op_sel_hi:[1,1,1]
    s_nop 0
    v_permlane32_swap_b32 v14, v18
    v_permlane32_swap_b32 v15, v19
    v_permlane32_swap_b32 v16, v20
    v_permlane32_swap_b32 v17, v21
    v_pk_add_f32 v[14:15], v[14:15], v[18:19]
    v_pk_add_f32 v[16:17], v[16:17], v[20:21]
    s_nop 1
    v_permlane16_swap_b32 v14, v16
    v_permlane16_swap_b32 v15, v17
    v_pk_add_f32 v[14:15], v[14:15], v[16:17]
    ds_write_b64 v1, v[14:15] offset:0
    v_lshlrev_b32 v7, 3, v0
    s_waitcnt lgkmcnt(0)
    s_barrier
    ds_read_b64 v[14:15], v7 offset:0
    ds_read_b64 v[16:17], v7 offset:512
    ds_read_b64 v[18:19], v7 offset:1024
    ds_read_b64 v[20:21], v7 offset:1536
    ds_read_b64 v[22:23], v7 offset:2048
    ds_read_b64 v[24:25], v7 offset:2560
    ds_read_b64 v[26:27], v7 offset:3072
    ds_read_b64 v[28:29], v7 offset:3584
    s_lshl_b32 s9, s3, 8
    v_lshlrev_b32 v8, 2, v0
    v_add_u32 v8, s9, v8
    v_lshlrev_b32 v9, 4, v6
    v_add_u32 v9, s9, v9
    s_waitcnt lgkmcnt(0)
    v_pk_add_f32 v[14:15], v[14:15], v[16:17]
    v_pk_add_f32 v[18:19], v[18:19], v[20:21]
    v_pk_add_f32 v[22:23], v[22:23], v[24:25]
    v_pk_add_f32 v[26:27], v[26:27], v[28:29]
    v_pk_add_f32 v[14:15], v[14:15], v[18:19]
    v_pk_add_f32 v[22:23], v[22:23], v[26:27]
    v_pk_add_f32 v[14:15], v[14:15], v[22:23]
    v_cvt_pk_bf16_f32 v14, v14, v15
    ds_write_b32 v8, v14 offset:4096
    s_waitcnt lgkmcnt(0)
    ds_read_b128 v[8:11], v9 offset:4096
    v_mov_b32 v12, 0xff800000
    s_mov_b32 s16, 0
    v_mov_b32 v29, 0
    s_mov_b32 s17, 0
    s_mov_b32 s21, 0
    s_mov_b64 vcc, 0
    s_lshr_b32 s9, s2, 3
    s_lshl_b32 s10, s2, 1
    s_and_b32 s10, s10, 14
    s_add_u32 s9, s9, s10
    s_and_b32 s9, s9, 15
    s_lshl_b32 s9, s9, 8
    s_add_u32 s9, s9, 1310784
    s_add_u32 s64, s12, s9
    s_addc_u32 s65, s13, 0
    s_lshl_b32 s9, s3, 11
    s_add_u32 s9, s9, 41472
    v_lshlrev_b32 v13, 4, v5
    v_and_b32 v14, 4, v0
    v_lshlrev_b32 v14, 1, v14
    v_and_b32 v15, 8, v0
    v_lshrrev_b32 v15, 1, v15
    v_add3_u32 v13, v13, v14, v15
    v_add_u32 v13, s9, v13
    s_waitcnt lgkmcnt(0)
    s_waitcnt vmcnt(2)
    buffer_load_dwordx4 v[44:47], v2, s[32:35], s56 offen offset:3072 nt
    s_waitcnt vmcnt(2)
    s_add_u32 s56, s56, 65536
    buffer_load_dwordx4 v[48:51], v2, s[32:35], s56 offen offset:0 nt
    s_cbranch_vccnz L_w0
    s_waitcnt vmcnt(2)
L_w0:
    s_barrier
    v_dot2_f32_bf16 v22, v32, v8, 0
    v_dot2_f32_bf16 v22, v33, v9, v22
    v_dot2_f32_bf16 v22, v34, v10, v22
    v_dot2_f32_bf16 v22, v35, v11, v22
    buffer_load_dwordx4 v[32:35], v2, s[32:35], s56 offen offset:1024 nt
    s_cbranch_vccnz L_w1
    s_waitcnt vmcnt(2)
L_w1:
    v_dot2_f32_bf16 v23, v36, v8, 0
    v_dot2_f32_bf16 v23, v37, v9, v23
    v_dot2_f32_bf16 v23, v38, v10, v23
    v_dot2_f32_bf16 v23, v39, v11, v23
    buffer_load_dwordx4 v[36:39], v2, s[32:35], s56 offen offset:2048 nt
    s_waitcnt vmcnt(4)
    s_cbranch_vccnz L_w2
    s_waitcnt vmcnt(2)
L_w2:
    v_dot2_f32_bf16 v24, v40, v8, 0
    v_dot2_f32_bf16 v24, v41, v9, v24
    v_dot2_f32_bf16 v24, v42, v10, v24
    v_dot2_f32_bf16 v24, v43, v11, v24
    buffer_load_dwordx4 v[40:43], v2, s[32:35], s56 offen offset:3072 nt
    s_waitcnt vmcnt(4)
    s_cbranch_vccnz L_w3
    s_waitcnt vmcnt(2)
L_w3:
    v_dot2_f32_bf16 v25, v44, v8, 0
    v_dot2_f32_bf16 v25, v45, v9, v25
    v_dot2_f32_bf16 v25, v46, v10, v25
    v_dot2_f32_bf16 v25, v47, v11, v25
    v_add_f32_dpp v26, v22, v22 row_ror:8 row_mask:0xf bank_mask:0x3
    v_add_f32_dpp v27, v24, v24 row_ror:8 row_mask:0xf bank_mask:0x3
    s_nop 0
    v_add_f32_dpp v26, v23, v23 row_ror:8 row_mask:0xf bank_mask:0xc
    v_add_f32_dpp v27, v25, v25 row_ror:8 row_mask:0xf bank_mask:0xc
    s_nop 0
    v_add_f32_dpp v28, v26, v26 row_half_mirror row_mask:0xf bank_mask:0x5
    s_nop 1
    v_add_f32_dpp v28, v27, v27 row_half_mirror row_mask:0xf bank_mask:0xa
    s_nop 1
    v_add_f32_dpp v28, v28, v28 quad_perm:[1,0,3,2] row_mask:0xf bank_mask:0xf
    s_nop 1
    v_add_f32_dpp v28, v28, v28 quad_perm:[2,3,0,1] row_mask:0xf bank_mask:0xf
    v_cvt_pk_bf16_f32 v28, v28, v28
    v_lshlrev_b32 v28, 16, v28
    v_mul_f32 v28, s61, v28
    v_cvt_pk_bf16_f32 v28, v28, v28
    v_lshlrev_b32 v28, 16, v28
    v_mul_f32 v28, s62, v28
    v_max_f32 v12, v12, v28
    ds_write_b32 v13, v28 offset:0
    s_add_u32 s56, s56, 65536
    buffer_load_dwordx4 v[44:47], v2, s[32:35], s56 offen offset:0 nt
    s_waitcnt vmcnt(4)
    s_cbranch_vccnz L_w4
    s_waitcnt vmcnt(2)
L_w4:
    s_barrier
    v_dot2_f32_bf16 v22, v48, v8, 0
    v_dot2_f32_bf16 v22, v49, v9, v22
    v_dot2_f32_bf16 v22, v50, v10, v22
    v_dot2_f32_bf16 v22, v51, v11, v22
    buffer_load_dwordx4 v[48:51], v2, s[32:35], s56 offen offset:1024 nt
    s_waitcnt vmcnt(4)
    s_cbranch_vccnz L_w5
    s_waitcnt vmcnt(2)
L_w5:
    v_dot2_f32_bf16 v23, v32, v8, 0
    v_dot2_f32_bf16 v23, v33, v9, v23
    v_dot2_f32_bf16 v23, v34, v10, v23
    v_dot2_f32_bf16 v23, v35, v11, v23
    buffer_load_dwordx4 v[32:35], v2, s[32:35], s56 offen offset:2048 nt
    s_waitcnt vmcnt(4)
    s_cbranch_vccnz L_w6
    s_waitcnt vmcnt(2)
L_w6:
    v_dot2_f32_bf16 v24, v36, v8, 0
    v_dot2_f32_bf16 v24, v37, v9, v24
    v_dot2_f32_bf16 v24, v38, v10, v24
    v_dot2_f32_bf16 v24, v39, v11, v24
    buffer_load_dwordx4 v[36:39], v2, s[32:35], s56 offen offset:3072 nt
    s_waitcnt vmcnt(4)
    s_cbranch_vccnz L_w7
    s_waitcnt vmcnt(2)
L_w7:
    v_dot2_f32_bf16 v25, v40, v8, 0
    v_dot2_f32_bf16 v25, v41, v9, v25
    v_dot2_f32_bf16 v25, v42, v10, v25
    v_dot2_f32_bf16 v25, v43, v11, v25
    v_add_f32_dpp v26, v22, v22 row_ror:8 row_mask:0xf bank_mask:0x3
    v_add_f32_dpp v27, v24, v24 row_ror:8 row_mask:0xf bank_mask:0x3
    s_nop 0
    v_add_f32_dpp v26, v23, v23 row_ror:8 row_mask:0xf bank_mask:0xc
    v_add_f32_dpp v27, v25, v25 row_ror:8 row_mask:0xf bank_mask:0xc
    s_nop 0
    v_add_f32_dpp v28, v26, v26 row_half_mirror row_mask:0xf bank_mask:0x5
    s_nop 1
    v_add_f32_dpp v28, v27, v27 row_half_mirror row_mask:0xf bank_mask:0xa
    s_nop 1
    v_add_f32_dpp v28, v28, v28 quad_perm:[1,0,3,2] row_mask:0xf bank_mask:0xf
    s_nop 1
    v_add_f32_dpp v28, v28, v28 quad_perm:[2,3,0,1] row_mask:0xf bank_mask:0xf
    v_cvt_pk_bf16_f32 v28, v28, v28
    v_lshlrev_b32 v28, 16, v28
    v_mul_f32 v28, s61, v28
    v_cvt_pk_bf16_f32 v28, v28, v28
    v_lshlrev_b32 v28, 16, v28
    v_mul_f32 v28, s62, v28
    v_max_f32 v12, v12, v28
    ds_write_b32 v13, v28 offset:64
    s_add_u32 s56, s56, 65536
    buffer_load_dwordx4 v[40:43], v2, s[32:35], s56 offen offset:0 nt
    s_waitcnt vmcnt(4)
    s_cbranch_vccnz L_w8
    s_waitcnt vmcnt(2)
L_w8:
    s_barrier
    v_dot2_f32_bf16 v22, v44, v8, 0
    v_dot2_f32_bf16 v22, v45, v9, v22
    v_dot2_f32_bf16 v22, v46, v10, v22
    v_dot2_f32_bf16 v22, v47, v11, v22
    buffer_load_dwordx4 v[44:47], v2, s[32:35], s56 offen offset:1024 nt
    s_waitcnt vmcnt(4)
    s_cbranch_vccnz L_w9
    s_waitcnt vmcnt(2)
L_w9:
    v_dot2_f32_bf16 v23, v48, v8, 0
    v_dot2_f32_bf16 v23, v49, v9, v23
    v_dot2_f32_bf16 v23, v50, v10, v23
    v_dot2_f32_bf16 v23, v51, v11, v23
    buffer_load_dwordx4 v[48:51], v2, s[32:35], s56 offen offset:2048 nt
    s_waitcnt vmcnt(4)
    s_cbranch_vccnz L_w10
    s_waitcnt vmcnt(2)
L_w10:
    v_dot2_f32_bf16 v24, v32, v8, 0
    v_dot2_f32_bf16 v24, v33, v9, v24
    v_dot2_f32_bf16 v24, v34, v10, v24
    v_dot2_f32_bf16 v24, v35, v11, v24
    buffer_load_dwordx4 v[32:35], v2, s[32:35], s56 offen offset:3072 nt
    s_waitcnt vmcnt(4)
    s_cbranch_vccnz L_w11
    s_waitcnt vmcnt(2)
L_w11:
    v_dot2_f32_bf16 v25, v36, v8, 0
    v_dot2_f32_bf16 v25, v37, v9, v25
    v_dot2_f32_bf16 v25, v38, v10, v25
    v_dot2_f32_bf16 v25, v39, v11, v25
    v_add_f32_dpp v26, v22, v22 row_ror:8 row_mask:0xf bank_mask:0x3
    v_add_f32_dpp v27, v24, v24 row_ror:8 row_mask:0xf bank_mask:0x3
    s_nop 0
    v_add_f32_dpp v26, v23, v23 row_ror:8 row_mask:0xf bank_mask:0xc
    v_add_f32_dpp v27, v25, v25 row_ror:8 row_mask:0xf bank_mask:0xc
    s_nop 0
    v_add_f32_dpp v28, v26, v26 row_half_mirror row_mask:0xf bank_mask:0x5
    s_nop 1
    v_add_f32_dpp v28, v27, v27 row_half_mirror row_mask:0xf bank_mask:0xa
    s_nop 1
    v_add_f32_dpp v28, v28, v28 quad_perm:[1,0,3,2] row_mask:0xf bank_mask:0xf
    s_nop 1
    v_add_f32_dpp v28, v28, v28 quad_perm:[2,3,0,1] row_mask:0xf bank_mask:0xf
    v_cvt_pk_bf16_f32 v28, v28, v28
    v_lshlrev_b32 v28, 16, v28
    v_mul_f32 v28, s61, v28
    v_cvt_pk_bf16_f32 v28, v28, v28
    v_lshlrev_b32 v28, 16, v28
    v_mul_f32 v28, s62, v28
    v_max_f32 v12, v12, v28
    ds_write_b32 v13, v28 offset:128
    s_add_u32 s56, s56, 65536
    buffer_load_dwordx4 v[36:39], v2, s[32:35], s56 offen offset:0 nt
    s_waitcnt vmcnt(4)
    s_cbranch_vccnz L_w12
    s_waitcnt vmcnt(2)
L_w12:
    s_barrier
    v_dot2_f32_bf16 v22, v40, v8, 0
    v_dot2_f32_bf16 v22, v41, v9, v22
    v_dot2_f32_bf16 v22, v42, v10, v22
    v_dot2_f32_bf16 v22, v43, v11, v22
    buffer_load_dwordx4 v[40:43], v2, s[32:35], s56 offen offset:1024 nt
    s_waitcnt vmcnt(4)
    s_cbranch_vccnz L_w13
    s_waitcnt vmcnt(2)
L_w13:
    v_dot2_f32_bf16 v23, v44, v8, 0
    v_dot2_f32_bf16 v23, v45, v9, v23
    v_dot2_f32_bf16 v23, v46, v10, v23
    v_dot2_f32_bf16 v23, v47, v11, v23
    buffer_load_dwordx4 v[44:47], v2, s[32:35], s56 offen offset:2048 nt
    s_waitcnt vmcnt(4)
    s_cbranch_vccnz L_w14
    s_waitcnt vmcnt(2)
L_w14:
    v_dot2_f32_bf16 v24, v48, v8, 0
    v_dot2_f32_bf16 v24, v49, v9, v24
    v_dot2_f32_bf16 v24, v50, v10, v24
    v_dot2_f32_bf16 v24, v51, v11, v24
    buffer_load_dwordx4 v[48:51], v2, s[32:35], s56 offen offset:3072 nt
    s_waitcnt vmcnt(4)
    s_cbranch_vccnz L_w15
    s_waitcnt vmcnt(2)
L_w15:
    v_dot2_f32_bf16 v25, v32, v8, 0
    v_dot2_f32_bf16 v25, v33, v9, v25
    v_dot2_f32_bf16 v25, v34, v10, v25
    v_dot2_f32_bf16 v25, v35, v11, v25
    v_add_f32_dpp v26, v22, v22 row_ror:8 row_mask:0xf bank_mask:0x3
    v_add_f32_dpp v27, v24, v24 row_ror:8 row_mask:0xf bank_mask:0x3
    s_nop 0
    v_add_f32_dpp v26, v23, v23 row_ror:8 row_mask:0xf bank_mask:0xc
    v_add_f32_dpp v27, v25, v25 row_ror:8 row_mask:0xf bank_mask:0xc
    s_nop 0
    v_add_f32_dpp v28, v26, v26 row_half_mirror row_mask:0xf bank_mask:0x5
    s_nop 1
    v_add_f32_dpp v28, v27, v27 row_half_mirror row_mask:0xf bank_mask:0xa
    s_nop 1
    v_add_f32_dpp v28, v28, v28 quad_perm:[1,0,3,2] row_mask:0xf bank_mask:0xf
    s_nop 1
    v_add_f32_dpp v28, v28, v28 quad_perm:[2,3,0,1] row_mask:0xf bank_mask:0xf
    v_cvt_pk_bf16_f32 v28, v28, v28
    v_lshlrev_b32 v28, 16, v28
    v_mul_f32 v28, s61, v28
    v_cvt_pk_bf16_f32 v28, v28, v28
    v_lshlrev_b32 v28, 16, v28
    v_mul_f32 v28, s62, v28
    v_max_f32 v12, v12, v28
    ds_write_b32 v13, v28 offset:192
    s_add_u32 s56, s56, 65536
    buffer_load_dwordx4 v[32:35], v2, s[32:35], s56 offen offset:0 nt
    s_waitcnt vmcnt(4)
    s_cbranch_vccnz L_w16
    s_waitcnt vmcnt(2)
L_w16:
    s_barrier
    v_dot2_f32_bf16 v22, v36, v8, 0
    v_dot2_f32_bf16 v22, v37, v9, v22
    v_dot2_f32_bf16 v22, v38, v10, v22
    v_dot2_f32_bf16 v22, v39, v11, v22
    buffer_load_dwordx4 v[36:39], v2, s[32:35], s56 offen offset:1024 nt
    s_waitcnt vmcnt(4)
    s_cbranch_vccnz L_w17
    s_waitcnt vmcnt(2)
L_w17:
    v_dot2_f32_bf16 v23, v40, v8, 0
    v_dot2_f32_bf16 v23, v41, v9, v23
    v_dot2_f32_bf16 v23, v42, v10, v23
    v_dot2_f32_bf16 v23, v43, v11, v23
    buffer_load_dwordx4 v[40:43], v2, s[32:35], s56 offen offset:2048 nt
    s_waitcnt vmcnt(4)
    s_cbranch_vccnz L_w18
    s_waitcnt vmcnt(2)
L_w18:
    v_dot2_f32_bf16 v24, v44, v8, 0
    v_dot2_f32_bf16 v24, v45, v9, v24
    v_dot2_f32_bf16 v24, v46, v10, v24
    v_dot2_f32_bf16 v24, v47, v11, v24
    buffer_load_dwordx4 v[44:47], v2, s[32:35], s56 offen offset:3072 nt
    s_waitcnt vmcnt(4)
    s_cbranch_vccnz L_w19
    s_waitcnt vmcnt(2)
L_w19:
    v_dot2_f32_bf16 v25, v48, v8, 0
    v_dot2_f32_bf16 v25, v49, v9, v25
    v_dot2_f32_bf16 v25, v50, v10, v25
    v_dot2_f32_bf16 v25, v51, v11, v25
    v_add_f32_dpp v26, v22, v22 row_ror:8 row_mask:0xf bank_mask:0x3
    v_add_f32_dpp v27, v24, v24 row_ror:8 row_mask:0xf bank_mask:0x3
    s_nop 0
    v_add_f32_dpp v26, v23, v23 row_ror:8 row_mask:0xf bank_mask:0xc
    v_add_f32_dpp v27, v25, v25 row_ror:8 row_mask:0xf bank_mask:0xc
    s_nop 0
    v_add_f32_dpp v28, v26, v26 row_half_mirror row_mask:0xf bank_mask:0x5
    s_nop 1
    v_add_f32_dpp v28, v27, v27 row_half_mirror row_mask:0xf bank_mask:0xa
    s_nop 1
    v_add_f32_dpp v28, v28, v28 quad_perm:[1,0,3,2] row_mask:0xf bank_mask:0xf
    s_nop 1
    v_add_f32_dpp v28, v28, v28 quad_perm:[2,3,0,1] row_mask:0xf bank_mask:0xf
    v_cvt_pk_bf16_f32 v28, v28, v28
    v_lshlrev_b32 v28, 16, v28
    v_mul_f32 v28, s61, v28
    v_cvt_pk_bf16_f32 v28, v28, v28
    v_lshlrev_b32 v28, 16, v28
    v_mul_f32 v28, s62, v28
    v_max_f32 v12, v12, v28
    ds_write_b32 v13, v28 offset:256
    s_add_u32 s56, s56, 65536
    buffer_load_dwordx4 v[48:51], v2, s[32:35], s56 offen offset:0 nt
    s_waitcnt vmcnt(4)
    s_cbranch_vccnz L_w20
    s_waitcnt vmcnt(2)
L_w20:
    s_barrier
    v_dot2_f32_bf16 v22, v32, v8, 0
    v_dot2_f32_bf16 v22, v33, v9, v22
    v_dot2_f32_bf16 v22, v34, v10, v22
    v_dot2_f32_bf16 v22, v35, v11, v22
    buffer_load_dwordx4 v[32:35], v2, s[32:35], s56 offen offset:1024 nt
    s_waitcnt vmcnt(4)
    s_cbranch_vccnz L_w21
    s_waitcnt vmcnt(2)
L_w21:
    v_dot2_f32_bf16 v23, v36, v8, 0
    v_dot2_f32_bf16 v23, v37, v9, v23
    v_dot2_f32_bf16 v23, v38, v10, v23
    v_dot2_f32_bf16 v23, v39, v11, v23
    buffer_load_dwordx4 v[36:39], v2, s[32:35], s56 offen offset:2048 nt
    s_waitcnt vmcnt(4)
    s_cbranch_vccnz L_w22
    s_waitcnt vmcnt(2)
L_w22:
    v_dot2_f32_bf16 v24, v40, v8, 0
    v_dot2_f32_bf16 v24, v41, v9, v24
    v_dot2_f32_bf16 v24, v42, v10, v24
    v_dot2_f32_bf16 v24, v43, v11, v24
    buffer_load_dwordx4 v[40:43], v2, s[32:35], s56 offen offset:3072 nt
    s_waitcnt vmcnt(4)
    s_cbranch_vccnz L_w23
    s_waitcnt vmcnt(2)
L_w23:
    v_dot2_f32_bf16 v25, v44, v8, 0
    v_dot2_f32_bf16 v25, v45, v9, v25
    v_dot2_f32_bf16 v25, v46, v10, v25
    v_dot2_f32_bf16 v25, v47, v11, v25
    v_add_f32_dpp v26, v22, v22 row_ror:8 row_mask:0xf bank_mask:0x3
    v_add_f32_dpp v27, v24, v24 row_ror:8 row_mask:0xf bank_mask:0x3
    s_nop 0
    v_add_f32_dpp v26, v23, v23 row_ror:8 row_mask:0xf bank_mask:0xc
    v_add_f32_dpp v27, v25, v25 row_ror:8 row_mask:0xf bank_mask:0xc
    s_nop 0
    v_add_f32_dpp v28, v26, v26 row_half_mirror row_mask:0xf bank_mask:0x5
    s_nop 1
    v_add_f32_dpp v28, v27, v27 row_half_mirror row_mask:0xf bank_mask:0xa
    s_nop 1
    v_add_f32_dpp v28, v28, v28 quad_perm:[1,0,3,2] row_mask:0xf bank_mask:0xf
    s_nop 1
    v_add_f32_dpp v28, v28, v28 quad_perm:[2,3,0,1] row_mask:0xf bank_mask:0xf
    v_cvt_pk_bf16_f32 v28, v28, v28
    v_lshlrev_b32 v28, 16, v28
    v_mul_f32 v28, s61, v28
    v_cvt_pk_bf16_f32 v28, v28, v28
    v_lshlrev_b32 v28, 16, v28
    v_mul_f32 v28, s62, v28
    v_max_f32 v12, v12, v28
    ds_write_b32 v13, v28 offset:320
    s_add_u32 s56, s56, 65536
    buffer_load_dwordx4 v[44:47], v2, s[32:35], s56 offen offset:0 nt
    s_waitcnt vmcnt(4)
    s_cbranch_vccnz L_w24
    s_waitcnt vmcnt(2)
L_w24:
    s_barrier
    v_dot2_f32_bf16 v22, v48, v8, 0
    v_dot2_f32_bf16 v22, v49, v9, v22
    v_dot2_f32_bf16 v22, v50, v10, v22
    v_dot2_f32_bf16 v22, v51, v11, v22
    buffer_load_dwordx4 v[48:51], v2, s[32:35], s56 offen offset:1024 nt
    s_waitcnt vmcnt(4)
    s_cbranch_vccnz L_w25
    s_waitcnt vmcnt(2)
L_w25:
    v_dot2_f32_bf16 v23, v32, v8, 0
    v_dot2_f32_bf16 v23, v33, v9, v23
    v_dot2_f32_bf16 v23, v34, v10, v23
    v_dot2_f32_bf16 v23, v35, v11, v23
    buffer_load_dwordx4 v[32:35], v2, s[32:35], s56 offen offset:2048 nt
    s_waitcnt vmcnt(4)
    s_cbranch_vccnz L_w26
    s_waitcnt vmcnt(2)
L_w26:
    v_dot2_f32_bf16 v24, v36, v8, 0
    v_dot2_f32_bf16 v24, v37, v9, v24
    v_dot2_f32_bf16 v24, v38, v10, v24
    v_dot2_f32_bf16 v24, v39, v11, v24
    buffer_load_dwordx4 v[36:39], v2, s[32:35], s56 offen offset:3072 nt
    s_waitcnt vmcnt(4)
    s_cbranch_vccnz L_w27
    s_waitcnt vmcnt(2)
L_w27:
    v_dot2_f32_bf16 v25, v40, v8, 0
    v_dot2_f32_bf16 v25, v41, v9, v25
    v_dot2_f32_bf16 v25, v42, v10, v25
    v_dot2_f32_bf16 v25, v43, v11, v25
    v_add_f32_dpp v26, v22, v22 row_ror:8 row_mask:0xf bank_mask:0x3
    v_add_f32_dpp v27, v24, v24 row_ror:8 row_mask:0xf bank_mask:0x3
    s_nop 0
    v_add_f32_dpp v26, v23, v23 row_ror:8 row_mask:0xf bank_mask:0xc
    v_add_f32_dpp v27, v25, v25 row_ror:8 row_mask:0xf bank_mask:0xc
    s_nop 0
    v_add_f32_dpp v28, v26, v26 row_half_mirror row_mask:0xf bank_mask:0x5
    s_nop 1
    v_add_f32_dpp v28, v27, v27 row_half_mirror row_mask:0xf bank_mask:0xa
    s_nop 1
    v_add_f32_dpp v28, v28, v28 quad_perm:[1,0,3,2] row_mask:0xf bank_mask:0xf
    s_nop 1
    v_add_f32_dpp v28, v28, v28 quad_perm:[2,3,0,1] row_mask:0xf bank_mask:0xf
    v_cvt_pk_bf16_f32 v28, v28, v28
    v_lshlrev_b32 v28, 16, v28
    v_mul_f32 v28, s61, v28
    v_cvt_pk_bf16_f32 v28, v28, v28
    v_lshlrev_b32 v28, 16, v28
    v_mul_f32 v28, s62, v28
    v_max_f32 v12, v12, v28
    ds_write_b32 v13, v28 offset:384
    s_add_u32 s56, s56, 65536
    buffer_load_dwordx4 v[40:43], v2, s[32:35], s56 offen offset:0 nt
    s_waitcnt vmcnt(4)
    s_cbranch_vccnz L_w28
    s_waitcnt vmcnt(2)
L_w28:
    s_barrier
    v_dot2_f32_bf16 v22, v44, v8, 0
    v_dot2_f32_bf16 v22, v45, v9, v22
    v_dot2_f32_bf16 v22, v46, v10, v22
    v_dot2_f32_bf16 v22, v47, v11, v22
    buffer_load_dwordx4 v[44:47], v2, s[32:35], s56 offen offset:1024 nt
    s_waitcnt vmcnt(4)
    s_cbranch_vccnz L_w29
    s_waitcnt vmcnt(2)
L_w29:
    v_dot2_f32_bf16 v23, v48, v8, 0
    v_dot2_f32_bf16 v23, v49, v9, v23
    v_dot2_f32_bf16 v23, v50, v10, v23
    v_dot2_f32_bf16 v23, v51, v11, v23
    buffer_load_dwordx4 v[48:51], v2, s[32:35], s56 offen offset:2048 nt
    s_waitcnt vmcnt(4)
    s_cbranch_vccnz L_w30
    s_waitcnt vmcnt(2)
L_w30:
    v_dot2_f32_bf16 v24, v32, v8, 0
    v_dot2_f32_bf16 v24, v33, v9, v24
    v_dot2_f32_bf16 v24, v34, v10, v24
    v_dot2_f32_bf16 v24, v35, v11, v24
    buffer_load_dwordx4 v[32:35], v2, s[32:35], s56 offen offset:3072 nt
    s_waitcnt vmcnt(4)
    s_cbranch_vccnz L_w31
    s_waitcnt vmcnt(2)
L_w31:
    v_dot2_f32_bf16 v25, v36, v8, 0
    v_dot2_f32_bf16 v25, v37, v9, v25
    v_dot2_f32_bf16 v25, v38, v10, v25
    v_dot2_f32_bf16 v25, v39, v11, v25
    v_add_f32_dpp v26, v22, v22 row_ror:8 row_mask:0xf bank_mask:0x3
    v_add_f32_dpp v27, v24, v24 row_ror:8 row_mask:0xf bank_mask:0x3
    s_nop 0
    v_add_f32_dpp v26, v23, v23 row_ror:8 row_mask:0xf bank_mask:0xc
    v_add_f32_dpp v27, v25, v25 row_ror:8 row_mask:0xf bank_mask:0xc
    s_nop 0
    v_add_f32_dpp v28, v26, v26 row_half_mirror row_mask:0xf bank_mask:0x5
    s_nop 1
    v_add_f32_dpp v28, v27, v27 row_half_mirror row_mask:0xf bank_mask:0xa
    s_nop 1
    v_add_f32_dpp v28, v28, v28 quad_perm:[1,0,3,2] row_mask:0xf bank_mask:0xf
    s_nop 1
    v_add_f32_dpp v28, v28, v28 quad_perm:[2,3,0,1] row_mask:0xf bank_mask:0xf
    v_cvt_pk_bf16_f32 v28, v28, v28
    v_lshlrev_b32 v28, 16, v28
    v_mul_f32 v28, s61, v28
    v_cvt_pk_bf16_f32 v28, v28, v28
    v_lshlrev_b32 v28, 16, v28
    v_mul_f32 v28, s62, v28
    v_max_f32 v12, v12, v28
    ds_write_b32 v13, v28 offset:448
    s_add_u32 s56, s56, 65536
    buffer_load_dwordx4 v[36:39], v2, s[32:35], s56 offen offset:0 nt
    s_waitcnt vmcnt(4)
    s_cbranch_vccnz L_w32
    s_waitcnt vmcnt(2)
L_w32:
    s_barrier
    v_dot2_f32_bf16 v22, v40, v8, 0
    v_dot2_f32_bf16 v22, v41, v9, v22
    v_dot2_f32_bf16 v22, v42, v10, v22
    v_dot2_f32_bf16 v22, v43, v11, v22
    buffer_load_dwordx4 v[40:43], v2, s[32:35], s56 offen offset:1024 nt
    s_waitcnt vmcnt(4)
    s_cbranch_vccnz L_w33
    s_waitcnt vmcnt(2)
L_w33:
    v_dot2_f32_bf16 v23, v44, v8, 0
    v_dot2_f32_bf16 v23, v45, v9, v23
    v_dot2_f32_bf16 v23, v46, v10, v23
    v_dot2_f32_bf16 v23, v47, v11, v23
    buffer_load_dwordx4 v[44:47], v2, s[32:35], s56 offen offset:2048 nt
    s_waitcnt vmcnt(4)
    s_cbranch_vccnz L_w34
    s_waitcnt vmcnt(2)
L_w34:
    v_dot2_f32_bf16 v24, v48, v8, 0
    v_dot2_f32_bf16 v24, v49, v9, v24
    v_dot2_f32_bf16 v24, v50, v10, v24
    v_dot2_f32_bf16 v24, v51, v11, v24
    buffer_load_dwordx4 v[48:51], v2, s[32:35], s56 offen offset:3072 nt
    s_waitcnt vmcnt(4)
    s_cbranch_vccnz L_w35
    s_waitcnt vmcnt(2)
L_w35:
    v_dot2_f32_bf16 v25, v32, v8, 0
    v_dot2_f32_bf16 v25, v33, v9, v25
    v_dot2_f32_bf16 v25, v34, v10, v25
    v_dot2_f32_bf16 v25, v35, v11, v25
    v_add_f32_dpp v26, v22, v22 row_ror:8 row_mask:0xf bank_mask:0x3
    v_add_f32_dpp v27, v24, v24 row_ror:8 row_mask:0xf bank_mask:0x3
    s_nop 0
    v_add_f32_dpp v26, v23, v23 row_ror:8 row_mask:0xf bank_mask:0xc
    v_add_f32_dpp v27, v25, v25 row_ror:8 row_mask:0xf bank_mask:0xc
    s_nop 0
    v_add_f32_dpp v28, v26, v26 row_half_mirror row_mask:0xf bank_mask:0x5
    s_nop 1
    v_add_f32_dpp v28, v27, v27 row_half_mirror row_mask:0xf bank_mask:0xa
    s_nop 1
    v_add_f32_dpp v28, v28, v28 quad_perm:[1,0,3,2] row_mask:0xf bank_mask:0xf
    s_nop 1
    v_add_f32_dpp v28, v28, v28 quad_perm:[2,3,0,1] row_mask:0xf bank_mask:0xf
    v_cvt_pk_bf16_f32 v28, v28, v28
    v_lshlrev_b32 v28, 16, v28
    v_mul_f32 v28, s61, v28
    v_cvt_pk_bf16_f32 v28, v28, v28
    v_lshlrev_b32 v28, 16, v28
    v_mul_f32 v28, s62, v28
    v_max_f32 v12, v12, v28
    ds_write_b32 v13, v28 offset:512
    s_add_u32 s56, s56, 65536
    buffer_load_dwordx4 v[32:35], v2, s[32:35], s56 offen offset:0 nt
    s_waitcnt vmcnt(4)
    s_cbranch_vccnz L_w36
    s_waitcnt vmcnt(2)
L_w36:
    s_barrier
    v_dot2_f32_bf16 v22, v36, v8, 0
    v_dot2_f32_bf16 v22, v37, v9, v22
    v_dot2_f32_bf16 v22, v38, v10, v22
    v_dot2_f32_bf16 v22, v39, v11, v22
    buffer_load_dwordx4 v[36:39], v2, s[32:35], s56 offen offset:1024 nt
    s_waitcnt vmcnt(4)
    s_cbranch_vccnz L_w37
    s_waitcnt vmcnt(2)
L_w37:
    v_dot2_f32_bf16 v23, v40, v8, 0
    v_dot2_f32_bf16 v23, v41, v9, v23
    v_dot2_f32_bf16 v23, v42, v10, v23
    v_dot2_f32_bf16 v23, v43, v11, v23
    buffer_load_dwordx4 v[40:43], v2, s[32:35], s56 offen offset:2048 nt
    s_waitcnt vmcnt(4)
    s_cbranch_vccnz L_w38
    s_waitcnt vmcnt(2)
L_w38:
    v_dot2_f32_bf16 v24, v44, v8, 0
    v_dot2_f32_bf16 v24, v45, v9, v24
    v_dot2_f32_bf16 v24, v46, v10, v24
    v_dot2_f32_bf16 v24, v47, v11, v24
    buffer_load_dwordx4 v[44:47], v2, s[32:35], s56 offen offset:3072 nt
    s_waitcnt vmcnt(4)
    s_cbranch_vccnz L_w39
    s_waitcnt vmcnt(2)
L_w39:
    v_dot2_f32_bf16 v25, v48, v8, 0
    v_dot2_f32_bf16 v25, v49, v9, v25
    v_dot2_f32_bf16 v25, v50, v10, v25
    v_dot2_f32_bf16 v25, v51, v11, v25
    v_add_f32_dpp v26, v22, v22 row_ror:8 row_mask:0xf bank_mask:0x3
    v_add_f32_dpp v27, v24, v24 row_ror:8 row_mask:0xf bank_mask:0x3
    s_nop 0
    v_add_f32_dpp v26, v23, v23 row_ror:8 row_mask:0xf bank_mask:0xc
    v_add_f32_dpp v27, v25, v25 row_ror:8 row_mask:0xf bank_mask:0xc
    s_nop 0
    v_add_f32_dpp v28, v26, v26 row_half_mirror row_mask:0xf bank_mask:0x5
    s_nop 1
    v_add_f32_dpp v28, v27, v27 row_half_mirror row_mask:0xf bank_mask:0xa
    s_nop 1
    v_add_f32_dpp v28, v28, v28 quad_perm:[1,0,3,2] row_mask:0xf bank_mask:0xf
    s_nop 1
    v_add_f32_dpp v28, v28, v28 quad_perm:[2,3,0,1] row_mask:0xf bank_mask:0xf
    v_cvt_pk_bf16_f32 v28, v28, v28
    v_lshlrev_b32 v28, 16, v28
    v_mul_f32 v28, s61, v28
    v_cvt_pk_bf16_f32 v28, v28, v28
    v_lshlrev_b32 v28, 16, v28
    v_mul_f32 v28, s62, v28
    v_max_f32 v12, v12, v28
    ds_write_b32 v13, v28 offset:576
    s_add_u32 s56, s56, 65536
    buffer_load_dwordx4 v[48:51], v2, s[32:35], s56 offen offset:0 nt
    s_waitcnt vmcnt(4)
    s_cbranch_vccnz L_w40
    s_waitcnt vmcnt(2)
L_w40:
    s_barrier
    v_dot2_f32_bf16 v22, v32, v8, 0
    v_dot2_f32_bf16 v22, v33, v9, v22
    v_dot2_f32_bf16 v22, v34, v10, v22
    v_dot2_f32_bf16 v22, v35, v11, v22
    buffer_load_dwordx4 v[32:35], v2, s[32:35], s56 offen offset:1024 nt
    s_waitcnt vmcnt(4)
    s_cbranch_vccnz L_w41
    s_waitcnt vmcnt(2)
L_w41:
    v_dot2_f32_bf16 v23, v36, v8, 0
    v_dot2_f32_bf16 v23, v37, v9, v23
    v_dot2_f32_bf16 v23, v38, v10, v23
    v_dot2_f32_bf16 v23, v39, v11, v23
    buffer_load_dwordx4 v[36:39], v2, s[32:35], s56 offen offset:2048 nt
    s_waitcnt vmcnt(4)
    s_cbranch_vccnz L_w42
    s_waitcnt vmcnt(2)
L_w42:
    v_dot2_f32_bf16 v24, v40, v8, 0
    v_dot2_f32_bf16 v24, v41, v9, v24
    v_dot2_f32_bf16 v24, v42, v10, v24
    v_dot2_f32_bf16 v24, v43, v11, v24
    buffer_load_dwordx4 v[40:43], v2, s[32:35], s56 offen offset:3072 nt
    s_waitcnt vmcnt(4)
    s_cbranch_vccnz L_w43
    s_waitcnt vmcnt(2)
L_w43:
    v_dot2_f32_bf16 v25, v44, v8, 0
    v_dot2_f32_bf16 v25, v45, v9, v25
    v_dot2_f32_bf16 v25, v46, v10, v25
    v_dot2_f32_bf16 v25, v47, v11, v25
    v_add_f32_dpp v26, v22, v22 row_ror:8 row_mask:0xf bank_mask:0x3
    v_add_f32_dpp v27, v24, v24 row_ror:8 row_mask:0xf bank_mask:0x3
    s_nop 0
    v_add_f32_dpp v26, v23, v23 row_ror:8 row_mask:0xf bank_mask:0xc
    v_add_f32_dpp v27, v25, v25 row_ror:8 row_mask:0xf bank_mask:0xc
    s_nop 0
    v_add_f32_dpp v28, v26, v26 row_half_mirror row_mask:0xf bank_mask:0x5
    s_nop 1
    v_add_f32_dpp v28, v27, v27 row_half_mirror row_mask:0xf bank_mask:0xa
    s_nop 1
    v_add_f32_dpp v28, v28, v28 quad_perm:[1,0,3,2] row_mask:0xf bank_mask:0xf
    s_nop 1
    v_add_f32_dpp v28, v28, v28 quad_perm:[2,3,0,1] row_mask:0xf bank_mask:0xf
    v_cvt_pk_bf16_f32 v28, v28, v28
    v_lshlrev_b32 v28, 16, v28
    v_mul_f32 v28, s61, v28
    v_cvt_pk_bf16_f32 v28, v28, v28
    v_lshlrev_b32 v28, 16, v28
    v_mul_f32 v28, s62, v28
    v_max_f32 v12, v12, v28
    ds_write_b32 v13, v28 offset:640
    s_add_u32 s56, s56, 65536
    buffer_load_dwordx4 v[44:47], v2, s[32:35], s56 offen offset:0 nt
    s_waitcnt vmcnt(4)
    s_cbranch_vccnz L_w44
    s_waitcnt vmcnt(2)
L_w44:
    s_barrier
    v_dot2_f32_bf16 v22, v48, v8, 0
    v_dot2_f32_bf16 v22, v49, v9, v22
    v_dot2_f32_bf16 v22, v50, v10, v22
    v_dot2_f32_bf16 v22, v51, v11, v22
    buffer_load_dwordx4 v[48:51], v2, s[32:35], s56 offen offset:1024 nt
    s_waitcnt vmcnt(4)
    s_cbranch_vccnz L_w45
    s_waitcnt vmcnt(2)
L_w45:
    v_dot2_f32_bf16 v23, v32, v8, 0
    v_dot2_f32_bf16 v23, v33, v9, v23
    v_dot2_f32_bf16 v23, v34, v10, v23
    v_dot2_f32_bf16 v23, v35, v11, v23
    buffer_load_dwordx4 v[32:35], v2, s[32:35], s56 offen offset:2048 nt
    s_waitcnt vmcnt(4)
    s_cbranch_vccnz L_w46
    s_waitcnt vmcnt(2)
L_w46:
    v_dot2_f32_bf16 v24, v36, v8, 0
    v_dot2_f32_bf16 v24, v37, v9, v24
    v_dot2_f32_bf16 v24, v38, v10, v24
    v_dot2_f32_bf16 v24, v39, v11, v24
    buffer_load_dwordx4 v[36:39], v2, s[32:35], s56 offen offset:3072 nt
    s_waitcnt vmcnt(4)
    s_cbranch_vccnz L_w47
    s_waitcnt vmcnt(2)
L_w47:
    v_dot2_f32_bf16 v25, v40, v8, 0
    v_dot2_f32_bf16 v25, v41, v9, v25
    v_dot2_f32_bf16 v25, v42, v10, v25
    v_dot2_f32_bf16 v25, v43, v11, v25
    v_add_f32_dpp v26, v22, v22 row_ror:8 row_mask:0xf bank_mask:0x3
    v_add_f32_dpp v27, v24, v24 row_ror:8 row_mask:0xf bank_mask:0x3
    s_nop 0
    v_add_f32_dpp v26, v23, v23 row_ror:8 row_mask:0xf bank_mask:0xc
    v_add_f32_dpp v27, v25, v25 row_ror:8 row_mask:0xf bank_mask:0xc
    s_nop 0
    v_add_f32_dpp v28, v26, v26 row_half_mirror row_mask:0xf bank_mask:0x5
    s_nop 1
    v_add_f32_dpp v28, v27, v27 row_half_mirror row_mask:0xf bank_mask:0xa
    s_nop 1
    v_add_f32_dpp v28, v28, v28 quad_perm:[1,0,3,2] row_mask:0xf bank_mask:0xf
    s_nop 1
    v_add_f32_dpp v28, v28, v28 quad_perm:[2,3,0,1] row_mask:0xf bank_mask:0xf
    v_cvt_pk_bf16_f32 v28, v28, v28
    v_lshlrev_b32 v28, 16, v28
    v_mul_f32 v28, s61, v28
    v_cvt_pk_bf16_f32 v28, v28, v28
    v_lshlrev_b32 v28, 16, v28
    v_mul_f32 v28, s62, v28
    v_max_f32 v12, v12, v28
    ds_write_b32 v13, v28 offset:704
    s_add_u32 s56, s56, 65536
    buffer_load_dwordx4 v[40:43], v2, s[32:35], s56 offen offset:0 nt
    s_waitcnt vmcnt(4)
    s_cbranch_vccnz L_w48
    s_waitcnt vmcnt(2)
L_w48:
    s_barrier
    ds_read_b32 v31, v29 offset:12568
    v_dot2_f32_bf16 v22, v44, v8, 0
    v_dot2_f32_bf16 v22, v45, v9, v22
    v_dot2_f32_bf16 v22, v46, v10, v22
    v_dot2_f32_bf16 v22, v47, v11, v22
    buffer_load_dwordx4 v[44:47], v2, s[32:35], s56 offen offset:1024 nt
    s_waitcnt vmcnt(4)
    s_cbranch_vccnz L_w49
    s_waitcnt vmcnt(2)
L_w49:
    v_dot2_f32_bf16 v23, v48, v8, 0
    v_dot2_f32_bf16 v23, v49, v9, v23
    v_dot2_f32_bf16 v23, v50, v10, v23
    v_dot2_f32_bf16 v23, v51, v11, v23
    buffer_load_dwordx4 v[48:51], v2, s[32:35], s56 offen offset:2048 nt
    s_waitcnt vmcnt(4)
    s_cbranch_vccnz L_w50
    s_waitcnt vmcnt(2)
L_w50:
    s_waitcnt lgkmcnt(0)
    v_readfirstlane_b32 s23, v31
    s_mov_b32 s22, -1
    s_cmp_lg_u32 s3, 0
    s_cbranch_scc1 L_m12
    s_cmp_eq_u32 s23, 0
    s_cbranch_scc1 L_m12
    s_mov_b32 s22, 1
    s_atomic_add s22, s[64:65], 0 glc
L_m12:
    v_dot2_f32_bf16 v24, v32, v8, 0
    v_dot2_f32_bf16 v24, v33, v9, v24
    v_dot2_f32_bf16 v24, v34, v10, v24
    v_dot2_f32_bf16 v24, v35, v11, v24
    buffer_load_dwordx4 v[32:35], v2, s[32:35], s56 offen offset:3072 nt
    s_waitcnt vmcnt(4)
    s_cbranch_vccnz L_w51
    s_waitcnt vmcnt(2)
L_w51:
    v_dot2_f32_bf16 v25, v36, v8, 0
    v_dot2_f32_bf16 v25, v37, v9, v25
    v_dot2_f32_bf16 v25, v38, v10, v25
    v_dot2_f32_bf16 v25, v39, v11, v25
    v_add_f32_dpp v26, v22, v22 row_ror:8 row_mask:0xf bank_mask:0x3
    v_add_f32_dpp v27, v24, v24 row_ror:8 row_mask:0xf bank_mask:0x3
    s_nop 0
    v_add_f32_dpp v26, v23, v23 row_ror:8 row_mask:0xf bank_mask:0xc
    v_add_f32_dpp v27, v25, v25 row_ror:8 row_mask:0xf bank_mask:0xc
    s_nop 0
    v_add_f32_dpp v28, v26, v26 row_half_mirror row_mask:0xf bank_mask:0x5
    s_nop 1
    v_add_f32_dpp v28, v27, v27 row_half_mirror row_mask:0xf bank_mask:0xa
    s_nop 1
    v_add_f32_dpp v28, v28, v28 quad_perm:[1,0,3,2] row_mask:0xf bank_mask:0xf
    s_nop 1
    v_add_f32_dpp v28, v28, v28 quad_perm:[2,3,0,1] row_mask:0xf bank_mask:0xf
    v_cvt_pk_bf16_f32 v28, v28, v28
    v_lshlrev_b32 v28, 16, v28
    v_mul_f32 v28, s61, v28
    v_cvt_pk_bf16_f32 v28, v28, v28
    v_lshlrev_b32 v28, 16, v28
    v_mul_f32 v28, s62, v28
    v_max_f32 v12, v12, v28
    ds_write_b32 v13, v28 offset:768
    s_add_u32 s56, s56, 65536
    buffer_load_dwordx4 v[36:39], v2, s[32:35], s56 offen offset:0 nt
    s_waitcnt vmcnt(4)
    s_cbranch_vccnz L_w52
    s_waitcnt vmcnt(2)
L_w52:
    s_barrier
    v_dot2_f32_bf16 v22, v40, v8, 0
    v_dot2_f32_bf16 v22, v41, v9, v22
    v_dot2_f32_bf16 v22, v42, v10, v22
    v_dot2_f32_bf16 v22, v43, v11, v22
    buffer_load_dwordx4 v[40:43], v2, s[32:35], s56 offen offset:1024 nt
    s_waitcnt vmcnt(4)
    s_cbranch_vccnz L_w53
    s_waitcnt vmcnt(2)
L_w53:
    v_dot2_f32_bf16 v23, v44, v8, 0
    v_dot2_f32_bf16 v23, v45, v9, v23
    v_dot2_f32_bf16 v23, v46, v10, v23
    v_dot2_f32_bf16 v23, v47, v11, v23
    buffer_load_dwordx4 v[44:47], v2, s[32:35], s56 offen offset:2048 nt
    s_waitcnt vmcnt(4)
    s_cbranch_vccnz L_w54
    s_waitcnt vmcnt(2)
L_w54:
    v_dot2_f32_bf16 v24, v48, v8, 0
    v_dot2_f32_bf16 v24, v49, v9, v24
    v_dot2_f32_bf16 v24, v50, v10, v24
    v_dot2_f32_bf16 v24, v51, v11, v24
    buffer_load_dwordx4 v[48:51], v2, s[32:35], s56 offen offset:3072 nt
    s_waitcnt vmcnt(4)
    s_cbranch_vccnz L_w55
    s_waitcnt vmcnt(2)
L_w55:
    v_dot2_f32_bf16 v25, v32, v8, 0
    v_dot2_f32_bf16 v25, v33, v9, v25
    v_dot2_f32_bf16 v25, v34, v10, v25
    v_dot2_f32_bf16 v25, v35, v11, v25
    v_add_f32_dpp v26, v22, v22 row_ror:8 row_mask:0xf bank_mask:0x3
    v_add_f32_dpp v27, v24, v24 row_ror:8 row_mask:0xf bank_mask:0x3
    s_nop 0
    v_add_f32_dpp v26, v23, v23 row_ror:8 row_mask:0xf bank_mask:0xc
    v_add_f32_dpp v27, v25, v25 row_ror:8 row_mask:0xf bank_mask:0xc
    s_nop 0
    v_add_f32_dpp v28, v26, v26 row_half_mirror row_mask:0xf bank_mask:0x5
    s_nop 1
    v_add_f32_dpp v28, v27, v27 row_half_mirror row_mask:0xf bank_mask:0xa
    s_nop 1
    v_add_f32_dpp v28, v28, v28 quad_perm:[1,0,3,2] row_mask:0xf bank_mask:0xf
    s_nop 1
    v_add_f32_dpp v28, v28, v28 quad_perm:[2,3,0,1] row_mask:0xf bank_mask:0xf
    v_cvt_pk_bf16_f32 v28, v28, v28
    v_lshlrev_b32 v28, 16, v28
    v_mul_f32 v28, s61, v28
    v_cvt_pk_bf16_f32 v28, v28, v28
    v_lshlrev_b32 v28, 16, v28
    v_mul_f32 v28, s62, v28
    v_max_f32 v12, v12, v28
    ds_write_b32 v13, v28 offset:832
    s_add_u32 s56, s56, 65536
    buffer_load_dwordx4 v[32:35], v2, s[32:35], s56 offen offset:0 nt
    s_waitcnt lgkmcnt(0)
    s_cmp_lg_u32 s3, 0
    s_cbranch_scc1 L_h14
    s_add_u32 s22, s22, 1
    s_min_u32 s22, s22, 15
    s_lshl_b32 s22, s22, 2
    s_mov_b32 s24, 0xabcd
    s_mov_b32 s25, 0x75310000
    s_lshr_b64 s[24:25], s[24:25], s22
    s_and_b32 s22, s24, 15
    v_mov_b32 v31, s22
    ds_write_b32 v29, v31 offset:12564
L_h14:
    s_waitcnt vmcnt(4)
    s_cbranch_vccnz L_w56
    s_waitcnt vmcnt(2)
L_w56:
    s_barrier
    v_dot2_f32_bf16 v22, v36, v8, 0
    v_dot2_f32_bf16 v22, v37, v9, v22
    v_dot2_f32_bf16 v22, v38, v10, v22
    v_dot2_f32_bf16 v22, v39, v11, v22
    buffer_load_dwordx4 v[36:39], v2, s[32:35], s56 offen offset:1024 nt
    s_waitcnt vmcnt(4)
    s_cbranch_vccnz L_w57
    s_waitcnt vmcnt(2)
L_w57:
    v_dot2_f32_bf16 v23, v40, v8, 0
    v_dot2_f32_bf16 v23, v41, v9, v23
    v_dot2_f32_bf16 v23, v42, v10, v23
    v_dot2_f32_bf16 v23, v43, v11, v23
    buffer_load_dwordx4 v[40:43], v2, s[32:35], s56 offen offset:2048 nt
    s_waitcnt vmcnt(4)
    s_cbranch_vccnz L_w58
    s_waitcnt vmcnt(2)
L_w58:
    v_dot2_f32_bf16 v24, v44, v8, 0
    v_dot2_f32_bf16 v24, v45, v9, v24
    v_dot2_f32_bf16 v24, v46, v10, v24
    v_dot2_f32_bf16 v24, v47, v11, v24
    buffer_load_dwordx4 v[44:47], v2, s[32:35], s56 offen offset:3072 nt
    s_waitcnt vmcnt(4)
    s_cbranch_vccnz L_w59
    s_waitcnt vmcnt(2)
L_w59:
    v_dot2_f32_bf16 v25, v48, v8, 0
    v_dot2_f32_bf16 v25, v49, v9, v25
    v_dot2_f32_bf16 v25, v50, v10, v25
    v_dot2_f32_bf16 v25, v51, v11, v25
    v_add_f32_dpp v26, v22, v22 row_ror:8 row_mask:0xf bank_mask:0x3
    v_add_f32_dpp v27, v24, v24 row_ror:8 row_mask:0xf bank_mask:0x3
    s_nop 0
    v_add_f32_dpp v26, v23, v23 row_ror:8 row_mask:0xf bank_mask:0xc
    v_add_f32_dpp v27, v25, v25 row_ror:8 row_mask:0xf bank_mask:0xc
    s_nop 0
    v_add_f32_dpp v28, v26, v26 row_half_mirror row_mask:0xf bank_mask:0x5
    s_nop 1
    v_add_f32_dpp v28, v27, v27 row_half_mirror row_mask:0xf bank_mask:0xa
    s_nop 1
    v_add_f32_dpp v28, v28, v28 quad_perm:[1,0,3,2] row_mask:0xf bank_mask:0xf
    s_nop 1
    v_add_f32_dpp v28, v28, v28 quad_perm:[2,3,0,1] row_mask:0xf bank_mask:0xf
    v_cvt_pk_bf16_f32 v28, v28, v28
    v_lshlrev_b32 v28, 16, v28
    v_mul_f32 v28, s61, v28
    v_cvt_pk_bf16_f32 v28, v28, v28
    v_lshlrev_b32 v28, 16, v28
    v_mul_f32 v28, s62, v28
    v_max_f32 v12, v12, v28
    ds_write_b32 v13, v28 offset:896
    s_add_u32 s56, s56, 65536
    buffer_load_dwordx4 v[48:51], v2, s[32:35], s56 offen offset:0 nt
    s_waitcnt lgkmcnt(0)
    s_waitcnt vmcnt(4)
    s_cbranch_vccnz L_w60
    s_waitcnt vmcnt(2)
L_w60:
    s_barrier
    ds_read_b32 v31, v29 offset:12564
    v_dot2_f32_bf16 v22, v32, v8, 0
    v_dot2_f32_bf16 v22, v33, v9, v22
    v_dot2_f32_bf16 v22, v34, v10, v22
    v_dot2_f32_bf16 v22, v35, v11, v22
    buffer_load_dwordx4 v[32:35], v2, s[32:35], s56 offen offset:1024 nt
    s_waitcnt vmcnt(4)
    s_cbranch_vccnz L_w61
    s_waitcnt vmcnt(2)
L_w61:
    v_dot2_f32_bf16 v23, v36, v8, 0
    v_dot2_f32_bf16 v23, v37, v9, v23
    v_dot2_f32_bf16 v23, v38, v10, v23
    v_dot2_f32_bf16 v23, v39, v11, v23
    buffer_load_dwordx4 v[36:39], v2, s[32:35], s56 offen offset:2048 nt
    s_waitcnt vmcnt(4)
    s_cbranch_vccnz L_w62
    s_waitcnt vmcnt(2)
L_w62:
    v_dot2_f32_bf16 v24, v40, v8, 0
    v_dot2_f32_bf16 v24, v41, v9, v24
    v_dot2_f32_bf16 v24, v42, v10, v24
    v_dot2_f32_bf16 v24, v43, v11, v24
    buffer_load_dwordx4 v[40:43], v2, s[32:35], s56 offen offset:3072 nt
    s_waitcnt vmcnt(4)
    s_cbranch_vccnz L_w63
    s_waitcnt vmcnt(2)
L_w63:
    v_dot2_f32_bf16 v25, v44, v8, 0
    v_dot2_f32_bf16 v25, v45, v9, v25
    v_dot2_f32_bf16 v25, v46, v10, v25
    v_dot2_f32_bf16 v25, v47, v11, v25
    v_add_f32_dpp v26, v22, v22 row_ror:8 row_mask:0xf bank_mask:0x3
    v_add_f32_dpp v27, v24, v24 row_ror:8 row_mask:0xf bank_mask:0x3
    s_nop 0
    v_add_f32_dpp v26, v23, v23 row_ror:8 row_mask:0xf bank_mask:0xc
    v_add_f32_dpp v27, v25, v25 row_ror:8 row_mask:0xf bank_mask:0xc
    s_nop 0
    v_add_f32_dpp v28, v26, v26 row_half_mirror row_mask:0xf bank_mask:0x5
    s_nop 1
    v_add_f32_dpp v28, v27, v27 row_half_mirror row_mask:0xf bank_mask:0xa
    s_nop 1
    v_add_f32_dpp v28, v28, v28 quad_perm:[1,0,3,2] row_mask:0xf bank_mask:0xf
    s_nop 1
    v_add_f32_dpp v28, v28, v28 quad_perm:[2,3,0,1] row_mask:0xf bank_mask:0xf
    v_cvt_pk_bf16_f32 v28, v28, v28
    v_lshlrev_b32 v28, 16, v28
    v_mul_f32 v28, s61, v28
    v_cvt_pk_bf16_f32 v28, v28, v28
    v_lshlrev_b32 v28, 16, v28
    v_mul_f32 v28, s62, v28
    v_max_f32 v12, v12, v28
    ds_write_b32 v13, v28 offset:960
    s_add_u32 s56, s56, 65536
    buffer_load_dwordx4 v[44:47], v2, s[32:35], s56 offen offset:0 nt
    s_waitcnt lgkmcnt(0)
    v_readfirstlane_b32 s16, v31
    s_sub_u32 s21, s16, 8
    s_cselect_b32 s21, 0, s21
    s_cselect_b32 s16, s16, 0
    s_cmp_lg_u32 s16, 0
    s_cselect_b64 vcc, -1, 0
    s_subb_u32 s16, s16, 0
    s_waitcnt vmcnt(4)
    s_cbranch_vccnz L_w64
    s_waitcnt vmcnt(2)
L_w64:
    s_cmp_eq_u32 s21, 0
    s_cbranch_scc1 L_w65
    s_waitcnt vmcnt(1)
    s_sub_u32 s21, s21, 1
L_w65:
    s_barrier
    v_dot2_f32_bf16 v22, v48, v8, 0
    v_dot2_f32_bf16 v22, v49, v9, v22
    v_dot2_f32_bf16 v22, v50, v10, v22
    v_dot2_f32_bf16 v22, v51, v11, v22
    buffer_load_dwordx4 v[48:51], v2, s[32:35], s56 offen offset:1024 nt
    s_waitcnt vmcnt(4)
    s_cbranch_vccnz L_w66
    s_waitcnt vmcnt(2)
L_w66:
    v_dot2_f32_bf16 v23, v32, v8, 0
    v_dot2_f32_bf16 v23, v33, v9, v23
    v_dot2_f32_bf16 v23, v34, v10, v23
    v_dot2_f32_bf16 v23, v35, v11, v23
    buffer_load_dwordx4 v[32:35], v2, s[32:35], s56 offen offset:2048 nt
    s_waitcnt vmcnt(4)
    s_cbranch_vccnz L_w67
    s_waitcnt vmcnt(2)
L_w67:
    v_dot2_f32_bf16 v24, v36, v8, 0
    v_dot2_f32_bf16 v24, v37, v9, v24
    v_dot2_f32_bf16 v24, v38, v10, v24
    v_dot2_f32_bf16 v24, v39, v11, v24
    buffer_load_dwordx4 v[36:39], v2, s[32:35], s56 offen offset:3072 nt
    s_waitcnt vmcnt(4)
    s_cbranch_vccnz L_w68
    s_waitcnt vmcnt(2)
L_w68:
    v_dot2_f32_bf16 v25, v40, v8, 0
    v_dot2_f32_bf16 v25, v41, v9, v25
    v_dot2_f32_bf16 v25, v42, v10, v25
    v_dot2_f32_bf16 v25, v43, v11, v25
    v_add_f32_dpp v26, v22, v22 row_ror:8 row_mask:0xf bank_mask:0x3
    v_add_f32_dpp v27, v24, v24 row_ror:8 row_mask:0xf bank_mask:0x3
    s_nop 0
    v_add_f32_dpp v26, v23, v23 row_ror:8 row_mask:0xf bank_mask:0xc
    v_add_f32_dpp v27, v25, v25 row_ror:8 row_mask:0xf bank_mask:0xc
    s_nop 0
    v_add_f32_dpp v28, v26, v26 row_half_mirror row_mask:0xf bank_mask:0x5
    s_nop 1
    v_add_f32_dpp v28, v27, v27 row_half_mirror row_mask:0xf bank_mask:0xa
    s_nop 1
    v_add_f32_dpp v28, v28, v28 quad_perm:[1,0,3,2] row_mask:0xf bank_mask:0xf
    s_nop 1
    v_add_f32_dpp v28, v28, v28 quad_perm:[2,3,0,1] row_mask:0xf bank_mask:0xf
    v_cvt_pk_bf16_f32 v28, v28, v28
    v_lshlrev_b32 v28, 16, v28
    v_mul_f32 v28, s61, v28
    v_cvt_pk_bf16_f32 v28, v28, v28
    v_lshlrev_b32 v28, 16, v28
    v_mul_f32 v28, s62, v28
    v_max_f32 v12, v12, v28
    ds_write_b32 v13, v28 offset:1024
    s_add_u32 s56, s56, 65536
    buffer_load_dwordx4 v[40:43], v2, s[32:35], s56 offen offset:0 nt
    s_cmp_lg_u32 s16, 0
    s_cselect_b64 vcc, -1, 0
    s_subb_u32 s16, s16, 0
    s_waitcnt vmcnt(4)
    s_cbranch_vccnz L_w69
    s_waitcnt vmcnt(2)
L_w69:
    s_cmp_eq_u32 s21, 0
    s_cbranch_scc1 L_w70
    s_waitcnt vmcnt(1)
    s_sub_u32 s21, s21, 1
L_w70:
    s_barrier
    ds_read_b32 v31, v29 offset:12568
    v_dot2_f32_bf16 v22, v44, v8, 0
    v_dot2_f32_bf16 v22, v45, v9, v22
    v_dot2_f32_bf16 v22, v46, v10, v22
    v_dot2_f32_bf16 v22, v47, v11, v22
    buffer_load_dwordx4 v[44:47], v2, s[32:35], s56 offen offset:1024 nt
    s_waitcnt vmcnt(4)
    s_cbranch_vccnz L_w71
    s_waitcnt vmcnt(2)
L_w71:
    v_dot2_f32_bf16 v23, v48, v8, 0
    v_dot2_f32_bf16 v23, v49, v9, v23
    v_dot2_f32_bf16 v23, v50, v10, v23
    v_dot2_f32_bf16 v23, v51, v11, v23
    buffer_load_dwordx4 v[48:51], v2, s[32:35], s56 offen offset:2048 nt
    s_waitcnt vmcnt(4)
    s_cbranch_vccnz L_w72
    s_waitcnt vmcnt(2)
L_w72:
    s_waitcnt lgkmcnt(0)
    v_readfirstlane_b32 s23, v31
    s_mov_b32 s22, -1
    s_cmp_lg_u32 s3, 0
    s_cbranch_scc1 L_m17
    s_cmp_eq_u32 s23, 0
    s_cbranch_scc1 L_m17
    s_mov_b32 s22, 1
    s_atomic_add s22, s[64:65], 4096 glc
L_m17:
    v_dot2_f32_bf16 v24, v32, v8, 0
    v_dot2_f32_bf16 v24, v33, v9, v24
    v_dot2_f32_bf16 v24, v34, v10, v24
    v_dot2_f32_bf16 v24, v35, v11, v24
    buffer_load_dwordx4 v[32:35], v2, s[32:35], s56 offen offset:3072 nt
    s_waitcnt vmcnt(4)
    s_cbranch_vccnz L_w73
    s_waitcnt vmcnt(2)
L_w73:
    v_dot2_f32_bf16 v25, v36, v8, 0
    v_dot2_f32_bf16 v25, v37, v9, v25
    v_dot2_f32_bf16 v25, v38, v10, v25
    v_dot2_f32_bf16 v25, v39, v11, v25
    v_add_f32_dpp v26, v22, v22 row_ror:8 row_mask:0xf bank_mask:0x3
    v_add_f32_dpp v27, v24, v24 row_ror:8 row_mask:0xf bank_mask:0x3
    s_nop 0
    v_add_f32_dpp v26, v23, v23 row_ror:8 row_mask:0xf bank_mask:0xc
    v_add_f32_dpp v27, v25, v25 row_ror:8 row_mask:0xf bank_mask:0xc
    s_nop 0
    v_add_f32_dpp v28, v26, v26 row_half_mirror row_mask:0xf bank_mask:0x5
    s_nop 1
    v_add_f32_dpp v28, v27, v27 row_half_mirror row_mask:0xf bank_mask:0xa
    s_nop 1
    v_add_f32_dpp v28, v28, v28 quad_perm:[1,0,3,2] row_mask:0xf bank_mask:0xf
    s_nop 1
    v_add_f32_dpp v28, v28, v28 quad_perm:[2,3,0,1] row_mask:0xf bank_mask:0xf
    v_cvt_pk_bf16_f32 v28, v28, v28
    v_lshlrev_b32 v28, 16, v28
    v_mul_f32 v28, s61, v28
    v_cvt_pk_bf16_f32 v28, v28, v28
    v_lshlrev_b32 v28, 16, v28
    v_mul_f32 v28, s62, v28
    v_max_f32 v12, v12, v28
    ds_write_b32 v13, v28 offset:1088
    s_add_u32 s56, s56, 65536
    buffer_load_dwordx4 v[36:39], v2, s[32:35], s56 offen offset:0 nt
    s_cmp_lg_u32 s16, 0
    s_cselect_b64 vcc, -1, 0
    s_subb_u32 s16, s16, 0
    s_waitcnt vmcnt(4)
    s_cbranch_vccnz L_w74
    s_waitcnt vmcnt(2)
L_w74:
    s_cmp_eq_u32 s21, 0
    s_cbranch_scc1 L_w75
    s_waitcnt vmcnt(1)
    s_sub_u32 s21, s21, 1
L_w75:
    s_barrier
    v_dot2_f32_bf16 v22, v40, v8, 0
    v_dot2_f32_bf16 v22, v41, v9, v22
    v_dot2_f32_bf16 v22, v42, v10, v22
    v_dot2_f32_bf16 v22, v43, v11, v22
    buffer_load_dwordx4 v[40:43], v2, s[32:35], s56 offen offset:1024 nt
    s_waitcnt vmcnt(4)
    s_cbranch_vccnz L_w76
    s_waitcnt vmcnt(2)
L_w76:
    v_dot2_f32_bf16 v23, v44, v8, 0
    v_dot2_f32_bf16 v23, v45, v9, v23
    v_dot2_f32_bf16 v23, v46, v10, v23
    v_dot2_f32_bf16 v23, v47, v11, v23
    buffer_load_dwordx4 v[44:47], v2, s[32:35], s56 offen offset:2048 nt
    s_waitcnt vmcnt(4)
    s_cbranch_vccnz L_w77
    s_waitcnt vmcnt(2)
L_w77:
    v_dot2_f32_bf16 v24, v48, v8, 0
    v_dot2_f32_bf16 v24, v49, v9, v24
    v_dot2_f32_bf16 v24, v50, v10, v24
    v_dot2_f32_bf16 v24, v51, v11, v24
    buffer_load_dwordx4 v[48:51], v2, s[32:35], s56 offen offset:3072 nt
    s_waitcnt vmcnt(4)
    s_cbranch_vccnz L_w78
    s_waitcnt vmcnt(2)
L_w78:
    v_dot2_f32_bf16 v25, v32, v8, 0
    v_dot2_f32_bf16 v25, v33, v9, v25
    v_dot2_f32_bf16 v25, v34, v10, v25
    v_dot2_f32_bf16 v25, v35, v11, v25
    v_add_f32_dpp v26, v22, v22 row_ror:8 row_mask:0xf bank_mask:0x3
    v_add_f32_dpp v27, v24, v24 row_ror:8 row_mask:0xf bank_mask:0x3
    s_nop 0
    v_add_f32_dpp v26, v23, v23 row_ror:8 row_mask:0xf bank_mask:0xc
    v_add_f32_dpp v27, v25, v25 row_ror:8 row_mask:0xf bank_mask:0xc
    s_nop 0
    v_add_f32_dpp v28, v26, v26 row_half_mirror row_mask:0xf bank_mask:0x5
    s_nop 1
    v_add_f32_dpp v28, v27, v27 row_half_mirror row_mask:0xf bank_mask:0xa
    s_nop 1
    v_add_f32_dpp v28, v28, v28 quad_perm:[1,0,3,2] row_mask:0xf bank_mask:0xf
    s_nop 1
    v_add_f32_dpp v28, v28, v28 quad_perm:[2,3,0,1] row_mask:0xf bank_mask:0xf
    v_cvt_pk_bf16_f32 v28, v28, v28
    v_lshlrev_b32 v28, 16, v28
    v_mul_f32 v28, s61, v28
    v_cvt_pk_bf16_f32 v28, v28, v28
    v_lshlrev_b32 v28, 16, v28
    v_mul_f32 v28, s62, v28
    v_max_f32 v12, v12, v28
    ds_write_b32 v13, v28 offset:1152
    s_add_u32 s56, s56, 65536
    buffer_load_dwordx4 v[32:35], v2, s[32:35], s56 offen offset:0 nt
    s_waitcnt lgkmcnt(0)
    s_cmp_lg_u32 s3, 0
    s_cbranch_scc1 L_h19
    s_add_u32 s22, s22, 1
    s_min_u32 s22, s22, 15
    s_lshl_b32 s22, s22, 2
    s_mov_b32 s24, 0xabcd
    s_mov_b32 s25, 0x75310000
    s_lshr_b64 s[24:25], s[24:25], s22
    s_and_b32 s22, s24, 15
    v_mov_b32 v31, s22
    ds_write_b32 v29, v31 offset:12564
L_h19:
    s_cmp_lg_u32 s16, 0
    s_cselect_b64 vcc, -1, 0
    s_subb_u32 s16, s16, 0
    s_waitcnt vmcnt(4)
    s_cbranch_vccnz L_w79
    s_waitcnt vmcnt(2)
L_w79:
    s_cmp_eq_u32 s21, 0
    s_cbranch_scc1 L_w80
    s_waitcnt vmcnt(1)
    s_sub_u32 s21, s21, 1
L_w80:
    s_barrier
    v_dot2_f32_bf16 v22, v36, v8, 0
    v_dot2_f32_bf16 v22, v37, v9, v22
    v_dot2_f32_bf16 v22, v38, v10, v22
    v_dot2_f32_bf16 v22, v39, v11, v22
    buffer_load_dwordx4 v[36:39], v2, s[32:35], s56 offen offset:1024 nt
    s_waitcnt vmcnt(4)
    s_cbranch_vccnz L_w81
    s_waitcnt vmcnt(2)
L_w81:
    v_dot2_f32_bf16 v23, v40, v8, 0
    v_dot2_f32_bf16 v23, v41, v9, v23
    v_dot2_f32_bf16 v23, v42, v10, v23
    v_dot2_f32_bf16 v23, v43, v11, v23
    buffer_load_dwordx4 v[40:43], v2, s[32:35], s56 offen offset:2048 nt
    s_waitcnt vmcnt(4)
    s_cbranch_vccnz L_w82
    s_waitcnt vmcnt(2)
L_w82:
    v_dot2_f32_bf16 v24, v44, v8, 0
    v_dot2_f32_bf16 v24, v45, v9, v24
    v_dot2_f32_bf16 v24, v46, v10, v24
    v_dot2_f32_bf16 v24, v47, v11, v24
    buffer_load_dwordx4 v[44:47], v2, s[32:35], s56 offen offset:3072 nt
    s_waitcnt vmcnt(4)
    s_cbranch_vccnz L_w83
    s_waitcnt vmcnt(2)
L_w83:
    v_dot2_f32_bf16 v25, v48, v8, 0
    v_dot2_f32_bf16 v25, v49, v9, v25
    v_dot2_f32_bf16 v25, v50, v10, v25
    v_dot2_f32_bf16 v25, v51, v11, v25
    v_add_f32_dpp v26, v22, v22 row_ror:8 row_mask:0xf bank_mask:0x3
    v_add_f32_dpp v27, v24, v24 row_ror:8 row_mask:0xf bank_mask:0x3
    s_nop 0
    v_add_f32_dpp v26, v23, v23 row_ror:8 row_mask:0xf bank_mask:0xc
    v_add_f32_dpp v27, v25, v25 row_ror:8 row_mask:0xf bank_mask:0xc
    s_nop 0
    v_add_f32_dpp v28, v26, v26 row_half_mirror row_mask:0xf bank_mask:0x5
    s_nop 1
    v_add_f32_dpp v28, v27, v27 row_half_mirror row_mask:0xf bank_mask:0xa
    s_nop 1
    v_add_f32_dpp v28, v28, v28 quad_perm:[1,0,3,2] row_mask:0xf bank_mask:0xf
    s_nop 1
    v_add_f32_dpp v28, v28, v28 quad_perm:[2,3,0,1] row_mask:0xf bank_mask:0xf
    v_cvt_pk_bf16_f32 v28, v28, v28
    v_lshlrev_b32 v28, 16, v28
    v_mul_f32 v28, s61, v28
    v_cvt_pk_bf16_f32 v28, v28, v28
    v_lshlrev_b32 v28, 16, v28
    v_mul_f32 v28, s62, v28
    v_max_f32 v12, v12, v28
    ds_write_b32 v13, v28 offset:1216
    s_add_u32 s56, s56, 65536
    buffer_load_dwordx4 v[48:51], v2, s[32:35], s56 offen offset:0 nt
    s_waitcnt lgkmcnt(0)
    s_cmp_lg_u32 s16, 0
    s_cselect_b64 vcc, -1, 0
    s_subb_u32 s16, s16, 0
    s_waitcnt vmcnt(4)
    s_cbranch_vccnz L_w84
    s_waitcnt vmcnt(2)
L_w84:
    s_cmp_eq_u32 s21, 0
    s_cbranch_scc1 L_w85
    s_waitcnt vmcnt(1)
    s_sub_u32 s21, s21, 1
L_w85:
    s_barrier
    ds_read_b32 v31, v29 offset:12564
    v_dot2_f32_bf16 v22, v32, v8, 0
    v_dot2_f32_bf16 v22, v33, v9, v22
    v_dot2_f32_bf16 v22, v34, v10, v22
    v_dot2_f32_bf16 v22, v35, v11, v22
    buffer_load_dwordx4 v[32:35], v2, s[32:35], s56 offen offset:1024 nt
    s_waitcnt vmcnt(4)
    s_cbranch_vccnz L_w86
    s_waitcnt vmcnt(2)
L_w86:
    v_dot2_f32_bf16 v23, v36, v8, 0
    v_dot2_f32_bf16 v23, v37, v9, v23
    v_dot2_f32_bf16 v23, v38, v10, v23
    v_dot2_f32_bf16 v23, v39, v11, v23
    buffer_load_dwordx4 v[36:39], v2, s[32:35], s56 offen offset:2048 nt
    s_waitcnt vmcnt(4)
    s_cbranch_vccnz L_w87
    s_waitcnt vmcnt(2)
L_w87:
    v_dot2_f32_bf16 v24, v40, v8, 0
    v_dot2_f32_bf16 v24, v41, v9, v24
    v_dot2_f32_bf16 v24, v42, v10, v24
    v_dot2_f32_bf16 v24, v43, v11, v24
    buffer_load_dwordx4 v[40:43], v2, s[32:35], s56 offen offset:3072 nt
    s_waitcnt vmcnt(4)
    s_cbranch_vccnz L_w88
    s_waitcnt vmcnt(2)
L_w88:
    v_dot2_f32_bf16 v25, v44, v8, 0
    v_dot2_f32_bf16 v25, v45, v9, v25
    v_dot2_f32_bf16 v25, v46, v10, v25
    v_dot2_f32_bf16 v25, v47, v11, v25
    v_add_f32_dpp v26, v22, v22 row_ror:8 row_mask:0xf bank_mask:0x3
    v_add_f32_dpp v27, v24, v24 row_ror:8 row_mask:0xf bank_mask:0x3
    s_nop 0
    v_add_f32_dpp v26, v23, v23 row_ror:8 row_mask:0xf bank_mask:0xc
    v_add_f32_dpp v27, v25, v25 row_ror:8 row_mask:0xf bank_mask:0xc
    s_nop 0
    v_add_f32_dpp v28, v26, v26 row_half_mirror row_mask:0xf bank_mask:0x5
    s_nop 1
    v_add_f32_dpp v28, v27, v27 row_half_mirror row_mask:0xf bank_mask:0xa
    s_nop 1
    v_add_f32_dpp v28, v28, v28 quad_perm:[1,0,3,2] row_mask:0xf bank_mask:0xf
    s_nop 1
    v_add_f32_dpp v28, v28, v28 quad_perm:[2,3,0,1] row_mask:0xf bank_mask:0xf
    v_cvt_pk_bf16_f32 v28, v28, v28
    v_lshlrev_b32 v28, 16, v28
    v_mul_f32 v28, s61, v28
    v_cvt_pk_bf16_f32 v28, v28, v28
    v_lshlrev_b32 v28, 16, v28
    v_mul_f32 v28, s62, v28
    v_max_f32 v12, v12, v28
    ds_write_b32 v13, v28 offset:1280
    s_add_u32 s56, s56, 65536
    buffer_load_dwordx4 v[44:47], v2, s[32:35], s56 offen offset:0 nt
    s_waitcnt lgkmcnt(0)
    v_readfirstlane_b32 s16, v31
    s_sub_u32 s21, s16, 8
    s_cselect_b32 s21, 0, s21
    s_cselect_b32 s16, s16, 0
    s_cmp_lg_u32 s16, 0
    s_cselect_b64 vcc, -1, 0
    s_subb_u32 s16, s16, 0
    s_waitcnt vmcnt(4)
    s_cbranch_vccnz L_w89
    s_waitcnt vmcnt(2)
L_w89:
    s_cmp_eq_u32 s21, 0
    s_cbranch_scc1 L_w90
    s_waitcnt vmcnt(1)
    s_sub_u32 s21, s21, 1
L_w90:
    s_barrier
    v_dot2_f32_bf16 v22, v48, v8, 0
    v_dot2_f32_bf16 v22, v49, v9, v22
    v_dot2_f32_bf16 v22, v50, v10, v22
    v_dot2_f32_bf16 v22, v51, v11, v22
    buffer_load_dwordx4 v[48:51], v2, s[32:35], s56 offen offset:1024 nt
    s_waitcnt vmcnt(4)
    s_cbranch_vccnz L_w91
    s_waitcnt vmcnt(2)
L_w91:
    v_dot2_f32_bf16 v23, v32, v8, 0
    v_dot2_f32_bf16 v23, v33, v9, v23
    v_dot2_f32_bf16 v23, v34, v10, v23
    v_dot2_f32_bf16 v23, v35, v11, v23
    buffer_load_dwordx4 v[32:35], v2, s[32:35], s56 offen offset:2048 nt
    s_waitcnt vmcnt(4)
    s_cbranch_vccnz L_w92
    s_waitcnt vmcnt(2)
L_w92:
    v_dot2_f32_bf16 v24, v36, v8, 0
    v_dot2_f32_bf16 v24, v37, v9, v24
    v_dot2_f32_bf16 v24, v38, v10, v24
    v_dot2_f32_bf16 v24, v39, v11, v24
    buffer_load_dwordx4 v[36:39], v2, s[32:35], s56 offen offset:3072 nt
    s_waitcnt vmcnt(4)
    s_cbranch_vccnz L_w93
    s_waitcnt vmcnt(2)
L_w93:
    v_dot2_f32_bf16 v25, v40, v8, 0
    v_dot2_f32_bf16 v25, v41, v9, v25
    v_dot2_f32_bf16 v25, v42, v10, v25
    v_dot2_f32_bf16 v25, v43, v11, v25
    v_add_f32_dpp v26, v22, v22 row_ror:8 row_mask:0xf bank_mask:0x3
    v_add_f32_dpp v27, v24, v24 row_ror:8 row_mask:0xf bank_mask:0x3
    s_nop 0
    v_add_f32_dpp v26, v23, v23 row_ror:8 row_mask:0xf bank_mask:0xc
    v_add_f32_dpp v27, v25, v25 row_ror:8 row_mask:0xf bank_mask:0xc
    s_nop 0
    v_add_f32_dpp v28, v26, v26 row_half_mirror row_mask:0xf bank_mask:0x5
    s_nop 1
    v_add_f32_dpp v28, v27, v27 row_half_mirror row_mask:0xf bank_mask:0xa
    s_nop 1
    v_add_f32_dpp v28, v28, v28 quad_perm:[1,0,3,2] row_mask:0xf bank_mask:0xf
    s_nop 1
    v_add_f32_dpp v28, v28, v28 quad_perm:[2,3,0,1] row_mask:0xf bank_mask:0xf
    v_cvt_pk_bf16_f32 v28, v28, v28
    v_lshlrev_b32 v28, 16, v28
    v_mul_f32 v28, s61, v28
    v_cvt_pk_bf16_f32 v28, v28, v28
    v_lshlrev_b32 v28, 16, v28
    v_mul_f32 v28, s62, v28
    v_max_f32 v12, v12, v28
    ds_write_b32 v13, v28 offset:1344
    s_add_u32 s56, s56, 65536
    buffer_load_dwordx4 v[40:43], v2, s[32:35], s56 offen offset:0 nt
    s_cmp_lg_u32 s16, 0
    s_cselect_b64 vcc, -1, 0
    s_subb_u32 s16, s16, 0
    s_waitcnt vmcnt(4)
    s_cbranch_vccnz L_w94
    s_waitcnt vmcnt(2)
L_w94:
    s_cmp_eq_u32 s21, 0
    s_cbranch_scc1 L_w95
    s_waitcnt vmcnt(1)
    s_sub_u32 s21, s21, 1
L_w95:
    s_barrier
    ds_read_b32 v31, v29 offset:12568
    v_dot2_f32_bf16 v22, v44, v8, 0
    v_dot2_f32_bf16 v22, v45, v9, v22
    v_dot2_f32_bf16 v22, v46, v10, v22
    v_dot2_f32_bf16 v22, v47, v11, v22
    buffer_load_dwordx4 v[44:47], v2, s[32:35], s56 offen offset:1024 nt
    buffer_load_dwordx4 v[100:103], v4, s[44:47], 0 offen offset:0
    s_waitcnt vmcnt(5)
    s_cbranch_vccnz L_w96
    s_waitcnt vmcnt(3)
L_w96:
    v_dot2_f32_bf16 v23, v48, v8, 0
    v_dot2_f32_bf16 v23, v49, v9, v23
    v_dot2_f32_bf16 v23, v50, v10, v23
    v_dot2_f32_bf16 v23, v51, v11, v23
    buffer_load_dwordx4 v[48:51], v2, s[32:35], s56 offen offset:2048 nt
    s_waitcnt vmcnt(5)
    s_cbranch_vccnz L_w97
    s_waitcnt vmcnt(3)
L_w97:
    s_waitcnt lgkmcnt(0)
    v_readfirstlane_b32 s23, v31
    s_mov_b32 s22, -1
    s_cmp_lg_u32 s3, 0
    s_cbranch_scc1 L_m22
    s_cmp_eq_u32 s23, 0
    s_cbranch_scc1 L_m22
    s_mov_b32 s22, 1
    s_atomic_add s22, s[64:65], 8192 glc
L_m22:
    v_dot2_f32_bf16 v24, v32, v8, 0
    v_dot2_f32_bf16 v24, v33, v9, v24
    v_dot2_f32_bf16 v24, v34, v10, v24
    v_dot2_f32_bf16 v24, v35, v11, v24
    buffer_load_dwordx4 v[32:35], v2, s[32:35], s56 offen offset:3072 nt
    buffer_load_dwordx4 v[104:107], v4, s[44:47], 0 offen offset:1024
    s_waitcnt vmcnt(6)
    s_cbranch_vccnz L_w98
    s_waitcnt vmcnt(4)
L_w98:
    v_dot2_f32_bf16 v25, v36, v8, 0
    v_dot2_f32_bf16 v25, v37, v9, v25
    v_dot2_f32_bf16 v25, v38, v10, v25
    v_dot2_f32_bf16 v25, v39, v11, v25
    v_add_f32_dpp v26, v22, v22 row_ror:8 row_mask:0xf bank_mask:0x3
    v_add_f32_dpp v27, v24, v24 row_ror:8 row_mask:0xf bank_mask:0x3
    s_nop 0
    v_add_f32_dpp v26, v23, v23 row_ror:8 row_mask:0xf bank_mask:0xc
    v_add_f32_dpp v27, v25, v25 row_ror:8 row_mask:0xf bank_mask:0xc
    s_nop 0
    v_add_f32_dpp v28, v26, v26 row_half_mirror row_mask:0xf bank_mask:0x5
    s_nop 1
    v_add_f32_dpp v28, v27, v27 row_half_mirror row_mask:0xf bank_mask:0xa
    s_nop 1
    v_add_f32_dpp v28, v28, v28 quad_perm:[1,0,3,2] row_mask:0xf bank_mask:0xf
    s_nop 1
    v_add_f32_dpp v28, v28, v28 quad_perm:[2,3,0,1] row_mask:0xf bank_mask:0xf
    v_cvt_pk_bf16_f32 v28, v28, v28
    v_lshlrev_b32 v28, 16, v28
    v_mul_f32 v28, s61, v28
    v_cvt_pk_bf16_f32 v28, v28, v28
    v_lshlrev_b32 v28, 16, v28
    v_mul_f32 v28, s62, v28
    v_max_f32 v12, v12, v28
    ds_write_b32 v13, v28 offset:1408
    s_add_u32 s56, s56, 65536
    buffer_load_dwordx4 v[36:39], v2, s[32:35], s56 offen offset:0 nt
    s_cmp_lg_u32 s16, 0
    s_cselect_b64 vcc, -1, 0
    s_subb_u32 s16, s16, 0
    s_waitcnt vmcnt(6)
    s_cbranch_vccnz L_w99
    s_waitcnt vmcnt(3)
L_w99:
    s_cmp_eq_u32 s21, 0
    s_cbranch_scc1 L_w100
    s_waitcnt vmcnt(2)
    s_sub_u32 s21, s21, 1
L_w100:
    s_barrier
    v_dot2_f32_bf16 v22, v40, v8, 0
    v_dot2_f32_bf16 v22, v41, v9, v22
    v_dot2_f32_bf16 v22, v42, v10, v22
    v_dot2_f32_bf16 v22, v43, v11, v22
    buffer_load_dwordx4 v[40:43], v2, s[32:35], s56 offen offset:1024 nt
    buffer_load_dwordx4 v[108:111], v4, s[44:47], 0 offen offset:2048
    s_waitcnt vmcnt(7)
    s_cbranch_vccnz L_w101
    s_waitcnt vmcnt(4)
L_w101:
    v_dot2_f32_bf16 v23, v44, v8, 0
    v_dot2_f32_bf16 v23, v45, v9, v23
    v_dot2_f32_bf16 v23, v46, v10, v23
    v_dot2_f32_bf16 v23, v47, v11, v23
    buffer_load_dwordx4 v[44:47], v2, s[32:35], s56 offen offset:2048 nt
    s_waitcnt vmcnt(6)
    s_cbranch_vccnz L_w102
    s_waitcnt vmcnt(3)
L_w102:
    v_dot2_f32_bf16 v24, v48, v8, 0
    v_dot2_f32_bf16 v24, v49, v9, v24
    v_dot2_f32_bf16 v24, v50, v10, v24
    v_dot2_f32_bf16 v24, v51, v11, v24
    buffer_load_dwordx4 v[48:51], v2, s[32:35], s56 offen offset:3072 nt
    buffer_load_dwordx4 v[112:115], v4, s[44:47], 0 offen offset:3072
    s_waitcnt vmcnt(7)
    s_cbranch_vccnz L_w103
    s_waitcnt vmcnt(4)
L_w103:
    v_dot2_f32_bf16 v25, v32, v8, 0
    v_dot2_f32_bf16 v25, v33, v9, v25
    v_dot2_f32_bf16 v25, v34, v10, v25
    v_dot2_f32_bf16 v25, v35, v11, v25
    v_add_f32_dpp v26, v22, v22 row_ror:8 row_mask:0xf bank_mask:0x3
    v_add_f32_dpp v27, v24, v24 row_ror:8 row_mask:0xf bank_mask:0x3
    s_nop 0
    v_add_f32_dpp v26, v23, v23 row_ror:8 row_mask:0xf bank_mask:0xc
    v_add_f32_dpp v27, v25, v25 row_ror:8 row_mask:0xf bank_mask:0xc
    s_nop 0
    v_add_f32_dpp v28, v26, v26 row_half_mirror row_mask:0xf bank_mask:0x5
    s_nop 1
    v_add_f32_dpp v28, v27, v27 row_half_mirror row_mask:0xf bank_mask:0xa
    s_nop 1
    v_add_f32_dpp v28, v28, v28 quad_perm:[1,0,3,2] row_mask:0xf bank_mask:0xf
    s_nop 1
    v_add_f32_dpp v28, v28, v28 quad_perm:[2,3,0,1] row_mask:0xf bank_mask:0xf
    v_cvt_pk_bf16_f32 v28, v28, v28
    v_lshlrev_b32 v28, 16, v28
    v_mul_f32 v28, s61, v28
    v_cvt_pk_bf16_f32 v28, v28, v28
    v_lshlrev_b32 v28, 16, v28
    v_mul_f32 v28, s62, v28
    v_max_f32 v12, v12, v28
    ds_write_b32 v13, v28 offset:1472
    s_add_u32 s56, s56, 65536
    buffer_load_dwordx4 v[32:35], v2, s[32:35], s56 offen offset:0 nt
    s_waitcnt lgkmcnt(0)
    s_cmp_lg_u32 s3, 0
    s_cbranch_scc1 L_h24
    s_add_u32 s22, s22, 1
    s_min_u32 s22, s22, 15
    s_lshl_b32 s22, s22, 2
    s_mov_b32 s24, 0xabcd
    s_mov_b32 s25, 0x75310000
    s_lshr_b64 s[24:25], s[24:25], s22
    s_and_b32 s22, s24, 15
    v_mov_b32 v31, s22
    ds_write_b32 v29, v31 offset:12564
L_h24:
    s_cmp_lg_u32 s16, 0
    s_cselect_b64 vcc, -1, 0
    s_subb_u32 s16, s16, 0
    s_waitcnt vmcnt(6)
    s_cbranch_vccnz L_w104
    s_waitcnt vmcnt(3)
L_w104:
    s_cmp_eq_u32 s21, 0
    s_cbranch_scc1 L_w105
    s_waitcnt vmcnt(2)
    s_sub_u32 s21, s21, 1
L_w105:
    s_barrier
    v_dot2_f32_bf16 v22, v36, v8, 0
    v_dot2_f32_bf16 v22, v37, v9, v22
    v_dot2_f32_bf16 v22, v38, v10, v22
    v_dot2_f32_bf16 v22, v39, v11, v22
    buffer_load_dwordx4 v[36:39], v2, s[32:35], s56 offen offset:1024 nt
    buffer_load_dwordx4 v[116:119], v4, s[44:47], s57 offen offset:0
    s_waitcnt vmcnt(7)
    s_cbranch_vccnz L_w106
    s_waitcnt vmcnt(4)
L_w106:
    v_dot2_f32_bf16 v23, v40, v8, 0
    v_dot2_f32_bf16 v23, v41, v9, v23
    v_dot2_f32_bf16 v23, v42, v10, v23
    v_dot2_f32_bf16 v23, v43, v11, v23
    buffer_load_dwordx4 v[40:43], v2, s[32:35], s56 offen offset:2048 nt
    s_waitcnt vmcnt(6)
    s_cbranch_vccnz L_w107
    s_waitcnt vmcnt(3)
L_w107:
    v_dot2_f32_bf16 v24, v44, v8, 0
    v_dot2_f32_bf16 v24, v45, v9, v24
    v_dot2_f32_bf16 v24, v46, v10, v24
    v_dot2_f32_bf16 v24, v47, v11, v24
    buffer_load_dwordx4 v[44:47], v2, s[32:35], s56 offen offset:3072 nt
    buffer_load_dwordx4 v[120:123], v4, s[44:47], s57 offen offset:1024
    s_waitcnt vmcnt(7)
    s_cbranch_vccnz L_w108
    s_waitcnt vmcnt(4)
L_w108:
    v_dot2_f32_bf16 v25, v48, v8, 0
    v_dot2_f32_bf16 v25, v49, v9, v25
    v_dot2_f32_bf16 v25, v50, v10, v25
    v_dot2_f32_bf16 v25, v51, v11, v25
    v_add_f32_dpp v26, v22, v22 row_ror:8 row_mask:0xf bank_mask:0x3
    v_add_f32_dpp v27, v24, v24 row_ror:8 row_mask:0xf bank_mask:0x3
    s_nop 0
    v_add_f32_dpp v26, v23, v23 row_ror:8 row_mask:0xf bank_mask:0xc
    v_add_f32_dpp v27, v25, v25 row_ror:8 row_mask:0xf bank_mask:0xc
    s_nop 0
    v_add_f32_dpp v28, v26, v26 row_half_mirror row_mask:0xf bank_mask:0x5
    s_nop 1
    v_add_f32_dpp v28, v27, v27 row_half_mirror row_mask:0xf bank_mask:0xa
    s_nop 1
    v_add_f32_dpp v28, v28, v28 quad_perm:[1,0,3,2] row_mask:0xf bank_mask:0xf
    s_nop 1
    v_add_f32_dpp v28, v28, v28 quad_perm:[2,3,0,1] row_mask:0xf bank_mask:0xf
    v_cvt_pk_bf16_f32 v28, v28, v28
    v_lshlrev_b32 v28, 16, v28
    v_mul_f32 v28, s61, v28
    v_cvt_pk_bf16_f32 v28, v28, v28
    v_lshlrev_b32 v28, 16, v28
    v_mul_f32 v28, s62, v28
    v_max_f32 v12, v12, v28
    ds_write_b32 v13, v28 offset:1536
    s_add_u32 s56, s56, 65536
    buffer_load_dwordx4 v[48:51], v2, s[32:35], s56 offen offset:0 nt
    s_waitcnt lgkmcnt(0)
    s_cmp_lg_u32 s16, 0
    s_cselect_b64 vcc, -1, 0
    s_subb_u32 s16, s16, 0
    s_waitcnt vmcnt(6)
    s_cbranch_vccnz L_w109
    s_waitcnt vmcnt(3)
L_w109:
    s_cmp_eq_u32 s21, 0
    s_cbranch_scc1 L_w110
    s_waitcnt vmcnt(2)
    s_sub_u32 s21, s21, 1
L_w110:
    s_barrier
    ds_read_b32 v31, v29 offset:12564
    v_dot2_f32_bf16 v22, v32, v8, 0
    v_dot2_f32_bf16 v22, v33, v9, v22
    v_dot2_f32_bf16 v22, v34, v10, v22
    v_dot2_f32_bf16 v22, v35, v11, v22
    buffer_load_dwordx4 v[32:35], v2, s[32:35], s56 offen offset:1024 nt
    buffer_load_dwordx4 v[124:127], v4, s[44:47], s57 offen offset:2048
    s_waitcnt vmcnt(7)
    s_cbranch_vccnz L_w111
    s_waitcnt vmcnt(4)
L_w111:
    v_dot2_f32_bf16 v23, v36, v8, 0
    v_dot2_f32_bf16 v23, v37, v9, v23
    v_dot2_f32_bf16 v23, v38, v10, v23
    v_dot2_f32_bf16 v23, v39, v11, v23
    buffer_load_dwordx4 v[36:39], v2, s[32:35], s56 offen offset:2048 nt
    s_waitcnt vmcnt(6)
    s_cbranch_vccnz L_w112
    s_waitcnt vmcnt(3)
L_w112:
    v_dot2_f32_bf16 v24, v40, v8, 0
    v_dot2_f32_bf16 v24, v41, v9, v24
    v_dot2_f32_bf16 v24, v42, v10, v24
    v_dot2_f32_bf16 v24, v43, v11, v24
    buffer_load_dwordx4 v[40:43], v2, s[32:35], s56 offen offset:3072 nt
    buffer_load_dwordx4 v[128:131], v4, s[44:47], s57 offen offset:3072
    s_waitcnt vmcnt(7)
    s_cbranch_vccnz L_w113
    s_waitcnt vmcnt(4)
L_w113:
    v_dot2_f32_bf16 v25, v44, v8, 0
    v_dot2_f32_bf16 v25, v45, v9, v25
    v_dot2_f32_bf16 v25, v46, v10, v25
    v_dot2_f32_bf16 v25, v47, v11, v25
    v_add_f32_dpp v26, v22, v22 row_ror:8 row_mask:0xf bank_mask:0x3
    v_add_f32_dpp v27, v24, v24 row_ror:8 row_mask:0xf bank_mask:0x3
    s_nop 0
    v_add_f32_dpp v26, v23, v23 row_ror:8 row_mask:0xf bank_mask:0xc
    v_add_f32_dpp v27, v25, v25 row_ror:8 row_mask:0xf bank_mask:0xc
    s_nop 0
    v_add_f32_dpp v28, v26, v26 row_half_mirror row_mask:0xf bank_mask:0x5
    s_nop 1
    v_add_f32_dpp v28, v27, v27 row_half_mirror row_mask:0xf bank_mask:0xa
    s_nop 1
    v_add_f32_dpp v28, v28, v28 quad_perm:[1,0,3,2] row_mask:0xf bank_mask:0xf
    s_nop 1
    v_add_f32_dpp v28, v28, v28 quad_perm:[2,3,0,1] row_mask:0xf bank_mask:0xf
    v_cvt_pk_bf16_f32 v28, v28, v28
    v_lshlrev_b32 v28, 16, v28
    v_mul_f32 v28, s61, v28
    v_cvt_pk_bf16_f32 v28, v28, v28
    v_lshlrev_b32 v28, 16, v28
    v_mul_f32 v28, s62, v28
    v_max_f32 v12, v12, v28
    ds_write_b32 v13, v28 offset:1600
    s_add_u32 s56, s56, 65536
    buffer_load_dwordx4 v[44:47], v2, s[32:35], s56 offen offset:0 nt
    s_waitcnt lgkmcnt(0)
    v_readfirstlane_b32 s16, v31
    s_sub_u32 s21, s16, 8
    s_cselect_b32 s21, 0, s21
    s_cselect_b32 s16, s16, 0
    s_cmp_lg_u32 s16, 0
    s_cselect_b64 vcc, -1, 0
    s_subb_u32 s16, s16, 0
    s_waitcnt vmcnt(6)
    s_cbranch_vccnz L_w114
    s_waitcnt vmcnt(3)
L_w114:
    s_cmp_eq_u32 s21, 0
    s_cbranch_scc1 L_w115
    s_waitcnt vmcnt(2)
    s_sub_u32 s21, s21, 1
L_w115:
    s_barrier
    v_dot2_f32_bf16 v22, v48, v8, 0
    v_dot2_f32_bf16 v22, v49, v9, v22
    v_dot2_f32_bf16 v22, v50, v10, v22
    v_dot2_f32_bf16 v22, v51, v11, v22
    buffer_load_dwordx4 v[48:51], v2, s[32:35], s56 offen offset:1024 nt
    buffer_load_dwordx4 v[132:135], v4, s[44:47], s58 offen offset:0
    s_waitcnt vmcnt(7)
    s_cbranch_vccnz L_w116
    s_waitcnt vmcnt(4)
L_w116:
    v_dot2_f32_bf16 v23, v32, v8, 0
    v_dot2_f32_bf16 v23, v33, v9, v23
    v_dot2_f32_bf16 v23, v34, v10, v23
    v_dot2_f32_bf16 v23, v35, v11, v23
    buffer_load_dwordx4 v[32:35], v2, s[32:35], s56 offen offset:2048 nt
    s_waitcnt vmcnt(6)
    s_cbranch_vccnz L_w117
    s_waitcnt vmcnt(3)
L_w117:
    v_dot2_f32_bf16 v24, v36, v8, 0
    v_dot2_f32_bf16 v24, v37, v9, v24
    v_dot2_f32_bf16 v24, v38, v10, v24
    v_dot2_f32_bf16 v24, v39, v11, v24
    buffer_load_dwordx4 v[36:39], v2, s[32:35], s56 offen offset:3072 nt
    buffer_load_dwordx4 v[136:139], v4, s[44:47], s58 offen offset:1024
    s_waitcnt vmcnt(7)
    s_cbranch_vccnz L_w118
    s_waitcnt vmcnt(4)
L_w118:
    v_dot2_f32_bf16 v25, v40, v8, 0
    v_dot2_f32_bf16 v25, v41, v9, v25
    v_dot2_f32_bf16 v25, v42, v10, v25
    v_dot2_f32_bf16 v25, v43, v11, v25
    v_add_f32_dpp v26, v22, v22 row_ror:8 row_mask:0xf bank_mask:0x3
    v_add_f32_dpp v27, v24, v24 row_ror:8 row_mask:0xf bank_mask:0x3
    s_nop 0
    v_add_f32_dpp v26, v23, v23 row_ror:8 row_mask:0xf bank_mask:0xc
    v_add_f32_dpp v27, v25, v25 row_ror:8 row_mask:0xf bank_mask:0xc
    s_nop 0
    v_add_f32_dpp v28, v26, v26 row_half_mirror row_mask:0xf bank_mask:0x5
    s_nop 1
    v_add_f32_dpp v28, v27, v27 row_half_mirror row_mask:0xf bank_mask:0xa
    s_nop 1
    v_add_f32_dpp v28, v28, v28 quad_perm:[1,0,3,2] row_mask:0xf bank_mask:0xf
    s_nop 1
    v_add_f32_dpp v28, v28, v28 quad_perm:[2,3,0,1] row_mask:0xf bank_mask:0xf
    v_cvt_pk_bf16_f32 v28, v28, v28
    v_lshlrev_b32 v28, 16, v28
    v_mul_f32 v28, s61, v28
    v_cvt_pk_bf16_f32 v28, v28, v28
    v_lshlrev_b32 v28, 16, v28
    v_mul_f32 v28, s62, v28
    v_max_f32 v12, v12, v28
    ds_write_b32 v13, v28 offset:1664
    s_add_u32 s56, s56, 65536
    buffer_load_dwordx4 v[40:43], v2, s[32:35], s56 offen offset:0 nt
    s_cmp_lg_u32 s16, 0
    s_cselect_b64 vcc, -1, 0
    s_subb_u32 s16, s16, 0
    s_waitcnt vmcnt(6)
    s_cbranch_vccnz L_w119
    s_waitcnt vmcnt(3)
L_w119:
    s_cmp_eq_u32 s21, 0
    s_cbranch_scc1 L_w120
    s_waitcnt vmcnt(2)
    s_sub_u32 s21, s21, 1
L_w120:
    s_barrier
    ds_read_b32 v31, v29 offset:12568
    v_dot2_f32_bf16 v22, v44, v8, 0
    v_dot2_f32_bf16 v22, v45, v9, v22
    v_dot2_f32_bf16 v22, v46, v10, v22
    v_dot2_f32_bf16 v22, v47, v11, v22
    buffer_load_dwordx4 v[44:47], v2, s[32:35], s56 offen offset:1024 nt
    buffer_load_dwordx4 v[140:143], v4, s[44:47], s58 offen offset:2048
    s_waitcnt vmcnt(7)
    s_cbranch_vccnz L_w121
    s_waitcnt vmcnt(4)
L_w121:
    v_dot2_f32_bf16 v23, v48, v8, 0
    v_dot2_f32_bf16 v23, v49, v9, v23
    v_dot2_f32_bf16 v23, v50, v10, v23
    v_dot2_f32_bf16 v23, v51, v11, v23
    buffer_load_dwordx4 v[48:51], v2, s[32:35], s56 offen offset:2048 nt
    s_waitcnt vmcnt(6)
    s_cbranch_vccnz L_w122
    s_waitcnt vmcnt(3)
L_w122:
    s_waitcnt lgkmcnt(0)
    v_readfirstlane_b32 s23, v31
    s_mov_b32 s22, -1
    s_cmp_lg_u32 s3, 0
    s_cbranch_scc1 L_m27
    s_cmp_eq_u32 s23, 0
    s_cbranch_scc1 L_m27
    s_mov_b32 s22, 1
    s_atomic_add s22, s[64:65], 12288 glc
L_m27:
    v_dot2_f32_bf16 v24, v32, v8, 0
    v_dot2_f32_bf16 v24, v33, v9, v24
    v_dot2_f32_bf16 v24, v34, v10, v24
    v_dot2_f32_bf16 v24, v35, v11, v24
    buffer_load_dwordx4 v[32:35], v2, s[32:35], s56 offen offset:3072 nt
    buffer_load_dwordx4 v[144:147], v4, s[44:47], s58 offen offset:3072
    s_waitcnt vmcnt(7)
    s_cbranch_vccnz L_w123
    s_waitcnt vmcnt(4)
L_w123:
    v_dot2_f32_bf16 v25, v36, v8, 0
    v_dot2_f32_bf16 v25, v37, v9, v25
    v_dot2_f32_bf16 v25, v38, v10, v25
    v_dot2_f32_bf16 v25, v39, v11, v25
    v_add_f32_dpp v26, v22, v22 row_ror:8 row_mask:0xf bank_mask:0x3
    v_add_f32_dpp v27, v24, v24 row_ror:8 row_mask:0xf bank_mask:0x3
    s_nop 0
    v_add_f32_dpp v26, v23, v23 row_ror:8 row_mask:0xf bank_mask:0xc
    v_add_f32_dpp v27, v25, v25 row_ror:8 row_mask:0xf bank_mask:0xc
    s_nop 0
    v_add_f32_dpp v28, v26, v26 row_half_mirror row_mask:0xf bank_mask:0x5
    s_nop 1
    v_add_f32_dpp v28, v27, v27 row_half_mirror row_mask:0xf bank_mask:0xa
    s_nop 1
    v_add_f32_dpp v28, v28, v28 quad_perm:[1,0,3,2] row_mask:0xf bank_mask:0xf
    s_nop 1
    v_add_f32_dpp v28, v28, v28 quad_perm:[2,3,0,1] row_mask:0xf bank_mask:0xf
    v_cvt_pk_bf16_f32 v28, v28, v28
    v_lshlrev_b32 v28, 16, v28
    v_mul_f32 v28, s61, v28
    v_cvt_pk_bf16_f32 v28, v28, v28
    v_lshlrev_b32 v28, 16, v28
    v_mul_f32 v28, s62, v28
    v_max_f32 v12, v12, v28
    ds_write_b32 v13, v28 offset:1728
    s_add_u32 s56, s56, 65536
    buffer_load_dwordx4 v[36:39], v2, s[32:35], s56 offen offset:0 nt
    s_cmp_lg_u32 s16, 0
    s_cselect_b64 vcc, -1, 0
    s_subb_u32 s16, s16, 0
    s_waitcnt vmcnt(6)
    s_cbranch_vccnz L_w124
    s_waitcnt vmcnt(3)
L_w124:
    s_cmp_eq_u32 s21, 0
    s_cbranch_scc1 L_w125
    s_waitcnt vmcnt(2)
    s_sub_u32 s21, s21, 1
L_w125:
    s_barrier
    v_dot2_f32_bf16 v22, v40, v8, 0
    v_dot2_f32_bf16 v22, v41, v9, v22
    v_dot2_f32_bf16 v22, v42, v10, v22
    v_dot2_f32_bf16 v22, v43, v11, v22
    buffer_load_dwordx4 v[40:43], v2, s[32:35], s56 offen offset:1024 nt
    buffer_load_dwordx4 v[148:151], v4, s[44:47], s59 offen offset:0
    s_waitcnt vmcnt(7)
    s_cbranch_vccnz L_w126
    s_waitcnt vmcnt(4)
L_w126:
    v_dot2_f32_bf16 v23, v44, v8, 0
    v_dot2_f32_bf16 v23, v45, v9, v23
    v_dot2_f32_bf16 v23, v46, v10, v23
    v_dot2_f32_bf16 v23, v47, v11, v23
    buffer_load_dwordx4 v[44:47], v2, s[32:35], s56 offen offset:2048 nt
    s_waitcnt vmcnt(6)
    s_cbranch_vccnz L_w127
    s_waitcnt vmcnt(3)
L_w127:
    v_dot2_f32_bf16 v24, v48, v8, 0
    v_dot2_f32_bf16 v24, v49, v9, v24
    v_dot2_f32_bf16 v24, v50, v10, v24
    v_dot2_f32_bf16 v24, v51, v11, v24
    buffer_load_dwordx4 v[48:51], v2, s[32:35], s56 offen offset:3072 nt
    buffer_load_dwordx4 v[152:155], v4, s[44:47], s59 offen offset:1024
    s_waitcnt vmcnt(7)
    s_cbranch_vccnz L_w128
    s_waitcnt vmcnt(4)
L_w128:
    v_dot2_f32_bf16 v25, v32, v8, 0
    v_dot2_f32_bf16 v25, v33, v9, v25
    v_dot2_f32_bf16 v25, v34, v10, v25
    v_dot2_f32_bf16 v25, v35, v11, v25
    v_add_f32_dpp v26, v22, v22 row_ror:8 row_mask:0xf bank_mask:0x3
    v_add_f32_dpp v27, v24, v24 row_ror:8 row_mask:0xf bank_mask:0x3
    s_nop 0
    v_add_f32_dpp v26, v23, v23 row_ror:8 row_mask:0xf bank_mask:0xc
    v_add_f32_dpp v27, v25, v25 row_ror:8 row_mask:0xf bank_mask:0xc
    s_nop 0
    v_add_f32_dpp v28, v26, v26 row_half_mirror row_mask:0xf bank_mask:0x5
    s_nop 1
    v_add_f32_dpp v28, v27, v27 row_half_mirror row_mask:0xf bank_mask:0xa
    s_nop 1
    v_add_f32_dpp v28, v28, v28 quad_perm:[1,0,3,2] row_mask:0xf bank_mask:0xf
    s_nop 1
    v_add_f32_dpp v28, v28, v28 quad_perm:[2,3,0,1] row_mask:0xf bank_mask:0xf
    v_cvt_pk_bf16_f32 v28, v28, v28
    v_lshlrev_b32 v28, 16, v28
    v_mul_f32 v28, s61, v28
    v_cvt_pk_bf16_f32 v28, v28, v28
    v_lshlrev_b32 v28, 16, v28
    v_mul_f32 v28, s62, v28
    v_max_f32 v12, v12, v28
    ds_write_b32 v13, v28 offset:1792
    s_add_u32 s56, s56, 65536
    buffer_load_dwordx4 v[32:35], v2, s[32:35], s56 offen offset:0 nt
    s_waitcnt lgkmcnt(0)
    s_cmp_lg_u32 s3, 0
    s_cbranch_scc1 L_h29
    s_add_u32 s22, s22, 1
    s_min_u32 s22, s22, 15
    s_lshl_b32 s22, s22, 2
    s_mov_b32 s24, 0xabcd
    s_mov_b32 s25, 0x75310000
    s_lshr_b64 s[24:25], s[24:25], s22
    s_and_b32 s22, s24, 15
    v_mov_b32 v31, s22
    ds_write_b32 v29, v31 offset:12564
L_h29:
    s_cmp_lg_u32 s16, 0
    s_cselect_b64 vcc, -1, 0
    s_subb_u32 s16, s16, 0
    s_waitcnt vmcnt(6)
    s_cbranch_vccnz L_w129
    s_waitcnt vmcnt(3)
L_w129:
    s_cmp_eq_u32 s21, 0
    s_cbranch_scc1 L_w130
    s_waitcnt vmcnt(2)
    s_sub_u32 s21, s21, 1
L_w130:
    s_barrier
    v_dot2_f32_bf16 v22, v36, v8, 0
    v_dot2_f32_bf16 v22, v37, v9, v22
    v_dot2_f32_bf16 v22, v38, v10, v22
    v_dot2_f32_bf16 v22, v39, v11, v22
    buffer_load_dwordx4 v[36:39], v2, s[32:35], s56 offen offset:1024 nt
    buffer_load_dwordx4 v[156:159], v4, s[44:47], s59 offen offset:2048
    s_waitcnt vmcnt(7)
    s_cbranch_vccnz L_w131
    s_waitcnt vmcnt(4)
L_w131:
    v_dot2_f32_bf16 v23, v40, v8, 0
    v_dot2_f32_bf16 v23, v41, v9, v23
    v_dot2_f32_bf16 v23, v42, v10, v23
    v_dot2_f32_bf16 v23, v43, v11, v23
    buffer_load_dwordx4 v[40:43], v2, s[32:35], s56 offen offset:2048 nt
    s_waitcnt vmcnt(6)
    s_cbranch_vccnz L_w132
    s_waitcnt vmcnt(3)
L_w132:
    v_dot2_f32_bf16 v24, v44, v8, 0
    v_dot2_f32_bf16 v24, v45, v9, v24
    v_dot2_f32_bf16 v24, v46, v10, v24
    v_dot2_f32_bf16 v24, v47, v11, v24
    buffer_load_dwordx4 v[44:47], v2, s[32:35], s56 offen offset:3072 nt
    buffer_load_dwordx4 v[160:163], v4, s[44:47], s59 offen offset:3072
    s_waitcnt vmcnt(7)
    s_cbranch_vccnz L_w133
    s_waitcnt vmcnt(4)
L_w133:
    v_dot2_f32_bf16 v25, v48, v8, 0
    v_dot2_f32_bf16 v25, v49, v9, v25
    v_dot2_f32_bf16 v25, v50, v10, v25
    v_dot2_f32_bf16 v25, v51, v11, v25
    v_add_f32_dpp v26, v22, v22 row_ror:8 row_mask:0xf bank_mask:0x3
    v_add_f32_dpp v27, v24, v24 row_ror:8 row_mask:0xf bank_mask:0x3
    s_nop 0
    v_add_f32_dpp v26, v23, v23 row_ror:8 row_mask:0xf bank_mask:0xc
    v_add_f32_dpp v27, v25, v25 row_ror:8 row_mask:0xf bank_mask:0xc
    s_nop 0
    v_add_f32_dpp v28, v26, v26 row_half_mirror row_mask:0xf bank_mask:0x5
    s_nop 1
    v_add_f32_dpp v28, v27, v27 row_half_mirror row_mask:0xf bank_mask:0xa
    s_nop 1
    v_add_f32_dpp v28, v28, v28 quad_perm:[1,0,3,2] row_mask:0xf bank_mask:0xf
    s_nop 1
    v_add_f32_dpp v28, v28, v28 quad_perm:[2,3,0,1] row_mask:0xf bank_mask:0xf
    v_cvt_pk_bf16_f32 v28, v28, v28
    v_lshlrev_b32 v28, 16, v28
    v_mul_f32 v28, s61, v28
    v_cvt_pk_bf16_f32 v28, v28, v28
    v_lshlrev_b32 v28, 16, v28
    v_mul_f32 v28, s62, v28
    v_max_f32 v12, v12, v28
    ds_write_b32 v13, v28 offset:1856
    s_add_u32 s56, s56, 65536
    buffer_load_dwordx4 v[48:51], v2, s[32:35], s56 offen offset:0 nt
    s_waitcnt lgkmcnt(0)
    s_cmp_lg_u32 s16, 0
    s_cselect_b64 vcc, -1, 0
    s_subb_u32 s16, s16, 0
    s_waitcnt vmcnt(6)
    s_cbranch_vccnz L_w134
    s_waitcnt vmcnt(3)
L_w134:
    s_cmp_eq_u32 s21, 0
    s_cbranch_scc1 L_w135
    s_waitcnt vmcnt(2)
    s_sub_u32 s21, s21, 1
L_w135:
    s_barrier
    ds_read_b32 v31, v29 offset:12564
    v_dot2_f32_bf16 v22, v32, v8, 0
    v_dot2_f32_bf16 v22, v33, v9, v22
    v_dot2_f32_bf16 v22, v34, v10, v22
    v_dot2_f32_bf16 v22, v35, v11, v22
    buffer_load_dwordx4 v[32:35], v2, s[32:35], s56 offen offset:1024 nt
    s_waitcnt vmcnt(6)
    s_cbranch_vccnz L_w136
    s_waitcnt vmcnt(3)
L_w136:
    v_dot2_f32_bf16 v23, v36, v8, 0
    v_dot2_f32_bf16 v23, v37, v9, v23
    v_dot2_f32_bf16 v23, v38, v10, v23
    v_dot2_f32_bf16 v23, v39, v11, v23
    buffer_load_dwordx4 v[36:39], v2, s[32:35], s56 offen offset:2048 nt
    s_waitcnt vmcnt(5)
    s_cbranch_vccnz L_w137
    s_waitcnt vmcnt(2)
L_w137:
    v_dot2_f32_bf16 v24, v40, v8, 0
    v_dot2_f32_bf16 v24, v41, v9, v24
    v_dot2_f32_bf16 v24, v42, v10, v24
    v_dot2_f32_bf16 v24, v43, v11, v24
    buffer_load_dwordx4 v[40:43], v2, s[32:35], s56 offen offset:3072 nt
    s_waitcnt vmcnt(5)
    s_cbranch_vccnz L_w138
    s_waitcnt vmcnt(2)
L_w138:
    v_dot2_f32_bf16 v25, v44, v8, 0
    v_dot2_f32_bf16 v25, v45, v9, v25
    v_dot2_f32_bf16 v25, v46, v10, v25
    v_dot2_f32_bf16 v25, v47, v11, v25
    v_add_f32_dpp v26, v22, v22 row_ror:8 row_mask:0xf bank_mask:0x3
    v_add_f32_dpp v27, v24, v24 row_ror:8 row_mask:0xf bank_mask:0x3
    s_nop 0
    v_add_f32_dpp v26, v23, v23 row_ror:8 row_mask:0xf bank_mask:0xc
    v_add_f32_dpp v27, v25, v25 row_ror:8 row_mask:0xf bank_mask:0xc
    s_nop 0
    v_add_f32_dpp v28, v26, v26 row_half_mirror row_mask:0xf bank_mask:0x5
    s_nop 1
    v_add_f32_dpp v28, v27, v27 row_half_mirror row_mask:0xf bank_mask:0xa
    s_nop 1
    v_add_f32_dpp v28, v28, v28 quad_perm:[1,0,3,2] row_mask:0xf bank_mask:0xf
    s_nop 1
    v_add_f32_dpp v28, v28, v28 quad_perm:[2,3,0,1] row_mask:0xf bank_mask:0xf
    v_cvt_pk_bf16_f32 v28, v28, v28
    v_lshlrev_b32 v28, 16, v28
    v_mul_f32 v28, s61, v28
    v_cvt_pk_bf16_f32 v28, v28, v28
    v_lshlrev_b32 v28, 16, v28
    v_mul_f32 v28, s62, v28
    v_max_f32 v12, v12, v28
    ds_write_b32 v13, v28 offset:1920
    s_mov_b32 s56, 196608
    buffer_load_dwordx4 v[44:47], v2, s[36:39], s56 offen offset:0 nt
    s_waitcnt lgkmcnt(0)
    v_readfirstlane_b32 s16, v31
    s_sub_u32 s21, s16, 8
    s_cselect_b32 s21, 0, s21
    s_cselect_b32 s16, s16, 0
    s_cmp_lg_u32 s16, 0
    s_cselect_b64 vcc, -1, 0
    s_subb_u32 s16, s16, 0
    s_waitcnt vmcnt(4)
    s_cbranch_vccnz L_w139
    s_waitcnt vmcnt(2)
L_w139:
    s_cmp_eq_u32 s21, 0
    s_cbranch_scc1 L_w140
    s_waitcnt vmcnt(1)
    s_sub_u32 s21, s21, 1
L_w140:
    s_barrier
    v_dot2_f32_bf16 v22, v48, v8, 0
    v_dot2_f32_bf16 v22, v49, v9, v22
    v_dot2_f32_bf16 v22, v50, v10, v22
    v_dot2_f32_bf16 v22, v51, v11, v22
    buffer_load_dwordx4 v[48:51], v2, s[36:39], s56 offen offset:1024 nt
    s_waitcnt vmcnt(4)
    s_cbranch_vccnz L_w141
    s_waitcnt vmcnt(2)
L_w141:
    v_dot2_f32_bf16 v23, v32, v8, 0
    v_dot2_f32_bf16 v23, v33, v9, v23
    v_dot2_f32_bf16 v23, v34, v10, v23
    v_dot2_f32_bf16 v23, v35, v11, v23
    buffer_load_dwordx4 v[32:35], v2, s[36:39], s56 offen offset:2048 nt
    s_waitcnt vmcnt(4)
    s_cbranch_vccnz L_w142
    s_waitcnt vmcnt(2)
L_w142:
    v_dot2_f32_bf16 v24, v36, v8, 0
    v_dot2_f32_bf16 v24, v37, v9, v24
    v_dot2_f32_bf16 v24, v38, v10, v24
    v_dot2_f32_bf16 v24, v39, v11, v24
    buffer_load_dwordx4 v[36:39], v2, s[36:39], s56 offen offset:3072 nt
    s_waitcnt vmcnt(4)
    s_cbranch_vccnz L_w143
    s_waitcnt vmcnt(2)
L_w143:
    v_dot2_f32_bf16 v25, v40, v8, 0
    v_dot2_f32_bf16 v25, v41, v9, v25
    v_dot2_f32_bf16 v25, v42, v10, v25
    v_dot2_f32_bf16 v25, v43, v11, v25
    v_add_f32_dpp v26, v22, v22 row_ror:8 row_mask:0xf bank_mask:0x3
    v_add_f32_dpp v27, v24, v24 row_ror:8 row_mask:0xf bank_mask:0x3
    s_nop 0
    v_add_f32_dpp v26, v23, v23 row_ror:8 row_mask:0xf bank_mask:0xc
    v_add_f32_dpp v27, v25, v25 row_ror:8 row_mask:0xf bank_mask:0xc
    s_nop 0
    v_add_f32_dpp v28, v26, v26 row_half_mirror row_mask:0xf bank_mask:0x5
    s_nop 1
    v_add_f32_dpp v28, v27, v27 row_half_mirror row_mask:0xf bank_mask:0xa
    s_nop 1
    v_add_f32_dpp v28, v28, v28 quad_perm:[1,0,3,2] row_mask:0xf bank_mask:0xf
    s_nop 1
    v_add_f32_dpp v28, v28, v28 quad_perm:[2,3,0,1] row_mask:0xf bank_mask:0xf
    v_cvt_pk_bf16_f32 v28, v28, v28
    v_lshlrev_b32 v28, 16, v28
    v_mul_f32 v28, s61, v28
    v_cvt_pk_bf16_f32 v28, v28, v28
    v_lshlrev_b32 v28, 16, v28
    v_mul_f32 v28, s62, v28
    v_max_f32 v12, v12, v28
    ds_write_b32 v13, v28 offset:1984
    s_add_u32 s56, s56, 65536
    buffer_load_dwordx4 v[40:43], v2, s[36:39], s56 offen offset:0 nt
    s_lshl_b32 s9, s3, 11
    s_add_u32 s9, s9, 41472
    v_lshlrev_b32 v13, 5, v0
    v_add_u32 v13, s9, v13
    v_max_f32_dpp v12, v12, v12 row_ror:4 row_mask:0xf bank_mask:0xf
    s_nop 1
    v_max_f32_dpp v12, v12, v12 row_ror:8 row_mask:0xf bank_mask:0xf
    s_waitcnt lgkmcnt(0)
    ds_read_b128 v[14:17], v13
    ds_read_b128 v[18:21], v13 offset:16
    v_mov_b32 v27, v12
    s_nop 1
    v_permlane32_swap_b32 v12, v27
    v_max_f32 v12, v12, v27
    v_mov_b32 v27, v12
    s_nop 1
    v_permlane16_swap_b32 v12, v27
    v_max_f32 v26, v12, v27
    s_waitcnt lgkmcnt(0)
    v_sub_f32 v14, v14, v26
    v_sub_f32 v15, v15, v26
    v_sub_f32 v16, v16, v26
    v_sub_f32 v17, v17, v26
    v_sub_f32 v18, v18, v26
    v_sub_f32 v19, v19, v26
    v_sub_f32 v20, v20, v26
    v_sub_f32 v21, v21, v26
    v_exp_f32 v14, v14
    v_exp_f32 v15, v15
    v_exp_f32 v16, v16
    v_exp_f32 v17, v17
    v_exp_f32 v18, v18
    v_exp_f32 v19, v19
    v_exp_f32 v20, v20
    v_exp_f32 v21, v21
    ds_write_b128 v13, v[14:17]
    ds_write_b128 v13, v[18:21] offset:16
    v_pk_add_f32 v[22:23], v[14:15], v[16:17]
    v_pk_add_f32 v[24:25], v[18:19], v[20:21]
    v_pk_add_f32 v[22:23], v[22:23], v[24:25]
    v_add_f32 v27, v22, v23
    s_nop 1
    v_add_f32_dpp v27, v27, v27 quad_perm:[1,0,3,2] row_mask:0xf bank_mask:0xf
    s_nop 1
    v_add_f32_dpp v27, v27, v27 quad_perm:[2,3,0,1] row_mask:0xf bank_mask:0xf
    s_nop 1
    v_add_f32_dpp v27, v27, v27 row_ror:4 row_mask:0xf bank_mask:0xf
    s_nop 1
    v_add_f32_dpp v27, v27, v27 row_ror:8 row_mask:0xf bank_mask:0xf
    v_mov_b32 v28, v27
    s_nop 1
    v_permlane32_swap_b32 v27, v28
    v_add_f32 v27, v27, v28
    v_mov_b32 v28, v27
    s_nop 1
    v_permlane16_swap_b32 v27, v28
    v_add_f32 v27, v27, v28
    s_lshl_b32 s10, s3, 3
    v_mov_b32 v28, s10
    s_mov_b64 exec, 1
    ds_write_b64 v28, v[26:27] offset:10240
    v_mov_b32 v28, 0
    v_mov_b32 v29, 1
    ds_add_u32 v28, v29 offset:12560
    s_mov_b64 exec, -1
    v_mov_b32 v30, v26
    v_lshlrev_b32 v13, 4, v5
    v_add_u32 v13, s9, v13
    s_waitcnt lgkmcnt(0)
    ds_read_b128 v[22:25], v13 offset:192
    v_mov_b32 v4, 0
    v_mov_b32 v14, 0
    v_mov_b32 v15, 0
    v_mov_b32 v16, 0
    v_mov_b32 v17, 0
    v_mov_b32 v18, 0
    v_mov_b32 v19, 0
    v_mov_b32 v20, 0
    v_mov_b32 v21, 0
    s_mov_b32 s14, 0x05040100
    s_mov_b32 s15, 0x07060302
    s_waitcnt lgkmcnt(0)
    s_cmp_lg_u32 s16, 0
    s_cselect_b64 vcc, -1, 0
    s_subb_u32 s16, s16, 0
    ds_read_b128 v[26:29], v13 offset:0
    ds_read_b128 v[8:11], v13 offset:256
    s_waitcnt vmcnt(4)
    s_cbranch_vccnz L_w144
    s_waitcnt vmcnt(2)
L_w144:
    s_cmp_eq_u32 s21, 0
    s_cbranch_scc1 L_w145
    s_waitcnt vmcnt(1)
    s_sub_u32 s21, s21, 1
L_w145:
    s_barrier
    v_lshlrev_b32 v164, 16, v44
    v_and_b32 v165, s60, v44
    v_lshlrev_b32 v166, 16, v45
    v_and_b32 v167, s60, v45
    v_pk_fma_f32 v[14:15], v[164:165], v[22:23], v[14:15] op_sel_hi:[1,0,1]
    v_lshlrev_b32 v164, 16, v46
    v_and_b32 v165, s60, v46
    v_pk_fma_f32 v[16:17], v[166:167], v[22:23], v[16:17] op_sel_hi:[1,0,1]
    v_lshlrev_b32 v166, 16, v47
    v_and_b32 v167, s60, v47
    v_pk_fma_f32 v[18:19], v[164:165], v[22:23], v[18:19] op_sel_hi:[1,0,1]
    v_pk_fma_f32 v[20:21], v[166:167], v[22:23], v[20:21] op_sel_hi:[1,0,1]
    buffer_load_dwordx4 v[44:47], v2, s[36:39], s56 offen offset:1024 nt
    s_waitcnt lgkmcnt(0)
    v_lshlrev_b32 v164, 16, v52
    v_and_b32 v165, s60, v52
    v_lshlrev_b32 v166, 16, v53
    v_and_b32 v167, s60, v53
    v_pk_fma_f32 v[14:15], v[164:165], v[26:27], v[14:15] op_sel_hi:[1,0,1]
    v_lshlrev_b32 v164, 16, v54
    v_and_b32 v165, s60, v54
    v_pk_fma_f32 v[16:17], v[166:167], v[26:27], v[16:17] op_sel_hi:[1,0,1]
    v_lshlrev_b32 v166, 16, v55
    v_and_b32 v167, s60, v55
    v_pk_fma_f32 v[18:19], v[164:165], v[26:27], v[18:19] op_sel_hi:[1,0,1]
    v_pk_fma_f32 v[20:21], v[166:167], v[26:27], v[20:21] op_sel_hi:[1,0,1]
    s_waitcnt vmcnt(4)
    s_cbranch_vccnz L_w146
    s_waitcnt vmcnt(2)
L_w146:
    v_lshlrev_b32 v164, 16, v48
    v_and_b32 v165, s60, v48
    v_lshlrev_b32 v166, 16, v49
    v_and_b32 v167, s60, v49
    v_pk_fma_f32 v[14:15], v[164:165], v[22:23], v[14:15] op_sel:[0,1,0] op_sel_hi:[1,1,1]
    v_lshlrev_b32 v164, 16, v50
    v_and_b32 v165, s60, v50
    v_pk_fma_f32 v[16:17], v[166:167], v[22:23], v[16:17] op_sel:[0,1,0] op_sel_hi:[1,1,1]
    v_lshlrev_b32 v166, 16, v51
    v_and_b32 v167, s60, v51
    v_pk_fma_f32 v[18:19], v[164:165], v[22:23], v[18:19] op_sel:[0,1,0] op_sel_hi:[1,1,1]
    v_pk_fma_f32 v[20:21], v[166:167], v[22:23], v[20:21] op_sel:[0,1,0] op_sel_hi:[1,1,1]
    buffer_load_dwordx4 v[48:51], v2, s[36:39], s56 offen offset:2048 nt
    v_lshlrev_b32 v164, 16, v56
    v_and_b32 v165, s60, v56
    v_lshlrev_b32 v166, 16, v57
    v_and_b32 v167, s60, v57
    v_pk_fma_f32 v[14:15], v[164:165], v[26:27], v[14:15] op_sel:[0,1,0] op_sel_hi:[1,1,1]
    v_lshlrev_b32 v164, 16, v58
    v_and_b32 v165, s60, v58
    v_pk_fma_f32 v[16:17], v[166:167], v[26:27], v[16:17] op_sel:[0,1,0] op_sel_hi:[1,1,1]
    v_lshlrev_b32 v166, 16, v59
    v_and_b32 v167, s60, v59
    v_pk_fma_f32 v[18:19], v[164:165], v[26:27], v[18:19] op_sel:[0,1,0] op_sel_hi:[1,1,1]
    v_pk_fma_f32 v[20:21], v[166:167], v[26:27], v[20:21] op_sel:[0,1,0] op_sel_hi:[1,1,1]
    s_waitcnt vmcnt(4)
    s_cbranch_vccnz L_w147
    s_waitcnt vmcnt(2)
L_w147:
    v_lshlrev_b32 v164, 16, v32
    v_and_b32 v165, s60, v32
    v_lshlrev_b32 v166, 16, v33
    v_and_b32 v167, s60, v33
    v_pk_fma_f32 v[14:15], v[164:165], v[24:25], v[14:15] op_sel_hi:[1,0,1]
    v_lshlrev_b32 v164, 16, v34
    v_and_b32 v165, s60, v34
    v_pk_fma_f32 v[16:17], v[166:167], v[24:25], v[16:17] op_sel_hi:[1,0,1]
    v_lshlrev_b32 v166, 16, v35
    v_and_b32 v167, s60, v35
    v_pk_fma_f32 v[18:19], v[164:165], v[24:25], v[18:19] op_sel_hi:[1,0,1]
    v_pk_fma_f32 v[20:21], v[166:167], v[24:25], v[20:21] op_sel_hi:[1,0,1]
    buffer_load_dwordx4 v[32:35], v2, s[36:39], s56 offen offset:3072 nt
    v_lshlrev_b32 v164, 16, v60
    v_and_b32 v165, s60, v60
    v_lshlrev_b32 v166, 16, v61
    v_and_b32 v167, s60, v61
    v_pk_fma_f32 v[14:15], v[164:165], v[28:29], v[14:15] op_sel_hi:[1,0,1]
    v_lshlrev_b32 v164, 16, v62
    v_and_b32 v165, s60, v62
    v_pk_fma_f32 v[16:17], v[166:167], v[28:29], v[16:17] op_sel_hi:[1,0,1]
    v_lshlrev_b32 v166, 16, v63
    v_and_b32 v167, s60, v63
    v_pk_fma_f32 v[18:19], v[164:165], v[28:29], v[18:19] op_sel_hi:[1,0,1]
    v_pk_fma_f32 v[20:21], v[166:167], v[28:29], v[20:21] op_sel_hi:[1,0,1]
    s_waitcnt vmcnt(4)
    s_cbranch_vccnz L_w148
    s_waitcnt vmcnt(2)
L_w148:
    v_lshlrev_b32 v164, 16, v36
    v_and_b32 v165, s60, v36
    v_lshlrev_b32 v166, 16, v37
    v_and_b32 v167, s60, v37
    v_pk_fma_f32 v[14:15], v[164:165], v[24:25], v[14:15] op_sel:[0,1,0] op_sel_hi:[1,1,1]
    v_lshlrev_b32 v164, 16, v38
    v_and_b32 v165, s60, v38
    v_pk_fma_f32 v[16:17], v[166:167], v[24:25], v[16:17] op_sel:[0,1,0] op_sel_hi:[1,1,1]
    v_lshlrev_b32 v166, 16, v39
    v_and_b32 v167, s60, v39
    v_pk_fma_f32 v[18:19], v[164:165], v[24:25], v[18:19] op_sel:[0,1,0] op_sel_hi:[1,1,1]
    v_pk_fma_f32 v[20:21], v[166:167], v[24:25], v[20:21] op_sel:[0,1,0] op_sel_hi:[1,1,1]
    s_add_u32 s56, s56, 65536
    buffer_load_dwordx4 v[36:39], v2, s[36:39], s56 offen offset:0 nt
    v_lshlrev_b32 v164, 16, v64
    v_and_b32 v165, s60, v64
    v_lshlrev_b32 v166, 16, v65
    v_and_b32 v167, s60, v65
    v_pk_fma_f32 v[14:15], v[164:165], v[28:29], v[14:15] op_sel:[0,1,0] op_sel_hi:[1,1,1]
    v_lshlrev_b32 v164, 16, v66
    v_and_b32 v165, s60, v66
    v_pk_fma_f32 v[16:17], v[166:167], v[28:29], v[16:17] op_sel:[0,1,0] op_sel_hi:[1,1,1]
    v_lshlrev_b32 v166, 16, v67
    v_and_b32 v167, s60, v67
    v_pk_fma_f32 v[18:19], v[164:165], v[28:29], v[18:19] op_sel:[0,1,0] op_sel_hi:[1,1,1]
    v_pk_fma_f32 v[20:21], v[166:167], v[28:29], v[20:21] op_sel:[0,1,0] op_sel_hi:[1,1,1]
    s_waitcnt lgkmcnt(0)
    s_cmp_lg_u32 s16, 0
    s_cselect_b64 vcc, -1, 0
    s_subb_u32 s16, s16, 0
    ds_read_b128 v[26:29], v13 offset:64
    ds_read_b128 v[22:25], v13 offset:320
    s_waitcnt vmcnt(4)
    s_cbranch_vccnz L_w149
    s_waitcnt vmcnt(2)
L_w149:
    s_cmp_eq_u32 s21, 0
    s_cbranch_scc1 L_w150
    s_waitcnt vmcnt(1)
    s_sub_u32 s21, s21, 1
L_w150:
    s_barrier
    v_lshlrev_b32 v164, 16, v40
    v_and_b32 v165, s60, v40
    v_lshlrev_b32 v166, 16, v41
    v_and_b32 v167, s60, v41
    v_pk_fma_f32 v[14:15], v[164:165], v[8:9], v[14:15] op_sel_hi:[1,0,1]
    v_lshlrev_b32 v164, 16, v42
    v_and_b32 v165, s60, v42
    v_pk_fma_f32 v[16:17], v[166:167], v[8:9], v[16:17] op_sel_hi:[1,0,1]
    v_lshlrev_b32 v166, 16, v43
    v_and_b32 v167, s60, v43
    v_pk_fma_f32 v[18:19], v[164:165], v[8:9], v[18:19] op_sel_hi:[1,0,1]
    v_pk_fma_f32 v[20:21], v[166:167], v[8:9], v[20:21] op_sel_hi:[1,0,1]
    buffer_load_dwordx4 v[40:43], v2, s[36:39], s56 offen offset:1024 nt
    s_waitcnt lgkmcnt(0)
    v_lshlrev_b32 v164, 16, v68
    v_and_b32 v165, s60, v68
    v_lshlrev_b32 v166, 16, v69
    v_and_b32 v167, s60, v69
    v_pk_fma_f32 v[14:15], v[164:165], v[26:27], v[14:15] op_sel_hi:[1,0,1]
    v_lshlrev_b32 v164, 16, v70
    v_and_b32 v165, s60, v70
    v_pk_fma_f32 v[16:17], v[166:167], v[26:27], v[16:17] op_sel_hi:[1,0,1]
    v_lshlrev_b32 v166, 16, v71
    v_and_b32 v167, s60, v71
    v_pk_fma_f32 v[18:19], v[164:165], v[26:27], v[18:19] op_sel_hi:[1,0,1]
    v_pk_fma_f32 v[20:21], v[166:167], v[26:27], v[20:21] op_sel_hi:[1,0,1]
    s_waitcnt vmcnt(4)
    s_cbranch_vccnz L_w151
    s_waitcnt vmcnt(2)
L_w151:
    v_lshlrev_b32 v164, 16, v44
    v_and_b32 v165, s60, v44
    v_lshlrev_b32 v166, 16, v45
    v_and_b32 v167, s60, v45
    v_pk_fma_f32 v[14:15], v[164:165], v[8:9], v[14:15] op_sel:[0,1,0] op_sel_hi:[1,1,1]
    v_lshlrev_b32 v164, 16, v46
    v_and_b32 v165, s60, v46
    v_pk_fma_f32 v[16:17], v[166:167], v[8:9], v[16:17] op_sel:[0,1,0] op_sel_hi:[1,1,1]
    v_lshlrev_b32 v166, 16, v47
    v_and_b32 v167, s60, v47
    v_pk_fma_f32 v[18:19], v[164:165], v[8:9], v[18:19] op_sel:[0,1,0] op_sel_hi:[1,1,1]
    v_pk_fma_f32 v[20:21], v[166:167], v[8:9], v[20:21] op_sel:[0,1,0] op_sel_hi:[1,1,1]
    buffer_load_dwordx4 v[44:47], v2, s[36:39], s56 offen offset:2048 nt
    v_lshlrev_b32 v164, 16, v72
    v_and_b32 v165, s60, v72
    v_lshlrev_b32 v166, 16, v73
    v_and_b32 v167, s60, v73
    v_pk_fma_f32 v[14:15], v[164:165], v[26:27], v[14:15] op_sel:[0,1,0] op_sel_hi:[1,1,1]
    v_lshlrev_b32 v164, 16, v74
    v_and_b32 v165, s60, v74
    v_pk_fma_f32 v[16:17], v[166:167], v[26:27], v[16:17] op_sel:[0,1,0] op_sel_hi:[1,1,1]
    v_lshlrev_b32 v166, 16, v75
    v_and_b32 v167, s60, v75
    v_pk_fma_f32 v[18:19], v[164:165], v[26:27], v[18:19] op_sel:[0,1,0] op_sel_hi:[1,1,1]
    v_pk_fma_f32 v[20:21], v[166:167], v[26:27], v[20:21] op_sel:[0,1,0] op_sel_hi:[1,1,1]
    s_waitcnt vmcnt(4)
    s_cbranch_vccnz L_w152
    s_waitcnt vmcnt(2)
L_w152:
    v_lshlrev_b32 v164, 16, v48
    v_and_b32 v165, s60, v48
    v_lshlrev_b32 v166, 16, v49
    v_and_b32 v167, s60, v49
    v_pk_fma_f32 v[14:15], v[164:165], v[10:11], v[14:15] op_sel_hi:[1,0,1]
    v_lshlrev_b32 v164, 16, v50
    v_and_b32 v165, s60, v50
    v_pk_fma_f32 v[16:17], v[166:167], v[10:11], v[16:17] op_sel_hi:[1,0,1]
    v_lshlrev_b32 v166, 16, v51
    v_and_b32 v167, s60, v51
    v_pk_fma_f32 v[18:19], v[164:165], v[10:11], v[18:19] op_sel_hi:[1,0,1]
    v_pk_fma_f32 v[20:21], v[166:167], v[10:11], v[20:21] op_sel_hi:[1,0,1]
    buffer_load_dwordx4 v[48:51], v2, s[36:39], s56 offen offset:3072 nt
    v_lshlrev_b32 v164, 16, v76
    v_and_b32 v165, s60, v76
    v_lshlrev_b32 v166, 16, v77
    v_and_b32 v167, s60, v77
    v_pk_fma_f32 v[14:15], v[164:165], v[28:29], v[14:15] op_sel_hi:[1,0,1]
    v_lshlrev_b32 v164, 16, v78
    v_and_b32 v165, s60, v78
    v_pk_fma_f32 v[16:17], v[166:167], v[28:29], v[16:17] op_sel_hi:[1,0,1]
    v_lshlrev_b32 v166, 16, v79
    v_and_b32 v167, s60, v79
    v_pk_fma_f32 v[18:19], v[164:165], v[28:29], v[18:19] op_sel_hi:[1,0,1]
    v_pk_fma_f32 v[20:21], v[166:167], v[28:29], v[20:21] op_sel_hi:[1,0,1]
    s_waitcnt vmcnt(4)
    s_cbranch_vccnz L_w153
    s_waitcnt vmcnt(2)
L_w153:
    v_lshlrev_b32 v164, 16, v32
    v_and_b32 v165, s60, v32
    v_lshlrev_b32 v166, 16, v33
    v_and_b32 v167, s60, v33
    v_pk_fma_f32 v[14:15], v[164:165], v[10:11], v[14:15] op_sel:[0,1,0] op_sel_hi:[1,1,1]
    v_lshlrev_b32 v164, 16, v34
    v_and_b32 v165, s60, v34
    v_pk_fma_f32 v[16:17], v[166:167], v[10:11], v[16:17] op_sel:[0,1,0] op_sel_hi:[1,1,1]
    v_lshlrev_b32 v166, 16, v35
    v_and_b32 v167, s60, v35
    v_pk_fma_f32 v[18:19], v[164:165], v[10:11], v[18:19] op_sel:[0,1,0] op_sel_hi:[1,1,1]
    v_pk_fma_f32 v[20:21], v[166:167], v[10:11], v[20:21] op_sel:[0,1,0] op_sel_hi:[1,1,1]
    s_add_u32 s56, s56, 65536
    buffer_load_dwordx4 v[32:35], v2, s[36:39], s56 offen offset:0 nt
    v_lshlrev_b32 v164, 16, v80
    v_and_b32 v165, s60, v80
    v_lshlrev_b32 v166, 16, v81
    v_and_b32 v167, s60, v81
    v_pk_fma_f32 v[14:15], v[164:165], v[28:29], v[14:15] op_sel:[0,1,0] op_sel_hi:[1,1,1]
    v_lshlrev_b32 v164, 16, v82
    v_and_b32 v165, s60, v82
    v_pk_fma_f32 v[16:17], v[166:167], v[28:29], v[16:17] op_sel:[0,1,0] op_sel_hi:[1,1,1]
    v_lshlrev_b32 v166, 16, v83
    v_and_b32 v167, s60, v83
    v_pk_fma_f32 v[18:19], v[164:165], v[28:29], v[18:19] op_sel:[0,1,0] op_sel_hi:[1,1,1]
    v_pk_fma_f32 v[20:21], v[166:167], v[28:29], v[20:21] op_sel:[0,1,0] op_sel_hi:[1,1,1]
    s_waitcnt lgkmcnt(0)
    s_cmp_lg_u32 s16, 0
    s_cselect_b64 vcc, -1, 0
    s_subb_u32 s16, s16, 0
    ds_read_b128 v[26:29], v13 offset:128
    ds_read_b128 v[8:11], v13 offset:384
    s_waitcnt vmcnt(4)
    s_cbranch_vccnz L_w154
    s_waitcnt vmcnt(2)
L_w154:
    s_cmp_eq_u32 s21, 0
    s_cbranch_scc1 L_w155
    s_waitcnt vmcnt(1)
    s_sub_u32 s21, s21, 1
L_w155:
    s_barrier
    v_lshlrev_b32 v164, 16, v36
    v_and_b32 v165, s60, v36
    v_lshlrev_b32 v166, 16, v37
    v_and_b32 v167, s60, v37
    v_pk_fma_f32 v[14:15], v[164:165], v[22:23], v[14:15] op_sel_hi:[1,0,1]
    v_lshlrev_b32 v164, 16, v38
    v_and_b32 v165, s60, v38
    v_pk_fma_f32 v[16:17], v[166:167], v[22:23], v[16:17] op_sel_hi:[1,0,1]
    v_lshlrev_b32 v166, 16, v39
    v_and_b32 v167, s60, v39
    v_pk_fma_f32 v[18:19], v[164:165], v[22:23], v[18:19] op_sel_hi:[1,0,1]
    v_pk_fma_f32 v[20:21], v[166:167], v[22:23], v[20:21] op_sel_hi:[1,0,1]
    buffer_load_dwordx4 v[36:39], v2, s[36:39], s56 offen offset:1024 nt
    s_waitcnt lgkmcnt(0)
    v_lshlrev_b32 v164, 16, v84
    v_and_b32 v165, s60, v84
    v_lshlrev_b32 v166, 16, v85
    v_and_b32 v167, s60, v85
    v_pk_fma_f32 v[14:15], v[164:165], v[26:27], v[14:15] op_sel_hi:[1,0,1]
    v_lshlrev_b32 v164, 16, v86
    v_and_b32 v165, s60, v86
    v_pk_fma_f32 v[16:17], v[166:167], v[26:27], v[16:17] op_sel_hi:[1,0,1]
    v_lshlrev_b32 v166, 16, v87
    v_and_b32 v167, s60, v87
    v_pk_fma_f32 v[18:19], v[164:165], v[26:27], v[18:19] op_sel_hi:[1,0,1]
    v_pk_fma_f32 v[20:21], v[166:167], v[26:27], v[20:21] op_sel_hi:[1,0,1]
    s_waitcnt vmcnt(4)
    s_cbranch_vccnz L_w156
    s_waitcnt vmcnt(2)
L_w156:
    v_lshlrev_b32 v164, 16, v40
    v_and_b32 v165, s60, v40
    v_lshlrev_b32 v166, 16, v41
    v_and_b32 v167, s60, v41
    v_pk_fma_f32 v[14:15], v[164:165], v[22:23], v[14:15] op_sel:[0,1,0] op_sel_hi:[1,1,1]
    v_lshlrev_b32 v164, 16, v42
    v_and_b32 v165, s60, v42
    v_pk_fma_f32 v[16:17], v[166:167], v[22:23], v[16:17] op_sel:[0,1,0] op_sel_hi:[1,1,1]
    v_lshlrev_b32 v166, 16, v43
    v_and_b32 v167, s60, v43
    v_pk_fma_f32 v[18:19], v[164:165], v[22:23], v[18:19] op_sel:[0,1,0] op_sel_hi:[1,1,1]
    v_pk_fma_f32 v[20:21], v[166:167], v[22:23], v[20:21] op_sel:[0,1,0] op_sel_hi:[1,1,1]
    buffer_load_dwordx4 v[40:43], v2, s[36:39], s56 offen offset:2048 nt
    v_lshlrev_b32 v164, 16, v88
    v_and_b32 v165, s60, v88
    v_lshlrev_b32 v166, 16, v89
    v_and_b32 v167, s60, v89
    v_pk_fma_f32 v[14:15], v[164:165], v[26:27], v[14:15] op_sel:[0,1,0] op_sel_hi:[1,1,1]
    v_lshlrev_b32 v164, 16, v90
    v_and_b32 v165, s60, v90
    v_pk_fma_f32 v[16:17], v[166:167], v[26:27], v[16:17] op_sel:[0,1,0] op_sel_hi:[1,1,1]
    v_lshlrev_b32 v166, 16, v91
    v_and_b32 v167, s60, v91
    v_pk_fma_f32 v[18:19], v[164:165], v[26:27], v[18:19] op_sel:[0,1,0] op_sel_hi:[1,1,1]
    v_pk_fma_f32 v[20:21], v[166:167], v[26:27], v[20:21] op_sel:[0,1,0] op_sel_hi:[1,1,1]
    s_waitcnt vmcnt(4)
    s_cbranch_vccnz L_w157
    s_waitcnt vmcnt(2)
L_w157:
    v_lshlrev_b32 v164, 16, v44
    v_and_b32 v165, s60, v44
    v_lshlrev_b32 v166, 16, v45
    v_and_b32 v167, s60, v45
    v_pk_fma_f32 v[14:15], v[164:165], v[24:25], v[14:15] op_sel_hi:[1,0,1]
    v_lshlrev_b32 v164, 16, v46
    v_and_b32 v165, s60, v46
    v_pk_fma_f32 v[16:17], v[166:167], v[24:25], v[16:17] op_sel_hi:[1,0,1]
    v_lshlrev_b32 v166, 16, v47
    v_and_b32 v167, s60, v47
    v_pk_fma_f32 v[18:19], v[164:165], v[24:25], v[18:19] op_sel_hi:[1,0,1]
    v_pk_fma_f32 v[20:21], v[166:167], v[24:25], v[20:21] op_sel_hi:[1,0,1]
    buffer_load_dwordx4 v[44:47], v2, s[36:39], s56 offen offset:3072 nt
    v_lshlrev_b32 v164, 16, v92
    v_and_b32 v165, s60, v92
    v_lshlrev_b32 v166, 16, v93
    v_and_b32 v167, s60, v93
    v_pk_fma_f32 v[14:15], v[164:165], v[28:29], v[14:15] op_sel_hi:[1,0,1]
    v_lshlrev_b32 v164, 16, v94
    v_and_b32 v165, s60, v94
    v_pk_fma_f32 v[16:17], v[166:167], v[28:29], v[16:17] op_sel_hi:[1,0,1]
    v_lshlrev_b32 v166, 16, v95
    v_and_b32 v167, s60, v95
    v_pk_fma_f32 v[18:19], v[164:165], v[28:29], v[18:19] op_sel_hi:[1,0,1]
    v_pk_fma_f32 v[20:21], v[166:167], v[28:29], v[20:21] op_sel_hi:[1,0,1]
    s_waitcnt vmcnt(4)
    s_cbranch_vccnz L_w158
    s_waitcnt vmcnt(2)
L_w158:
    v_lshlrev_b32 v164, 16, v48
    v_and_b32 v165, s60, v48
    v_lshlrev_b32 v166, 16, v49
    v_and_b32 v167, s60, v49
    v_pk_fma_f32 v[14:15], v[164:165], v[24:25], v[14:15] op_sel:[0,1,0] op_sel_hi:[1,1,1]
    v_lshlrev_b32 v164, 16, v50
    v_and_b32 v165, s60, v50
    v_pk_fma_f32 v[16:17], v[166:167], v[24:25], v[16:17] op_sel:[0,1,0] op_sel_hi:[1,1,1]
    v_lshlrev_b32 v166, 16, v51
    v_and_b32 v167, s60, v51
    v_pk_fma_f32 v[18:19], v[164:165], v[24:25], v[18:19] op_sel:[0,1,0] op_sel_hi:[1,1,1]
    v_pk_fma_f32 v[20:21], v[166:167], v[24:25], v[20:21] op_sel:[0,1,0] op_sel_hi:[1,1,1]
    s_add_u32 s56, s56, 65536
    buffer_load_dwordx4 v[48:51], v2, s[36:39], s56 offen offset:0 nt
    v_lshlrev_b32 v164, 16, v96
    v_and_b32 v165, s60, v96
    v_lshlrev_b32 v166, 16, v97
    v_and_b32 v167, s60, v97
    v_pk_fma_f32 v[14:15], v[164:165], v[28:29], v[14:15] op_sel:[0,1,0] op_sel_hi:[1,1,1]
    v_lshlrev_b32 v164, 16, v98
    v_and_b32 v165, s60, v98
    v_pk_fma_f32 v[16:17], v[166:167], v[28:29], v[16:17] op_sel:[0,1,0] op_sel_hi:[1,1,1]
    v_lshlrev_b32 v166, 16, v99
    v_and_b32 v167, s60, v99
    v_pk_fma_f32 v[18:19], v[164:165], v[28:29], v[18:19] op_sel:[0,1,0] op_sel_hi:[1,1,1]
    v_pk_fma_f32 v[20:21], v[166:167], v[28:29], v[20:21] op_sel:[0,1,0] op_sel_hi:[1,1,1]
    s_waitcnt lgkmcnt(0)
    s_cmp_lg_u32 s16, 0
    s_cselect_b64 vcc, -1, 0
    s_subb_u32 s16, s16, 0
    ds_read_b128 v[22:25], v13 offset:448
    s_waitcnt vmcnt(4)
    s_cbranch_vccnz L_w159
    s_waitcnt vmcnt(2)
L_w159:
    s_cmp_eq_u32 s21, 0
    s_cbranch_scc1 L_w160
    s_waitcnt vmcnt(1)
    s_sub_u32 s21, s21, 1
L_w160:
    s_barrier
    v_lshlrev_b32 v164, 16, v32
    v_and_b32 v165, s60, v32
    v_lshlrev_b32 v166, 16, v33
    v_and_b32 v167, s60, v33
    v_pk_fma_f32 v[14:15], v[164:165], v[8:9], v[14:15] op_sel_hi:[1,0,1]
    v_lshlrev_b32 v164, 16, v34
    v_and_b32 v165, s60, v34
    v_pk_fma_f32 v[16:17], v[166:167], v[8:9], v[16:17] op_sel_hi:[1,0,1]
    v_lshlrev_b32 v166, 16, v35
    v_and_b32 v167, s60, v35
    v_pk_fma_f32 v[18:19], v[164:165], v[8:9], v[18:19] op_sel_hi:[1,0,1]
    v_pk_fma_f32 v[20:21], v[166:167], v[8:9], v[20:21] op_sel_hi:[1,0,1]
    buffer_load_dwordx4 v[32:35], v2, s[36:39], s56 offen offset:1024 nt
    s_waitcnt vmcnt(4)
    s_cbranch_vccnz L_w161
    s_waitcnt vmcnt(2)
L_w161:
    v_lshlrev_b32 v164, 16, v36
    v_and_b32 v165, s60, v36
    v_lshlrev_b32 v166, 16, v37
    v_and_b32 v167, s60, v37
    v_pk_fma_f32 v[14:15], v[164:165], v[8:9], v[14:15] op_sel:[0,1,0] op_sel_hi:[1,1,1]
    v_lshlrev_b32 v164, 16, v38
    v_and_b32 v165, s60, v38
    v_pk_fma_f32 v[16:17], v[166:167], v[8:9], v[16:17] op_sel:[0,1,0] op_sel_hi:[1,1,1]
    v_lshlrev_b32 v166, 16, v39
    v_and_b32 v167, s60, v39
    v_pk_fma_f32 v[18:19], v[164:165], v[8:9], v[18:19] op_sel:[0,1,0] op_sel_hi:[1,1,1]
    v_pk_fma_f32 v[20:21], v[166:167], v[8:9], v[20:21] op_sel:[0,1,0] op_sel_hi:[1,1,1]
    buffer_load_dwordx4 v[36:39], v2, s[36:39], s56 offen offset:2048 nt
    s_waitcnt vmcnt(4)
    s_cbranch_vccnz L_w162
    s_waitcnt vmcnt(2)
L_w162:
    v_lshlrev_b32 v164, 16, v40
    v_and_b32 v165, s60, v40
    v_lshlrev_b32 v166, 16, v41
    v_and_b32 v167, s60, v41
    v_pk_fma_f32 v[14:15], v[164:165], v[10:11], v[14:15] op_sel_hi:[1,0,1]
    v_lshlrev_b32 v164, 16, v42
    v_and_b32 v165, s60, v42
    v_pk_fma_f32 v[16:17], v[166:167], v[10:11], v[16:17] op_sel_hi:[1,0,1]
    v_lshlrev_b32 v166, 16, v43
    v_and_b32 v167, s60, v43
    v_pk_fma_f32 v[18:19], v[164:165], v[10:11], v[18:19] op_sel_hi:[1,0,1]
    v_pk_fma_f32 v[20:21], v[166:167], v[10:11], v[20:21] op_sel_hi:[1,0,1]
    buffer_load_dwordx4 v[40:43], v2, s[36:39], s56 offen offset:3072 nt
    s_waitcnt vmcnt(4)
    s_cbranch_vccnz L_w163
    s_waitcnt vmcnt(2)
L_w163:
    v_lshlrev_b32 v164, 16, v44
    v_and_b32 v165, s60, v44
    v_lshlrev_b32 v166, 16, v45
    v_and_b32 v167, s60, v45
    v_pk_fma_f32 v[14:15], v[164:165], v[10:11], v[14:15] op_sel:[0,1,0] op_sel_hi:[1,1,1]
    v_lshlrev_b32 v164, 16, v46
    v_and_b32 v165, s60, v46
    v_pk_fma_f32 v[16:17], v[166:167], v[10:11], v[16:17] op_sel:[0,1,0] op_sel_hi:[1,1,1]
    v_lshlrev_b32 v166, 16, v47
    v_and_b32 v167, s60, v47
    v_pk_fma_f32 v[18:19], v[164:165], v[10:11], v[18:19] op_sel:[0,1,0] op_sel_hi:[1,1,1]
    v_pk_fma_f32 v[20:21], v[166:167], v[10:11], v[20:21] op_sel:[0,1,0] op_sel_hi:[1,1,1]
    s_add_u32 s56, s56, 65536
    buffer_load_dwordx4 v[44:47], v2, s[36:39], s56 offen offset:0 nt
    v_perm_b32 v12, v104, v100, s14
    v_perm_b32 v104, v104, v100, s15
    v_perm_b32 v100, v105, v101, s14
    v_perm_b32 v105, v105, v101, s15
    v_perm_b32 v101, v106, v102, s14
    v_perm_b32 v106, v106, v102, s15
    v_perm_b32 v102, v107, v103, s14
    v_perm_b32 v107, v107, v103, s15
    v_perm_b32 v103, v112, v108, s14
    v_perm_b32 v112, v112, v108, s15
    v_perm_b32 v108, v113, v109, s14
    v_perm_b32 v113, v113, v109, s15
    v_perm_b32 v109, v114, v110, s14
    v_perm_b32 v114, v114, v110, s15
    v_perm_b32 v110, v115, v111, s14
    v_perm_b32 v115, v115, v111, s15
    v_perm_b32 v111, v120, v116, s14
    v_perm_b32 v120, v120, v116, s15
    v_perm_b32 v116, v121, v117, s14
    v_perm_b32 v121, v121, v117, s15
    v_perm_b32 v117, v122, v118, s14
    v_perm_b32 v122, v122, v118, s15
    v_perm_b32 v118, v123, v119, s14
    v_perm_b32 v123, v123, v119, s15
    v_perm_b32 v119, v128, v124, s14
    v_perm_b32 v128, v128, v124, s15
    v_perm_b32 v124, v129, v125, s14
    v_perm_b32 v129, v129, v125, s15
    v_perm_b32 v125, v130, v126, s14
    v_perm_b32 v130, v130, v126, s15
    v_perm_b32 v126, v131, v127, s14
    v_perm_b32 v131, v131, v127, s15
    s_waitcnt lgkmcnt(0)
    s_cmp_lg_u32 s16, 0
    s_cselect_b64 vcc, -1, 0
    s_subb_u32 s16, s16, 0
    ds_read_b128 v[8:11], v13 offset:512
    s_waitcnt vmcnt(4)
    s_cbranch_vccnz L_w164
    s_waitcnt vmcnt(2)
L_w164:
    s_cmp_eq_u32 s21, 0
    s_cbranch_scc1 L_w165
    s_waitcnt vmcnt(1)
    s_sub_u32 s21, s21, 1
L_w165:
    s_barrier
    ds_read_b32 v31, v4 offset:12568
    v_lshlrev_b32 v164, 16, v48
    v_and_b32 v165, s60, v48
    v_lshlrev_b32 v166, 16, v49
    v_and_b32 v167, s60, v49
    v_pk_fma_f32 v[14:15], v[164:165], v[22:23], v[14:15] op_sel_hi:[1,0,1]
    v_lshlrev_b32 v164, 16, v50
    v_and_b32 v165, s60, v50
    v_pk_fma_f32 v[16:17], v[166:167], v[22:23], v[16:17] op_sel_hi:[1,0,1]
    v_lshlrev_b32 v166, 16, v51
    v_and_b32 v167, s60, v51
    v_pk_fma_f32 v[18:19], v[164:165], v[22:23], v[18:19] op_sel_hi:[1,0,1]
    v_pk_fma_f32 v[20:21], v[166:167], v[22:23], v[20:21] op_sel_hi:[1,0,1]
    buffer_load_dwordx4 v[48:51], v2, s[36:39], s56 offen offset:1024 nt
    s_waitcnt vmcnt(4)
    s_cbranch_vccnz L_w166
    s_waitcnt vmcnt(2)
L_w166:
    v_lshlrev_b32 v164, 16, v32
    v_and_b32 v165, s60, v32
    v_lshlrev_b32 v166, 16, v33
    v_and_b32 v167, s60, v33
    v_pk_fma_f32 v[14:15], v[164:165], v[22:23], v[14:15] op_sel:[0,1,0] op_sel_hi:[1,1,1]
    v_lshlrev_b32 v164, 16, v34
    v_and_b32 v165, s60, v34
    v_pk_fma_f32 v[16:17], v[166:167], v[22:23], v[16:17] op_sel:[0,1,0] op_sel_hi:[1,1,1]
    v_lshlrev_b32 v166, 16, v35
    v_and_b32 v167, s60, v35
    v_pk_fma_f32 v[18:19], v[164:165], v[22:23], v[18:19] op_sel:[0,1,0] op_sel_hi:[1,1,1]
    v_pk_fma_f32 v[20:21], v[166:167], v[22:23], v[20:21] op_sel:[0,1,0] op_sel_hi:[1,1,1]
    buffer_load_dwordx4 v[32:35], v2, s[36:39], s56 offen offset:2048 nt
    s_waitcnt vmcnt(4)
    s_cbranch_vccnz L_w167
    s_waitcnt vmcnt(2)
L_w167:
    s_waitcnt lgkmcnt(0)
    v_readfirstlane_b32 s23, v31
    s_mov_b32 s22, -1
    s_cmp_lg_u32 s3, 0
    s_cbranch_scc1 L_m36
    s_cmp_eq_u32 s23, 0
    s_cbranch_scc1 L_m36
    s_mov_b32 s22, 1
    s_atomic_add s22, s[64:65], 16384 glc
L_m36:
    v_lshlrev_b32 v164, 16, v36
    v_and_b32 v165, s60, v36
    v_lshlrev_b32 v166, 16, v37
    v_and_b32 v167, s60, v37
    v_pk_fma_f32 v[14:15], v[164:165], v[24:25], v[14:15] op_sel_hi:[1,0,1]
    v_lshlrev_b32 v164, 16, v38
    v_and_b32 v165, s60, v38
    v_pk_fma_f32 v[16:17], v[166:167], v[24:25], v[16:17] op_sel_hi:[1,0,1]
    v_lshlrev_b32 v166, 16, v39
    v_and_b32 v167, s60, v39
    v_pk_fma_f32 v[18:19], v[164:165], v[24:25], v[18:19] op_sel_hi:[1,0,1]
    v_pk_fma_f32 v[20:21], v[166:167], v[24:25], v[20:21] op_sel_hi:[1,0,1]
    buffer_load_dwordx4 v[36:39], v2, s[36:39], s56 offen offset:3072 nt
    s_waitcnt vmcnt(4)
    s_cbranch_vccnz L_w168
    s_waitcnt vmcnt(2)
L_w168:
    v_lshlrev_b32 v164, 16, v40
    v_and_b32 v165, s60, v40
    v_lshlrev_b32 v166, 16, v41
    v_and_b32 v167, s60, v41
    v_pk_fma_f32 v[14:15], v[164:165], v[24:25], v[14:15] op_sel:[0,1,0] op_sel_hi:[1,1,1]
    v_lshlrev_b32 v164, 16, v42
    v_and_b32 v165, s60, v42
    v_pk_fma_f32 v[16:17], v[166:167], v[24:25], v[16:17] op_sel:[0,1,0] op_sel_hi:[1,1,1]
    v_lshlrev_b32 v166, 16, v43
    v_and_b32 v167, s60, v43
    v_pk_fma_f32 v[18:19], v[164:165], v[24:25], v[18:19] op_sel:[0,1,0] op_sel_hi:[1,1,1]
    v_pk_fma_f32 v[20:21], v[166:167], v[24:25], v[20:21] op_sel:[0,1,0] op_sel_hi:[1,1,1]
    s_add_u32 s56, s56, 65536
    buffer_load_dwordx4 v[40:43], v2, s[36:39], s56 offen offset:0 nt
    v_perm_b32 v127, v136, v132, s14
    v_perm_b32 v136, v136, v132, s15
    v_perm_b32 v132, v137, v133, s14
    v_perm_b32 v137, v137, v133, s15
    v_perm_b32 v133, v138, v134, s14
    v_perm_b32 v138, v138, v134, s15
    v_perm_b32 v134, v139, v135, s14
    v_perm_b32 v139, v139, v135, s15
    v_perm_b32 v135, v144, v140, s14
    v_perm_b32 v144, v144, v140, s15
    v_perm_b32 v140, v145, v141, s14
    v_perm_b32 v145, v145, v141, s15
    v_perm_b32 v141, v146, v142, s14
    v_perm_b32 v146, v146, v142, s15
    v_perm_b32 v142, v147, v143, s14
    v_perm_b32 v147, v147, v143, s15
    v_perm_b32 v143, v152, v148, s14
    v_perm_b32 v152, v152, v148, s15
    v_perm_b32 v148, v153, v149, s14
    v_perm_b32 v153, v153, v149, s15
    v_perm_b32 v149, v154, v150, s14
    v_perm_b32 v154, v154, v150, s15
    v_perm_b32 v150, v155, v151, s14
    v_perm_b32 v155, v155, v151, s15
    v_perm_b32 v151, v160, v156, s14
    v_perm_b32 v160, v160, v156, s15
    v_perm_b32 v156, v161, v157, s14
    v_perm_b32 v161, v161, v157, s15
    v_perm_b32 v157, v162, v158, s14
    v_perm_b32 v162, v162, v158, s15
    v_perm_b32 v158, v163, v159, s14
    v_perm_b32 v163, v163, v159, s15
    s_cmp_lg_u32 s16, 0
    s_cselect_b64 vcc, -1, 0
    s_subb_u32 s16, s16, 0
    ds_read_b128 v[22:25], v13 offset:576
    s_waitcnt vmcnt(4)
    s_cbranch_vccnz L_w169
    s_waitcnt vmcnt(2)
L_w169:
    s_cmp_eq_u32 s21, 0
    s_cbranch_scc1 L_w170
    s_waitcnt vmcnt(1)
    s_sub_u32 s21, s21, 1
L_w170:
    s_barrier
    v_lshlrev_b32 v164, 16, v44
    v_and_b32 v165, s60, v44
    v_lshlrev_b32 v166, 16, v45
    v_and_b32 v167, s60, v45
    v_pk_fma_f32 v[14:15], v[164:165], v[8:9], v[14:15] op_sel_hi:[1,0,1]
    v_lshlrev_b32 v164, 16, v46
    v_and_b32 v165, s60, v46
    v_pk_fma_f32 v[16:17], v[166:167], v[8:9], v[16:17] op_sel_hi:[1,0,1]
    v_lshlrev_b32 v166, 16, v47
    v_and_b32 v167, s60, v47
    v_pk_fma_f32 v[18:19], v[164:165], v[8:9], v[18:19] op_sel_hi:[1,0,1]
    v_pk_fma_f32 v[20:21], v[166:167], v[8:9], v[20:21] op_sel_hi:[1,0,1]
    buffer_load_dwordx4 v[44:47], v2, s[36:39], s56 offen offset:1024 nt
    s_waitcnt vmcnt(4)
    s_cbranch_vccnz L_w171
    s_waitcnt vmcnt(2)
L_w171:
    v_lshlrev_b32 v164, 16, v48
    v_and_b32 v165, s60, v48
    v_lshlrev_b32 v166, 16, v49
    v_and_b32 v167, s60, v49
    v_pk_fma_f32 v[14:15], v[164:165], v[8:9], v[14:15] op_sel:[0,1,0] op_sel_hi:[1,1,1]
    v_lshlrev_b32 v164, 16, v50
    v_and_b32 v165, s60, v50
    v_pk_fma_f32 v[16:17], v[166:167], v[8:9], v[16:17] op_sel:[0,1,0] op_sel_hi:[1,1,1]
    v_lshlrev_b32 v166, 16, v51
    v_and_b32 v167, s60, v51
    v_pk_fma_f32 v[18:19], v[164:165], v[8:9], v[18:19] op_sel:[0,1,0] op_sel_hi:[1,1,1]
    v_pk_fma_f32 v[20:21], v[166:167], v[8:9], v[20:21] op_sel:[0,1,0] op_sel_hi:[1,1,1]
    buffer_load_dwordx4 v[48:51], v2, s[36:39], s56 offen offset:2048 nt
    s_waitcnt vmcnt(4)
    s_cbranch_vccnz L_w172
    s_waitcnt vmcnt(2)
L_w172:
    v_lshlrev_b32 v164, 16, v32
    v_and_b32 v165, s60, v32
    v_lshlrev_b32 v166, 16, v33
    v_and_b32 v167, s60, v33
    v_pk_fma_f32 v[14:15], v[164:165], v[10:11], v[14:15] op_sel_hi:[1,0,1]
    v_lshlrev_b32 v164, 16, v34
    v_and_b32 v165, s60, v34
    v_pk_fma_f32 v[16:17], v[166:167], v[10:11], v[16:17] op_sel_hi:[1,0,1]
    v_lshlrev_b32 v166, 16, v35
    v_and_b32 v167, s60, v35
    v_pk_fma_f32 v[18:19], v[164:165], v[10:11], v[18:19] op_sel_hi:[1,0,1]
    v_pk_fma_f32 v[20:21], v[166:167], v[10:11], v[20:21] op_sel_hi:[1,0,1]
    buffer_load_dwordx4 v[32:35], v2, s[36:39], s56 offen offset:3072 nt
    s_waitcnt vmcnt(4)
    s_cbranch_vccnz L_w173
    s_waitcnt vmcnt(2)
L_w173:
    v_lshlrev_b32 v164, 16, v36
    v_and_b32 v165, s60, v36
    v_lshlrev_b32 v166, 16, v37
    v_and_b32 v167, s60, v37
    v_pk_fma_f32 v[14:15], v[164:165], v[10:11], v[14:15] op_sel:[0,1,0] op_sel_hi:[1,1,1]
    v_lshlrev_b32 v164, 16, v38
    v_and_b32 v165, s60, v38
    v_pk_fma_f32 v[16:17], v[166:167], v[10:11], v[16:17] op_sel:[0,1,0] op_sel_hi:[1,1,1]
    v_lshlrev_b32 v166, 16, v39
    v_and_b32 v167, s60, v39
    v_pk_fma_f32 v[18:19], v[164:165], v[10:11], v[18:19] op_sel:[0,1,0] op_sel_hi:[1,1,1]
    v_pk_fma_f32 v[20:21], v[166:167], v[10:11], v[20:21] op_sel:[0,1,0] op_sel_hi:[1,1,1]
    s_add_u32 s56, s56, 65536
    buffer_load_dwordx4 v[36:39], v2, s[36:39], s56 offen offset:0 nt
    s_waitcnt lgkmcnt(0)
    s_cmp_lg_u32 s3, 0
    s_cbranch_scc1 L_h38
    s_add_u32 s22, s22, 1
    s_min_u32 s22, s22, 15
    s_lshl_b32 s22, s22, 2
    s_mov_b32 s24, 0xabcd
    s_mov_b32 s25, 0x75310000
    s_lshr_b64 s[24:25], s[24:25], s22
    s_and_b32 s22, s24, 15
    v_mov_b32 v31, s22
    ds_write_b32 v4, v31 offset:12564
L_h38:
    s_cmp_lg_u32 s16, 0
    s_cselect_b64 vcc, -1, 0
    s_subb_u32 s16, s16, 0
    ds_read_b128 v[8:11], v13 offset:640
    s_waitcnt vmcnt(4)
    s_cbranch_vccnz L_w174
    s_waitcnt vmcnt(2)
L_w174:
    s_cmp_eq_u32 s21, 0
    s_cbranch_scc1 L_w175
    s_waitcnt vmcnt(1)
    s_sub_u32 s21, s21, 1
L_w175:
    s_barrier
    v_lshlrev_b32 v164, 16, v40
    v_and_b32 v165, s60, v40
    v_lshlrev_b32 v166, 16, v41
    v_and_b32 v167, s60, v41
    v_pk_fma_f32 v[14:15], v[164:165], v[22:23], v[14:15] op_sel_hi:[1,0,1]
    v_lshlrev_b32 v164, 16, v42
    v_and_b32 v165, s60, v42
    v_pk_fma_f32 v[16:17], v[166:167], v[22:23], v[16:17] op_sel_hi:[1,0,1]
    v_lshlrev_b32 v166, 16, v43
    v_and_b32 v167, s60, v43
    v_pk_fma_f32 v[18:19], v[164:165], v[22:23], v[18:19] op_sel_hi:[1,0,1]
    v_pk_fma_f32 v[20:21], v[166:167], v[22:23], v[20:21] op_sel_hi:[1,0,1]
    buffer_load_dwordx4 v[40:43], v2, s[36:39], s56 offen offset:1024 nt
    s_waitcnt vmcnt(4)
    s_cbranch_vccnz L_w176
    s_waitcnt vmcnt(2)
L_w176:
    v_lshlrev_b32 v164, 16, v44
    v_and_b32 v165, s60, v44
    v_lshlrev_b32 v166, 16, v45
    v_and_b32 v167, s60, v45
    v_pk_fma_f32 v[14:15], v[164:165], v[22:23], v[14:15] op_sel:[0,1,0] op_sel_hi:[1,1,1]
    v_lshlrev_b32 v164, 16, v46
    v_and_b32 v165, s60, v46
    v_pk_fma_f32 v[16:17], v[166:167], v[22:23], v[16:17] op_sel:[0,1,0] op_sel_hi:[1,1,1]
    v_lshlrev_b32 v166, 16, v47
    v_and_b32 v167, s60, v47
    v_pk_fma_f32 v[18:19], v[164:165], v[22:23], v[18:19] op_sel:[0,1,0] op_sel_hi:[1,1,1]
    v_pk_fma_f32 v[20:21], v[166:167], v[22:23], v[20:21] op_sel:[0,1,0] op_sel_hi:[1,1,1]
    buffer_load_dwordx4 v[44:47], v2, s[36:39], s56 offen offset:2048 nt
    s_waitcnt vmcnt(4)
    s_cbranch_vccnz L_w177
    s_waitcnt vmcnt(2)
L_w177:
    v_lshlrev_b32 v164, 16, v48
    v_and_b32 v165, s60, v48
    v_lshlrev_b32 v166, 16, v49
    v_and_b32 v167, s60, v49
    v_pk_fma_f32 v[14:15], v[164:165], v[24:25], v[14:15] op_sel_hi:[1,0,1]
    v_lshlrev_b32 v164, 16, v50
    v_and_b32 v165, s60, v50
    v_pk_fma_f32 v[16:17], v[166:167], v[24:25], v[16:17] op_sel_hi:[1,0,1]
    v_lshlrev_b32 v166, 16, v51
    v_and_b32 v167, s60, v51
    v_pk_fma_f32 v[18:19], v[164:165], v[24:25], v[18:19] op_sel_hi:[1,0,1]
    v_pk_fma_f32 v[20:21], v[166:167], v[24:25], v[20:21] op_sel_hi:[1,0,1]
    buffer_load_dwordx4 v[48:51], v2, s[36:39], s56 offen offset:3072 nt
    s_waitcnt vmcnt(4)
    s_cbranch_vccnz L_w178
    s_waitcnt vmcnt(2)
L_w178:
    v_lshlrev_b32 v164, 16, v32
    v_and_b32 v165, s60, v32
    v_lshlrev_b32 v166, 16, v33
    v_and_b32 v167, s60, v33
    v_pk_fma_f32 v[14:15], v[164:165], v[24:25], v[14:15] op_sel:[0,1,0] op_sel_hi:[1,1,1]
    v_lshlrev_b32 v164, 16, v34
    v_and_b32 v165, s60, v34
    v_pk_fma_f32 v[16:17], v[166:167], v[24:25], v[16:17] op_sel:[0,1,0] op_sel_hi:[1,1,1]
    v_lshlrev_b32 v166, 16, v35
    v_and_b32 v167, s60, v35
    v_pk_fma_f32 v[18:19], v[164:165], v[24:25], v[18:19] op_sel:[0,1,0] op_sel_hi:[1,1,1]
    v_pk_fma_f32 v[20:21], v[166:167], v[24:25], v[20:21] op_sel:[0,1,0] op_sel_hi:[1,1,1]
    s_add_u32 s56, s56, 65536
    buffer_load_dwordx4 v[32:35], v2, s[36:39], s56 offen offset:0 nt
    v_mov_b32 v28, 0
    s_mov_b32 s11, 2097152
L_kdw:
    ds_read_b32 v29, v28 offset:12560
    ds_read_b128 v[52:55], v28 offset:10240
    ds_read_b128 v[56:59], v28 offset:10256
    ds_read_b128 v[60:63], v28 offset:10272
    ds_read_b128 v[64:67], v28 offset:10288
    s_waitcnt lgkmcnt(0)
    v_readfirstlane_b32 s10, v29
    s_sub_u32 s11, s11, 1
    s_cbranch_scc1 L_kdok
    s_cmp_lt_u32 s10, 8
    s_cbranch_scc1 L_kdw
L_kdok:
    v_max3_f32 v26, v52, v54, v56
    v_max3_f32 v27, v58, v60, v62
    v_max3_f32 v26, v26, v64, v66
    v_max_f32 v26, v26, v27
    v_sub_f32 v30, v30, v26
    v_exp_f32 v30, v30
    v_sub_f32 v52, v52, v26
    v_sub_f32 v54, v54, v26
    v_sub_f32 v56, v56, v26
    v_sub_f32 v58, v58, v26
    v_sub_f32 v60, v60, v26
    v_sub_f32 v62, v62, v26
    v_sub_f32 v64, v64, v26
    v_sub_f32 v66, v66, v26
    v_exp_f32 v52, v52
    v_exp_f32 v54, v54
    v_exp_f32 v56, v56
    v_exp_f32 v58, v58
    v_exp_f32 v60, v60
    v_exp_f32 v62, v62
    v_exp_f32 v64, v64
    v_exp_f32 v66, v66
    v_mul_f32 v27, v52, v53
    v_fmac_f32 v27, v54, v55
    v_fmac_f32 v27, v56, v57
    v_fmac_f32 v27, v58, v59
    v_fmac_f32 v27, v60, v61
    v_fmac_f32 v27, v62, v63
    v_fmac_f32 v27, v64, v65
    v_fmac_f32 v27, v66, v67
    s_lshl_b32 s9, s3, 8
    v_lshlrev_b32 v95, 2, v0
    v_add_u32 v95, s9, v95
    v_lshrrev_b32 v96, 3, v0
    v_lshlrev_b32 v96, 5, v96
    v_add_u32 v96, s9, v96
    v_and_b32 v98, 7, v6
    v_lshlrev_b32 v98, 5, v98
    v_lshrrev_b32 v29, 3, v6
    v_lshl_add_u32 v98, v29, 4, v98
    v_lshl_add_u32 v98, v5, 2, v98
    v_add_u32 v98, s9, v98
    s_lshl_b32 s9, s3, 2
    v_add_u32 v99, s9, v5
    v_lshlrev_b32 v29, 4, v6
    v_lshl_add_u32 v97, v99, 9, v29
    v_lshlrev_b32 v99, 8, v99
    s_sub_u32 s10, s2, 224
    s_lshl_b32 s11, s10, 15
    s_add_u32 s92, s12, s11
    s_addc_u32 s93, s13, 0
    s_lshr_b32 s58, s10, 3
    s_lshl_b32 s58, s58, 13
    s_add_u32 s58, s58, 1310720
    s_mov_b32 s96, s88
    s_mov_b32 s97, s89
    s_mov_b32 s98, 4096
    s_mov_b32 s99, 0x20000
    s_lshl_b32 s59, s10, 7
    s_waitcnt lgkmcnt(0)
    s_cmp_lg_u32 s16, 0
    s_cselect_b64 vcc, -1, 0
    s_subb_u32 s16, s16, 0
    ds_read_b128 v[22:25], v13 offset:704
    s_waitcnt vmcnt(4)
    s_cbranch_vccnz L_w179
    s_waitcnt vmcnt(2)
L_w179:
    s_cmp_eq_u32 s21, 0
    s_cbranch_scc1 L_w180
    s_waitcnt vmcnt(1)
    s_sub_u32 s21, s21, 1
L_w180:
    s_barrier
    ds_read_b32 v31, v4 offset:12564
    v_lshlrev_b32 v164, 16, v36
    v_and_b32 v165, s60, v36
    v_lshlrev_b32 v166, 16, v37
    v_and_b32 v167, s60, v37
    v_pk_fma_f32 v[14:15], v[164:165], v[8:9], v[14:15] op_sel_hi:[1,0,1]
    v_lshlrev_b32 v164, 16, v38
    v_and_b32 v165, s60, v38
    v_pk_fma_f32 v[16:17], v[166:167], v[8:9], v[16:17] op_sel_hi:[1,0,1]
    v_lshlrev_b32 v166, 16, v39
    v_and_b32 v167, s60, v39
    v_pk_fma_f32 v[18:19], v[164:165], v[8:9], v[18:19] op_sel_hi:[1,0,1]
    v_pk_fma_f32 v[20:21], v[166:167], v[8:9], v[20:21] op_sel_hi:[1,0,1]
    buffer_load_dwordx4 v[36:39], v2, s[36:39], s56 offen offset:1024 nt
    s_waitcnt vmcnt(4)
    s_cbranch_vccnz L_w181
    s_waitcnt vmcnt(2)
L_w181:
    v_lshlrev_b32 v164, 16, v40
    v_and_b32 v165, s60, v40
    v_lshlrev_b32 v166, 16, v41
    v_and_b32 v167, s60, v41
    v_pk_fma_f32 v[14:15], v[164:165], v[8:9], v[14:15] op_sel:[0,1,0] op_sel_hi:[1,1,1]
    v_lshlrev_b32 v164, 16, v42
    v_and_b32 v165, s60, v42
    v_pk_fma_f32 v[16:17], v[166:167], v[8:9], v[16:17] op_sel:[0,1,0] op_sel_hi:[1,1,1]
    v_lshlrev_b32 v166, 16, v43
    v_and_b32 v167, s60, v43
    v_pk_fma_f32 v[18:19], v[164:165], v[8:9], v[18:19] op_sel:[0,1,0] op_sel_hi:[1,1,1]
    v_pk_fma_f32 v[20:21], v[166:167], v[8:9], v[20:21] op_sel:[0,1,0] op_sel_hi:[1,1,1]
    buffer_load_dwordx4 v[40:43], v2, s[36:39], s56 offen offset:2048 nt
    s_waitcnt vmcnt(4)
    s_cbranch_vccnz L_w182
    s_waitcnt vmcnt(2)
L_w182:
    v_lshlrev_b32 v164, 16, v44
    v_and_b32 v165, s60, v44
    v_lshlrev_b32 v166, 16, v45
    v_and_b32 v167, s60, v45
    v_pk_fma_f32 v[14:15], v[164:165], v[10:11], v[14:15] op_sel_hi:[1,0,1]
    v_lshlrev_b32 v164, 16, v46
    v_and_b32 v165, s60, v46
    v_pk_fma_f32 v[16:17], v[166:167], v[10:11], v[16:17] op_sel_hi:[1,0,1]
    v_lshlrev_b32 v166, 16, v47
    v_and_b32 v167, s60, v47
    v_pk_fma_f32 v[18:19], v[164:165], v[10:11], v[18:19] op_sel_hi:[1,0,1]
    v_pk_fma_f32 v[20:21], v[166:167], v[10:11], v[20:21] op_sel_hi:[1,0,1]
    buffer_load_dwordx4 v[44:47], v2, s[36:39], s56 offen offset:3072 nt
    s_waitcnt vmcnt(4)
    s_cbranch_vccnz L_w183
    s_waitcnt vmcnt(2)
L_w183:
    v_lshlrev_b32 v164, 16, v48
    v_and_b32 v165, s60, v48
    v_lshlrev_b32 v166, 16, v49
    v_and_b32 v167, s60, v49
    v_pk_fma_f32 v[14:15], v[164:165], v[10:11], v[14:15] op_sel:[0,1,0] op_sel_hi:[1,1,1]
    v_lshlrev_b32 v164, 16, v50
    v_and_b32 v165, s60, v50
    v_pk_fma_f32 v[16:17], v[166:167], v[10:11], v[16:17] op_sel:[0,1,0] op_sel_hi:[1,1,1]
    v_lshlrev_b32 v166, 16, v51
    v_and_b32 v167, s60, v51
    v_pk_fma_f32 v[18:19], v[164:165], v[10:11], v[18:19] op_sel:[0,1,0] op_sel_hi:[1,1,1]
    v_pk_fma_f32 v[20:21], v[166:167], v[10:11], v[20:21] op_sel:[0,1,0] op_sel_hi:[1,1,1]
    s_add_u32 s56, s56, 65536
    buffer_load_dwordx4 v[48:51], v2, s[36:39], s56 offen offset:0 nt
    s_waitcnt lgkmcnt(0)
    v_readfirstlane_b32 s16, v31
    s_sub_u32 s21, s16, 8
    s_cselect_b32 s21, 0, s21
    s_cselect_b32 s16, s16, 0
    s_cmp_lg_u32 s16, 0
    s_cselect_b64 vcc, -1, 0
    s_subb_u32 s16, s16, 0
    ds_read_b128 v[8:11], v13 offset:768
    s_waitcnt vmcnt(4)
    s_cbranch_vccnz L_w184
    s_waitcnt vmcnt(2)
L_w184:
    s_cmp_eq_u32 s21, 0
    s_cbranch_scc1 L_w185
    s_waitcnt vmcnt(1)
    s_sub_u32 s21, s21, 1
L_w185:
    s_barrier
    v_lshlrev_b32 v164, 16, v32
    v_and_b32 v165, s60, v32
    v_lshlrev_b32 v166, 16, v33
    v_and_b32 v167, s60, v33
    v_pk_fma_f32 v[14:15], v[164:165], v[22:23], v[14:15] op_sel_hi:[1,0,1]
    v_lshlrev_b32 v164, 16, v34
    v_and_b32 v165, s60, v34
    v_pk_fma_f32 v[16:17], v[166:167], v[22:23], v[16:17] op_sel_hi:[1,0,1]
    v_lshlrev_b32 v166, 16, v35
    v_and_b32 v167, s60, v35
    v_pk_fma_f32 v[18:19], v[164:165], v[22:23], v[18:19] op_sel_hi:[1,0,1]
    v_pk_fma_f32 v[20:21], v[166:167], v[22:23], v[20:21] op_sel_hi:[1,0,1]
    buffer_load_dwordx4 v[32:35], v2, s[36:39], s56 offen offset:1024 nt
    s_waitcnt vmcnt(4)
    s_cbranch_vccnz L_w186
    s_waitcnt vmcnt(2)
L_w186:
    v_lshlrev_b32 v164, 16, v36
    v_and_b32 v165, s60, v36
    v_lshlrev_b32 v166, 16, v37
    v_and_b32 v167, s60, v37
    v_pk_fma_f32 v[14:15], v[164:165], v[22:23], v[14:15] op_sel:[0,1,0] op_sel_hi:[1,1,1]
    v_lshlrev_b32 v164, 16, v38
    v_and_b32 v165, s60, v38
    v_pk_fma_f32 v[16:17], v[166:167], v[22:23], v[16:17] op_sel:[0,1,0] op_sel_hi:[1,1,1]
    v_lshlrev_b32 v166, 16, v39
    v_and_b32 v167, s60, v39
    v_pk_fma_f32 v[18:19], v[164:165], v[22:23], v[18:19] op_sel:[0,1,0] op_sel_hi:[1,1,1]
    v_pk_fma_f32 v[20:21], v[166:167], v[22:23], v[20:21] op_sel:[0,1,0] op_sel_hi:[1,1,1]
    buffer_load_dwordx4 v[36:39], v2, s[36:39], s56 offen offset:2048 nt
    s_waitcnt vmcnt(4)
    s_cbranch_vccnz L_w187
    s_waitcnt vmcnt(2)
L_w187:
    v_lshlrev_b32 v164, 16, v40
    v_and_b32 v165, s60, v40
    v_lshlrev_b32 v166, 16, v41
    v_and_b32 v167, s60, v41
    v_pk_fma_f32 v[14:15], v[164:165], v[24:25], v[14:15] op_sel_hi:[1,0,1]
    v_lshlrev_b32 v164, 16, v42
    v_and_b32 v165, s60, v42
    v_pk_fma_f32 v[16:17], v[166:167], v[24:25], v[16:17] op_sel_hi:[1,0,1]
    v_lshlrev_b32 v166, 16, v43
    v_and_b32 v167, s60, v43
    v_pk_fma_f32 v[18:19], v[164:165], v[24:25], v[18:19] op_sel_hi:[1,0,1]
    v_pk_fma_f32 v[20:21], v[166:167], v[24:25], v[20:21] op_sel_hi:[1,0,1]
    buffer_load_dwordx4 v[40:43], v2, s[36:39], s56 offen offset:3072 nt
    s_waitcnt vmcnt(4)
    s_cbranch_vccnz L_w188
    s_waitcnt vmcnt(2)
L_w188:
    v_lshlrev_b32 v164, 16, v44
    v_and_b32 v165, s60, v44
    v_lshlrev_b32 v166, 16, v45
    v_and_b32 v167, s60, v45
    v_pk_fma_f32 v[14:15], v[164:165], v[24:25], v[14:15] op_sel:[0,1,0] op_sel_hi:[1,1,1]
    v_lshlrev_b32 v164, 16, v46
    v_and_b32 v165, s60, v46
    v_pk_fma_f32 v[16:17], v[166:167], v[24:25], v[16:17] op_sel:[0,1,0] op_sel_hi:[1,1,1]
    v_lshlrev_b32 v166, 16, v47
    v_and_b32 v167, s60, v47
    v_pk_fma_f32 v[18:19], v[164:165], v[24:25], v[18:19] op_sel:[0,1,0] op_sel_hi:[1,1,1]
    v_pk_fma_f32 v[20:21], v[166:167], v[24:25], v[20:21] op_sel:[0,1,0] op_sel_hi:[1,1,1]
    s_add_u32 s56, s56, 65536
    buffer_load_dwordx4 v[44:47], v2, s[36:39], s56 offen offset:0 nt
    s_waitcnt lgkmcnt(0)
    s_cmp_lg_u32 s16, 0
    s_cselect_b64 vcc, -1, 0
    s_subb_u32 s16, s16, 0
    ds_read_b128 v[22:25], v13 offset:832
    s_waitcnt vmcnt(4)
    s_cbranch_vccnz L_w189
    s_waitcnt vmcnt(2)
L_w189:
    s_cmp_eq_u32 s21, 0
    s_cbranch_scc1 L_w190
    s_waitcnt vmcnt(1)
    s_sub_u32 s21, s21, 1
L_w190:
    s_barrier
    v_lshlrev_b32 v164, 16, v48
    v_and_b32 v165, s60, v48
    v_lshlrev_b32 v166, 16, v49
    v_and_b32 v167, s60, v49
    v_pk_fma_f32 v[14:15], v[164:165], v[8:9], v[14:15] op_sel_hi:[1,0,1]
    v_lshlrev_b32 v164, 16, v50
    v_and_b32 v165, s60, v50
    v_pk_fma_f32 v[16:17], v[166:167], v[8:9], v[16:17] op_sel_hi:[1,0,1]
    v_lshlrev_b32 v166, 16, v51
    v_and_b32 v167, s60, v51
    v_pk_fma_f32 v[18:19], v[164:165], v[8:9], v[18:19] op_sel_hi:[1,0,1]
    v_pk_fma_f32 v[20:21], v[166:167], v[8:9], v[20:21] op_sel_hi:[1,0,1]
    buffer_load_dwordx4 v[48:51], v2, s[36:39], s56 offen offset:1024 nt
    s_waitcnt vmcnt(4)
    s_cbranch_vccnz L_w191
    s_waitcnt vmcnt(2)
L_w191:
    v_lshlrev_b32 v164, 16, v32
    v_and_b32 v165, s60, v32
    v_lshlrev_b32 v166, 16, v33
    v_and_b32 v167, s60, v33
    v_pk_fma_f32 v[14:15], v[164:165], v[8:9], v[14:15] op_sel:[0,1,0] op_sel_hi:[1,1,1]
    v_lshlrev_b32 v164, 16, v34
    v_and_b32 v165, s60, v34
    v_pk_fma_f32 v[16:17], v[166:167], v[8:9], v[16:17] op_sel:[0,1,0] op_sel_hi:[1,1,1]
    v_lshlrev_b32 v166, 16, v35
    v_and_b32 v167, s60, v35
    v_pk_fma_f32 v[18:19], v[164:165], v[8:9], v[18:19] op_sel:[0,1,0] op_sel_hi:[1,1,1]
    v_pk_fma_f32 v[20:21], v[166:167], v[8:9], v[20:21] op_sel:[0,1,0] op_sel_hi:[1,1,1]
    buffer_load_dwordx4 v[32:35], v2, s[36:39], s56 offen offset:2048 nt
    s_waitcnt vmcnt(4)
    s_cbranch_vccnz L_w192
    s_waitcnt vmcnt(2)
L_w192:
    v_lshlrev_b32 v164, 16, v36
    v_and_b32 v165, s60, v36
    v_lshlrev_b32 v166, 16, v37
    v_and_b32 v167, s60, v37
    v_pk_fma_f32 v[14:15], v[164:165], v[10:11], v[14:15] op_sel_hi:[1,0,1]
    v_lshlrev_b32 v164, 16, v38
    v_and_b32 v165, s60, v38
    v_pk_fma_f32 v[16:17], v[166:167], v[10:11], v[16:17] op_sel_hi:[1,0,1]
    v_lshlrev_b32 v166, 16, v39
    v_and_b32 v167, s60, v39
    v_pk_fma_f32 v[18:19], v[164:165], v[10:11], v[18:19] op_sel_hi:[1,0,1]
    v_pk_fma_f32 v[20:21], v[166:167], v[10:11], v[20:21] op_sel_hi:[1,0,1]
    buffer_load_dwordx4 v[36:39], v2, s[36:39], s56 offen offset:3072 nt
    s_waitcnt vmcnt(4)
    s_cbranch_vccnz L_w193
    s_waitcnt vmcnt(2)
L_w193:
    v_lshlrev_b32 v164, 16, v40
    v_and_b32 v165, s60, v40
    v_lshlrev_b32 v166, 16, v41
    v_and_b32 v167, s60, v41
    v_pk_fma_f32 v[14:15], v[164:165], v[10:11], v[14:15] op_sel:[0,1,0] op_sel_hi:[1,1,1]
    v_lshlrev_b32 v164, 16, v42
    v_and_b32 v165, s60, v42
    v_pk_fma_f32 v[16:17], v[166:167], v[10:11], v[16:17] op_sel:[0,1,0] op_sel_hi:[1,1,1]
    v_lshlrev_b32 v166, 16, v43
    v_and_b32 v167, s60, v43
    v_pk_fma_f32 v[18:19], v[164:165], v[10:11], v[18:19] op_sel:[0,1,0] op_sel_hi:[1,1,1]
    v_pk_fma_f32 v[20:21], v[166:167], v[10:11], v[20:21] op_sel:[0,1,0] op_sel_hi:[1,1,1]
    s_add_u32 s56, s56, 65536
    buffer_load_dwordx4 v[40:43], v2, s[36:39], s56 offen offset:0 nt
    s_waitcnt lgkmcnt(0)
    s_cmp_lg_u32 s16, 0
    s_cselect_b64 vcc, -1, 0
    s_subb_u32 s16, s16, 0
    ds_read_b128 v[8:11], v13 offset:896
    s_waitcnt vmcnt(4)
    s_cbranch_vccnz L_w194
    s_waitcnt vmcnt(2)
L_w194:
    s_cmp_eq_u32 s21, 0
    s_cbranch_scc1 L_w195
    s_waitcnt vmcnt(1)
    s_sub_u32 s21, s21, 1
L_w195:
    s_barrier
    ds_read_b32 v31, v4 offset:12568
    v_lshlrev_b32 v164, 16, v44
    v_and_b32 v165, s60, v44
    v_lshlrev_b32 v166, 16, v45
    v_and_b32 v167, s60, v45
    v_pk_fma_f32 v[14:15], v[164:165], v[22:23], v[14:15] op_sel_hi:[1,0,1]
    v_lshlrev_b32 v164, 16, v46
    v_and_b32 v165, s60, v46
    v_pk_fma_f32 v[16:17], v[166:167], v[22:23], v[16:17] op_sel_hi:[1,0,1]
    v_lshlrev_b32 v166, 16, v47
    v_and_b32 v167, s60, v47
    v_pk_fma_f32 v[18:19], v[164:165], v[22:23], v[18:19] op_sel_hi:[1,0,1]
    v_pk_fma_f32 v[20:21], v[166:167], v[22:23], v[20:21] op_sel_hi:[1,0,1]
    buffer_load_dwordx4 v[44:47], v2, s[36:39], s56 offen offset:1024 nt
    s_waitcnt vmcnt(4)
    s_cbranch_vccnz L_w196
    s_waitcnt vmcnt(2)
L_w196:
    v_lshlrev_b32 v164, 16, v48
    v_and_b32 v165, s60, v48
    v_lshlrev_b32 v166, 16, v49
    v_and_b32 v167, s60, v49
    v_pk_fma_f32 v[14:15], v[164:165], v[22:23], v[14:15] op_sel:[0,1,0] op_sel_hi:[1,1,1]
    v_lshlrev_b32 v164, 16, v50
    v_and_b32 v165, s60, v50
    v_pk_fma_f32 v[16:17], v[166:167], v[22:23], v[16:17] op_sel:[0,1,0] op_sel_hi:[1,1,1]
    v_lshlrev_b32 v166, 16, v51
    v_and_b32 v167, s60, v51
    v_pk_fma_f32 v[18:19], v[164:165], v[22:23], v[18:19] op_sel:[0,1,0] op_sel_hi:[1,1,1]
    v_pk_fma_f32 v[20:21], v[166:167], v[22:23], v[20:21] op_sel:[0,1,0] op_sel_hi:[1,1,1]
    buffer_load_dwordx4 v[48:51], v2, s[36:39], s56 offen offset:2048 nt
    s_waitcnt vmcnt(4)
    s_cbranch_vccnz L_w197
    s_waitcnt vmcnt(2)
L_w197:
    s_waitcnt lgkmcnt(0)
    v_readfirstlane_b32 s23, v31
    s_mov_b32 s22, -1
    s_cmp_lg_u32 s3, 0
    s_cbranch_scc1 L_m42
    s_cmp_eq_u32 s23, 0
    s_cbranch_scc1 L_m42
    s_mov_b32 s22, 1
    s_atomic_add s22, s[64:65], 20480 glc
L_m42:
    v_lshlrev_b32 v164, 16, v32
    v_and_b32 v165, s60, v32
    v_lshlrev_b32 v166, 16, v33
    v_and_b32 v167, s60, v33
    v_pk_fma_f32 v[14:15], v[164:165], v[24:25], v[14:15] op_sel_hi:[1,0,1]
    v_lshlrev_b32 v164, 16, v34
    v_and_b32 v165, s60, v34
    v_pk_fma_f32 v[16:17], v[166:167], v[24:25], v[16:17] op_sel_hi:[1,0,1]
    v_lshlrev_b32 v166, 16, v35
    v_and_b32 v167, s60, v35
    v_pk_fma_f32 v[18:19], v[164:165], v[24:25], v[18:19] op_sel_hi:[1,0,1]
    v_pk_fma_f32 v[20:21], v[166:167], v[24:25], v[20:21] op_sel_hi:[1,0,1]
    buffer_load_dwordx4 v[32:35], v2, s[36:39], s56 offen offset:3072 nt
    s_waitcnt vmcnt(4)
    s_cbranch_vccnz L_w198
    s_waitcnt vmcnt(2)
L_w198:
    v_lshlrev_b32 v164, 16, v36
    v_and_b32 v165, s60, v36
    v_lshlrev_b32 v166, 16, v37
    v_and_b32 v167, s60, v37
    v_pk_fma_f32 v[14:15], v[164:165], v[24:25], v[14:15] op_sel:[0,1,0] op_sel_hi:[1,1,1]
    v_lshlrev_b32 v164, 16, v38
    v_and_b32 v165, s60, v38
    v_pk_fma_f32 v[16:17], v[166:167], v[24:25], v[16:17] op_sel:[0,1,0] op_sel_hi:[1,1,1]
    v_lshlrev_b32 v166, 16, v39
    v_and_b32 v167, s60, v39
    v_pk_fma_f32 v[18:19], v[164:165], v[24:25], v[18:19] op_sel:[0,1,0] op_sel_hi:[1,1,1]
    v_pk_fma_f32 v[20:21], v[166:167], v[24:25], v[20:21] op_sel:[0,1,0] op_sel_hi:[1,1,1]
    s_add_u32 s56, s56, 65536
    buffer_load_dwordx4 v[36:39], v2, s[36:39], s56 offen offset:0 nt
    s_cmp_lg_u32 s16, 0
    s_cselect_b64 vcc, -1, 0
    s_subb_u32 s16, s16, 0
    ds_read_b128 v[22:25], v13 offset:960
    s_waitcnt vmcnt(4)
    s_cbranch_vccnz L_w199
    s_waitcnt vmcnt(2)
L_w199:
    s_cmp_eq_u32 s21, 0
    s_cbranch_scc1 L_w200
    s_waitcnt vmcnt(1)
    s_sub_u32 s21, s21, 1
L_w200:
    s_barrier
    v_lshlrev_b32 v164, 16, v40
    v_and_b32 v165, s60, v40
    v_lshlrev_b32 v166, 16, v41
    v_and_b32 v167, s60, v41
    v_pk_fma_f32 v[14:15], v[164:165], v[8:9], v[14:15] op_sel_hi:[1,0,1]
    v_lshlrev_b32 v164, 16, v42
    v_and_b32 v165, s60, v42
    v_pk_fma_f32 v[16:17], v[166:167], v[8:9], v[16:17] op_sel_hi:[1,0,1]
    v_lshlrev_b32 v166, 16, v43
    v_and_b32 v167, s60, v43
    v_pk_fma_f32 v[18:19], v[164:165], v[8:9], v[18:19] op_sel_hi:[1,0,1]
    v_pk_fma_f32 v[20:21], v[166:167], v[8:9], v[20:21] op_sel_hi:[1,0,1]
    buffer_load_dwordx4 v[40:43], v2, s[36:39], s56 offen offset:1024 nt
    s_waitcnt vmcnt(4)
    s_cbranch_vccnz L_w201
    s_waitcnt vmcnt(2)
L_w201:
    v_lshlrev_b32 v164, 16, v44
    v_and_b32 v165, s60, v44
    v_lshlrev_b32 v166, 16, v45
    v_and_b32 v167, s60, v45
    v_pk_fma_f32 v[14:15], v[164:165], v[8:9], v[14:15] op_sel:[0,1,0] op_sel_hi:[1,1,1]
    v_lshlrev_b32 v164, 16, v46
    v_and_b32 v165, s60, v46
    v_pk_fma_f32 v[16:17], v[166:167], v[8:9], v[16:17] op_sel:[0,1,0] op_sel_hi:[1,1,1]
    v_lshlrev_b32 v166, 16, v47
    v_and_b32 v167, s60, v47
    v_pk_fma_f32 v[18:19], v[164:165], v[8:9], v[18:19] op_sel:[0,1,0] op_sel_hi:[1,1,1]
    v_pk_fma_f32 v[20:21], v[166:167], v[8:9], v[20:21] op_sel:[0,1,0] op_sel_hi:[1,1,1]
    buffer_load_dwordx4 v[44:47], v2, s[36:39], s56 offen offset:2048 nt
    s_waitcnt vmcnt(4)
    s_cbranch_vccnz L_w202
    s_waitcnt vmcnt(2)
L_w202:
    v_lshlrev_b32 v164, 16, v48
    v_and_b32 v165, s60, v48
    v_lshlrev_b32 v166, 16, v49
    v_and_b32 v167, s60, v49
    v_pk_fma_f32 v[14:15], v[164:165], v[10:11], v[14:15] op_sel_hi:[1,0,1]
    v_lshlrev_b32 v164, 16, v50
    v_and_b32 v165, s60, v50
    v_pk_fma_f32 v[16:17], v[166:167], v[10:11], v[16:17] op_sel_hi:[1,0,1]
    v_lshlrev_b32 v166, 16, v51
    v_and_b32 v167, s60, v51
    v_pk_fma_f32 v[18:19], v[164:165], v[10:11], v[18:19] op_sel_hi:[1,0,1]
    v_pk_fma_f32 v[20:21], v[166:167], v[10:11], v[20:21] op_sel_hi:[1,0,1]
    buffer_load_dwordx4 v[48:51], v2, s[36:39], s56 offen offset:3072 nt
    s_waitcnt vmcnt(4)
    s_cbranch_vccnz L_w203
    s_waitcnt vmcnt(2)
L_w203:
    v_lshlrev_b32 v164, 16, v32
    v_and_b32 v165, s60, v32
    v_lshlrev_b32 v166, 16, v33
    v_and_b32 v167, s60, v33
    v_pk_fma_f32 v[14:15], v[164:165], v[10:11], v[14:15] op_sel:[0,1,0] op_sel_hi:[1,1,1]
    v_lshlrev_b32 v164, 16, v34
    v_and_b32 v165, s60, v34
    v_pk_fma_f32 v[16:17], v[166:167], v[10:11], v[16:17] op_sel:[0,1,0] op_sel_hi:[1,1,1]
    v_lshlrev_b32 v166, 16, v35
    v_and_b32 v167, s60, v35
    v_pk_fma_f32 v[18:19], v[164:165], v[10:11], v[18:19] op_sel:[0,1,0] op_sel_hi:[1,1,1]
    v_pk_fma_f32 v[20:21], v[166:167], v[10:11], v[20:21] op_sel:[0,1,0] op_sel_hi:[1,1,1]
    s_add_u32 s56, s56, 65536
    buffer_load_dwordx4 v[32:35], v2, s[36:39], s56 offen offset:0 nt
    s_waitcnt lgkmcnt(0)
    s_cmp_lg_u32 s3, 0
    s_cbranch_scc1 L_h44
    s_add_u32 s22, s22, 1
    s_min_u32 s22, s22, 15
    s_lshl_b32 s22, s22, 2
    s_mov_b32 s24, 0xabcd
    s_mov_b32 s25, 0x75310000
    s_lshr_b64 s[24:25], s[24:25], s22
    s_and_b32 s22, s24, 15
    v_mov_b32 v31, s22
    ds_write_b32 v4, v31 offset:12564
L_h44:
    s_cmp_lg_u32 s16, 0
    s_cselect_b64 vcc, -1, 0
    s_subb_u32 s16, s16, 0
    ds_read_b128 v[8:11], v13 offset:1024
    s_waitcnt vmcnt(4)
    s_cbranch_vccnz L_w204
    s_waitcnt vmcnt(2)
L_w204:
    s_cmp_eq_u32 s21, 0
    s_cbranch_scc1 L_w205
    s_waitcnt vmcnt(1)
    s_sub_u32 s21, s21, 1
L_w205:
    s_barrier
    v_lshlrev_b32 v164, 16, v36
    v_and_b32 v165, s60, v36
    v_lshlrev_b32 v166, 16, v37
    v_and_b32 v167, s60, v37
    v_pk_fma_f32 v[14:15], v[164:165], v[22:23], v[14:15] op_sel_hi:[1,0,1]
    v_lshlrev_b32 v164, 16, v38
    v_and_b32 v165, s60, v38
    v_pk_fma_f32 v[16:17], v[166:167], v[22:23], v[16:17] op_sel_hi:[1,0,1]
    v_lshlrev_b32 v166, 16, v39
    v_and_b32 v167, s60, v39
    v_pk_fma_f32 v[18:19], v[164:165], v[22:23], v[18:19] op_sel_hi:[1,0,1]
    v_pk_fma_f32 v[20:21], v[166:167], v[22:23], v[20:21] op_sel_hi:[1,0,1]
    buffer_load_dwordx4 v[36:39], v2, s[36:39], s56 offen offset:1024 nt
    s_waitcnt vmcnt(4)
    s_cbranch_vccnz L_w206
    s_waitcnt vmcnt(2)
L_w206:
    v_lshlrev_b32 v164, 16, v40
    v_and_b32 v165, s60, v40
    v_lshlrev_b32 v166, 16, v41
    v_and_b32 v167, s60, v41
    v_pk_fma_f32 v[14:15], v[164:165], v[22:23], v[14:15] op_sel:[0,1,0] op_sel_hi:[1,1,1]
    v_lshlrev_b32 v164, 16, v42
    v_and_b32 v165, s60, v42
    v_pk_fma_f32 v[16:17], v[166:167], v[22:23], v[16:17] op_sel:[0,1,0] op_sel_hi:[1,1,1]
    v_lshlrev_b32 v166, 16, v43
    v_and_b32 v167, s60, v43
    v_pk_fma_f32 v[18:19], v[164:165], v[22:23], v[18:19] op_sel:[0,1,0] op_sel_hi:[1,1,1]
    v_pk_fma_f32 v[20:21], v[166:167], v[22:23], v[20:21] op_sel:[0,1,0] op_sel_hi:[1,1,1]
    buffer_load_dwordx4 v[40:43], v2, s[36:39], s56 offen offset:2048 nt
    s_waitcnt vmcnt(4)
    s_cbranch_vccnz L_w207
    s_waitcnt vmcnt(2)
L_w207:
    v_lshlrev_b32 v164, 16, v44
    v_and_b32 v165, s60, v44
    v_lshlrev_b32 v166, 16, v45
    v_and_b32 v167, s60, v45
    v_pk_fma_f32 v[14:15], v[164:165], v[24:25], v[14:15] op_sel_hi:[1,0,1]
    v_lshlrev_b32 v164, 16, v46
    v_and_b32 v165, s60, v46
    v_pk_fma_f32 v[16:17], v[166:167], v[24:25], v[16:17] op_sel_hi:[1,0,1]
    v_lshlrev_b32 v166, 16, v47
    v_and_b32 v167, s60, v47
    v_pk_fma_f32 v[18:19], v[164:165], v[24:25], v[18:19] op_sel_hi:[1,0,1]
    v_pk_fma_f32 v[20:21], v[166:167], v[24:25], v[20:21] op_sel_hi:[1,0,1]
    buffer_load_dwordx4 v[44:47], v2, s[36:39], s56 offen offset:3072 nt
    s_waitcnt vmcnt(4)
    s_cbranch_vccnz L_w208
    s_waitcnt vmcnt(2)
L_w208:
    v_lshlrev_b32 v164, 16, v48
    v_and_b32 v165, s60, v48
    v_lshlrev_b32 v166, 16, v49
    v_and_b32 v167, s60, v49
    v_pk_fma_f32 v[14:15], v[164:165], v[24:25], v[14:15] op_sel:[0,1,0] op_sel_hi:[1,1,1]
    v_lshlrev_b32 v164, 16, v50
    v_and_b32 v165, s60, v50
    v_pk_fma_f32 v[16:17], v[166:167], v[24:25], v[16:17] op_sel:[0,1,0] op_sel_hi:[1,1,1]
    v_lshlrev_b32 v166, 16, v51
    v_and_b32 v167, s60, v51
    v_pk_fma_f32 v[18:19], v[164:165], v[24:25], v[18:19] op_sel:[0,1,0] op_sel_hi:[1,1,1]
    v_pk_fma_f32 v[20:21], v[166:167], v[24:25], v[20:21] op_sel:[0,1,0] op_sel_hi:[1,1,1]
    s_add_u32 s56, s56, 65536
    buffer_load_dwordx4 v[48:51], v2, s[36:39], s56 offen offset:0 nt
    s_waitcnt lgkmcnt(0)
    s_cmp_lg_u32 s16, 0
    s_cselect_b64 vcc, -1, 0
    s_subb_u32 s16, s16, 0
    ds_read_b128 v[22:25], v13 offset:1088
    s_waitcnt vmcnt(4)
    s_cbranch_vccnz L_w209
    s_waitcnt vmcnt(2)
L_w209:
    s_cmp_eq_u32 s21, 0
    s_cbranch_scc1 L_w210
    s_waitcnt vmcnt(1)
    s_sub_u32 s21, s21, 1
L_w210:
    s_barrier
    ds_read_b32 v31, v4 offset:12564
    v_lshlrev_b32 v164, 16, v32
    v_and_b32 v165, s60, v32
    v_lshlrev_b32 v166, 16, v33
    v_and_b32 v167, s60, v33
    v_pk_fma_f32 v[14:15], v[164:165], v[8:9], v[14:15] op_sel_hi:[1,0,1]
    v_lshlrev_b32 v164, 16, v34
    v_and_b32 v165, s60, v34
    v_pk_fma_f32 v[16:17], v[166:167], v[8:9], v[16:17] op_sel_hi:[1,0,1]
    v_lshlrev_b32 v166, 16, v35
    v_and_b32 v167, s60, v35
    v_pk_fma_f32 v[18:19], v[164:165], v[8:9], v[18:19] op_sel_hi:[1,0,1]
    v_pk_fma_f32 v[20:21], v[166:167], v[8:9], v[20:21] op_sel_hi:[1,0,1]
    buffer_load_dwordx4 v[32:35], v2, s[36:39], s56 offen offset:1024 nt
    s_waitcnt vmcnt(4)
    s_cbranch_vccnz L_w211
    s_waitcnt vmcnt(2)
L_w211:
    v_lshlrev_b32 v164, 16, v36
    v_and_b32 v165, s60, v36
    v_lshlrev_b32 v166, 16, v37
    v_and_b32 v167, s60, v37
    v_pk_fma_f32 v[14:15], v[164:165], v[8:9], v[14:15] op_sel:[0,1,0] op_sel_hi:[1,1,1]
    v_lshlrev_b32 v164, 16, v38
    v_and_b32 v165, s60, v38
    v_pk_fma_f32 v[16:17], v[166:167], v[8:9], v[16:17] op_sel:[0,1,0] op_sel_hi:[1,1,1]
    v_lshlrev_b32 v166, 16, v39
    v_and_b32 v167, s60, v39
    v_pk_fma_f32 v[18:19], v[164:165], v[8:9], v[18:19] op_sel:[0,1,0] op_sel_hi:[1,1,1]
    v_pk_fma_f32 v[20:21], v[166:167], v[8:9], v[20:21] op_sel:[0,1,0] op_sel_hi:[1,1,1]
    buffer_load_dwordx4 v[36:39], v2, s[36:39], s56 offen offset:2048 nt
    s_waitcnt vmcnt(4)
    s_cbranch_vccnz L_w212
    s_waitcnt vmcnt(2)
L_w212:
    v_lshlrev_b32 v164, 16, v40
    v_and_b32 v165, s60, v40
    v_lshlrev_b32 v166, 16, v41
    v_and_b32 v167, s60, v41
    v_pk_fma_f32 v[14:15], v[164:165], v[10:11], v[14:15] op_sel_hi:[1,0,1]
    v_lshlrev_b32 v164, 16, v42
    v_and_b32 v165, s60, v42
    v_pk_fma_f32 v[16:17], v[166:167], v[10:11], v[16:17] op_sel_hi:[1,0,1]
    v_lshlrev_b32 v166, 16, v43
    v_and_b32 v167, s60, v43
    v_pk_fma_f32 v[18:19], v[164:165], v[10:11], v[18:19] op_sel_hi:[1,0,1]
    v_pk_fma_f32 v[20:21], v[166:167], v[10:11], v[20:21] op_sel_hi:[1,0,1]
    buffer_load_dwordx4 v[40:43], v2, s[36:39], s56 offen offset:3072 nt
    s_waitcnt vmcnt(4)
    s_cbranch_vccnz L_w213
    s_waitcnt vmcnt(2)
L_w213:
    v_lshlrev_b32 v164, 16, v44
    v_and_b32 v165, s60, v44
    v_lshlrev_b32 v166, 16, v45
    v_and_b32 v167, s60, v45
    v_pk_fma_f32 v[14:15], v[164:165], v[10:11], v[14:15] op_sel:[0,1,0] op_sel_hi:[1,1,1]
    v_lshlrev_b32 v164, 16, v46
    v_and_b32 v165, s60, v46
    v_pk_fma_f32 v[16:17], v[166:167], v[10:11], v[16:17] op_sel:[0,1,0] op_sel_hi:[1,1,1]
    v_lshlrev_b32 v166, 16, v47
    v_and_b32 v167, s60, v47
    v_pk_fma_f32 v[18:19], v[164:165], v[10:11], v[18:19] op_sel:[0,1,0] op_sel_hi:[1,1,1]
    v_pk_fma_f32 v[20:21], v[166:167], v[10:11], v[20:21] op_sel:[0,1,0] op_sel_hi:[1,1,1]
    s_add_u32 s56, s56, 65536
    buffer_load_dwordx4 v[44:47], v2, s[36:39], s56 offen offset:0 nt
    s_waitcnt lgkmcnt(0)
    v_readfirstlane_b32 s16, v31
    s_sub_u32 s21, s16, 8
    s_cselect_b32 s21, 0, s21
    s_cselect_b32 s16, s16, 0
    s_cmp_lg_u32 s16, 0
    s_cselect_b64 vcc, -1, 0
    s_subb_u32 s16, s16, 0
    ds_read_b128 v[8:11], v13 offset:1152
    s_waitcnt vmcnt(4)
    s_cbranch_vccnz L_w214
    s_waitcnt vmcnt(2)
L_w214:
    s_cmp_eq_u32 s21, 0
    s_cbranch_scc1 L_w215
    s_waitcnt vmcnt(1)
    s_sub_u32 s21, s21, 1
L_w215:
    s_barrier
    v_lshlrev_b32 v164, 16, v48
    v_and_b32 v165, s60, v48
    v_lshlrev_b32 v166, 16, v49
    v_and_b32 v167, s60, v49
    v_pk_fma_f32 v[14:15], v[164:165], v[22:23], v[14:15] op_sel_hi:[1,0,1]
    v_lshlrev_b32 v164, 16, v50
    v_and_b32 v165, s60, v50
    v_pk_fma_f32 v[16:17], v[166:167], v[22:23], v[16:17] op_sel_hi:[1,0,1]
    v_lshlrev_b32 v166, 16, v51
    v_and_b32 v167, s60, v51
    v_pk_fma_f32 v[18:19], v[164:165], v[22:23], v[18:19] op_sel_hi:[1,0,1]
    v_pk_fma_f32 v[20:21], v[166:167], v[22:23], v[20:21] op_sel_hi:[1,0,1]
    buffer_load_dwordx4 v[48:51], v2, s[36:39], s56 offen offset:1024 nt
    s_waitcnt vmcnt(4)
    s_cbranch_vccnz L_w216
    s_waitcnt vmcnt(2)
L_w216:
    v_lshlrev_b32 v164, 16, v32
    v_and_b32 v165, s60, v32
    v_lshlrev_b32 v166, 16, v33
    v_and_b32 v167, s60, v33
    v_pk_fma_f32 v[14:15], v[164:165], v[22:23], v[14:15] op_sel:[0,1,0] op_sel_hi:[1,1,1]
    v_lshlrev_b32 v164, 16, v34
    v_and_b32 v165, s60, v34
    v_pk_fma_f32 v[16:17], v[166:167], v[22:23], v[16:17] op_sel:[0,1,0] op_sel_hi:[1,1,1]
    v_lshlrev_b32 v166, 16, v35
    v_and_b32 v167, s60, v35
    v_pk_fma_f32 v[18:19], v[164:165], v[22:23], v[18:19] op_sel:[0,1,0] op_sel_hi:[1,1,1]
    v_pk_fma_f32 v[20:21], v[166:167], v[22:23], v[20:21] op_sel:[0,1,0] op_sel_hi:[1,1,1]
    buffer_load_dwordx4 v[32:35], v2, s[36:39], s56 offen offset:2048 nt
    s_waitcnt vmcnt(4)
    s_cbranch_vccnz L_w217
    s_waitcnt vmcnt(2)
L_w217:
    v_lshlrev_b32 v164, 16, v36
    v_and_b32 v165, s60, v36
    v_lshlrev_b32 v166, 16, v37
    v_and_b32 v167, s60, v37
    v_pk_fma_f32 v[14:15], v[164:165], v[24:25], v[14:15] op_sel_hi:[1,0,1]
    v_lshlrev_b32 v164, 16, v38
    v_and_b32 v165, s60, v38
    v_pk_fma_f32 v[16:17], v[166:167], v[24:25], v[16:17] op_sel_hi:[1,0,1]
    v_lshlrev_b32 v166, 16, v39
    v_and_b32 v167, s60, v39
    v_pk_fma_f32 v[18:19], v[164:165], v[24:25], v[18:19] op_sel_hi:[1,0,1]
    v_pk_fma_f32 v[20:21], v[166:167], v[24:25], v[20:21] op_sel_hi:[1,0,1]
    buffer_load_dwordx4 v[36:39], v2, s[36:39], s56 offen offset:3072 nt
    s_waitcnt vmcnt(4)
    s_cbranch_vccnz L_w218
    s_waitcnt vmcnt(2)
L_w218:
    v_lshlrev_b32 v164, 16, v40
    v_and_b32 v165, s60, v40
    v_lshlrev_b32 v166, 16, v41
    v_and_b32 v167, s60, v41
    v_pk_fma_f32 v[14:15], v[164:165], v[24:25], v[14:15] op_sel:[0,1,0] op_sel_hi:[1,1,1]
    v_lshlrev_b32 v164, 16, v42
    v_and_b32 v165, s60, v42
    v_pk_fma_f32 v[16:17], v[166:167], v[24:25], v[16:17] op_sel:[0,1,0] op_sel_hi:[1,1,1]
    v_lshlrev_b32 v166, 16, v43
    v_and_b32 v167, s60, v43
    v_pk_fma_f32 v[18:19], v[164:165], v[24:25], v[18:19] op_sel:[0,1,0] op_sel_hi:[1,1,1]
    v_pk_fma_f32 v[20:21], v[166:167], v[24:25], v[20:21] op_sel:[0,1,0] op_sel_hi:[1,1,1]
    s_add_u32 s56, s56, 65536
    buffer_load_dwordx4 v[40:43], v2, s[36:39], s56 offen offset:0 nt
    s_waitcnt lgkmcnt(0)
    s_cmp_lg_u32 s16, 0
    s_cselect_b64 vcc, -1, 0
    s_subb_u32 s16, s16, 0
    ds_read_b128 v[22:25], v13 offset:1216
    s_waitcnt vmcnt(4)
    s_cbranch_vccnz L_w219
    s_waitcnt vmcnt(2)
L_w219:
    s_cmp_eq_u32 s21, 0
    s_cbranch_scc1 L_w220
    s_waitcnt vmcnt(1)
    s_sub_u32 s21, s21, 1
L_w220:
    s_barrier
    v_lshlrev_b32 v164, 16, v44
    v_and_b32 v165, s60, v44
    v_lshlrev_b32 v166, 16, v45
    v_and_b32 v167, s60, v45
    v_pk_fma_f32 v[14:15], v[164:165], v[8:9], v[14:15] op_sel_hi:[1,0,1]
    v_lshlrev_b32 v164, 16, v46
    v_and_b32 v165, s60, v46
    v_pk_fma_f32 v[16:17], v[166:167], v[8:9], v[16:17] op_sel_hi:[1,0,1]
    v_lshlrev_b32 v166, 16, v47
    v_and_b32 v167, s60, v47
    v_pk_fma_f32 v[18:19], v[164:165], v[8:9], v[18:19] op_sel_hi:[1,0,1]
    v_pk_fma_f32 v[20:21], v[166:167], v[8:9], v[20:21] op_sel_hi:[1,0,1]
    buffer_load_dwordx4 v[44:47], v2, s[36:39], s56 offen offset:1024 nt
    s_waitcnt vmcnt(4)
    s_cbranch_vccnz L_w221
    s_waitcnt vmcnt(2)
L_w221:
    v_lshlrev_b32 v164, 16, v48
    v_and_b32 v165, s60, v48
    v_lshlrev_b32 v166, 16, v49
    v_and_b32 v167, s60, v49
    v_pk_fma_f32 v[14:15], v[164:165], v[8:9], v[14:15] op_sel:[0,1,0] op_sel_hi:[1,1,1]
    v_lshlrev_b32 v164, 16, v50
    v_and_b32 v165, s60, v50
    v_pk_fma_f32 v[16:17], v[166:167], v[8:9], v[16:17] op_sel:[0,1,0] op_sel_hi:[1,1,1]
    v_lshlrev_b32 v166, 16, v51
    v_and_b32 v167, s60, v51
    v_pk_fma_f32 v[18:19], v[164:165], v[8:9], v[18:19] op_sel:[0,1,0] op_sel_hi:[1,1,1]
    v_pk_fma_f32 v[20:21], v[166:167], v[8:9], v[20:21] op_sel:[0,1,0] op_sel_hi:[1,1,1]
    buffer_load_dwordx4 v[48:51], v2, s[36:39], s56 offen offset:2048 nt
    s_waitcnt vmcnt(4)
    s_cbranch_vccnz L_w222
    s_waitcnt vmcnt(2)
L_w222:
    v_lshlrev_b32 v164, 16, v32
    v_and_b32 v165, s60, v32
    v_lshlrev_b32 v166, 16, v33
    v_and_b32 v167, s60, v33
    v_pk_fma_f32 v[14:15], v[164:165], v[10:11], v[14:15] op_sel_hi:[1,0,1]
    v_lshlrev_b32 v164, 16, v34
    v_and_b32 v165, s60, v34
    v_pk_fma_f32 v[16:17], v[166:167], v[10:11], v[16:17] op_sel_hi:[1,0,1]
    v_lshlrev_b32 v166, 16, v35
    v_and_b32 v167, s60, v35
    v_pk_fma_f32 v[18:19], v[164:165], v[10:11], v[18:19] op_sel_hi:[1,0,1]
    v_pk_fma_f32 v[20:21], v[166:167], v[10:11], v[20:21] op_sel_hi:[1,0,1]
    buffer_load_dwordx4 v[32:35], v2, s[36:39], s56 offen offset:3072 nt
    s_waitcnt vmcnt(4)
    s_cbranch_vccnz L_w223
    s_waitcnt vmcnt(2)
L_w223:
    v_lshlrev_b32 v164, 16, v36
    v_and_b32 v165, s60, v36
    v_lshlrev_b32 v166, 16, v37
    v_and_b32 v167, s60, v37
    v_pk_fma_f32 v[14:15], v[164:165], v[10:11], v[14:15] op_sel:[0,1,0] op_sel_hi:[1,1,1]
    v_lshlrev_b32 v164, 16, v38
    v_and_b32 v165, s60, v38
    v_pk_fma_f32 v[16:17], v[166:167], v[10:11], v[16:17] op_sel:[0,1,0] op_sel_hi:[1,1,1]
    v_lshlrev_b32 v166, 16, v39
    v_and_b32 v167, s60, v39
    v_pk_fma_f32 v[18:19], v[164:165], v[10:11], v[18:19] op_sel:[0,1,0] op_sel_hi:[1,1,1]
    v_pk_fma_f32 v[20:21], v[166:167], v[10:11], v[20:21] op_sel:[0,1,0] op_sel_hi:[1,1,1]
    s_add_u32 s56, s56, 65536
    buffer_load_dwordx4 v[36:39], v2, s[36:39], s56 offen offset:0 nt
    s_waitcnt lgkmcnt(0)
    s_cmp_lg_u32 s16, 0
    s_cselect_b64 vcc, -1, 0
    s_subb_u32 s16, s16, 0
    ds_read_b128 v[8:11], v13 offset:1280
    s_waitcnt vmcnt(4)
    s_cbranch_vccnz L_w224
    s_waitcnt vmcnt(2)
L_w224:
    s_cmp_eq_u32 s21, 0
    s_cbranch_scc1 L_w225
    s_waitcnt vmcnt(1)
    s_sub_u32 s21, s21, 1
L_w225:
    s_barrier
    ds_read_b32 v31, v4 offset:12568
    v_lshlrev_b32 v164, 16, v40
    v_and_b32 v165, s60, v40
    v_lshlrev_b32 v166, 16, v41
    v_and_b32 v167, s60, v41
    v_pk_fma_f32 v[14:15], v[164:165], v[22:23], v[14:15] op_sel_hi:[1,0,1]
    v_lshlrev_b32 v164, 16, v42
    v_and_b32 v165, s60, v42
    v_pk_fma_f32 v[16:17], v[166:167], v[22:23], v[16:17] op_sel_hi:[1,0,1]
    v_lshlrev_b32 v166, 16, v43
    v_and_b32 v167, s60, v43
    v_pk_fma_f32 v[18:19], v[164:165], v[22:23], v[18:19] op_sel_hi:[1,0,1]
    v_pk_fma_f32 v[20:21], v[166:167], v[22:23], v[20:21] op_sel_hi:[1,0,1]
    buffer_load_dwordx4 v[40:43], v2, s[36:39], s56 offen offset:1024 nt
    s_waitcnt vmcnt(4)
    s_cbranch_vccnz L_w226
    s_waitcnt vmcnt(2)
L_w226:
    v_lshlrev_b32 v164, 16, v44
    v_and_b32 v165, s60, v44
    v_lshlrev_b32 v166, 16, v45
    v_and_b32 v167, s60, v45
    v_pk_fma_f32 v[14:15], v[164:165], v[22:23], v[14:15] op_sel:[0,1,0] op_sel_hi:[1,1,1]
    v_lshlrev_b32 v164, 16, v46
    v_and_b32 v165, s60, v46
    v_pk_fma_f32 v[16:17], v[166:167], v[22:23], v[16:17] op_sel:[0,1,0] op_sel_hi:[1,1,1]
    v_lshlrev_b32 v166, 16, v47
    v_and_b32 v167, s60, v47
    v_pk_fma_f32 v[18:19], v[164:165], v[22:23], v[18:19] op_sel:[0,1,0] op_sel_hi:[1,1,1]
    v_pk_fma_f32 v[20:21], v[166:167], v[22:23], v[20:21] op_sel:[0,1,0] op_sel_hi:[1,1,1]
    buffer_load_dwordx4 v[44:47], v2, s[36:39], s56 offen offset:2048 nt
    s_waitcnt vmcnt(4)
    s_cbranch_vccnz L_w227
    s_waitcnt vmcnt(2)
L_w227:
    s_waitcnt lgkmcnt(0)
    v_readfirstlane_b32 s23, v31
    s_mov_b32 s22, -1
    s_cmp_lg_u32 s3, 0
    s_cbranch_scc1 L_m48
    s_cmp_eq_u32 s23, 0
    s_cbranch_scc1 L_m48
    s_mov_b32 s22, 1
    s_atomic_add s22, s[64:65], 24576 glc
L_m48:
    v_lshlrev_b32 v164, 16, v48
    v_and_b32 v165, s60, v48
    v_lshlrev_b32 v166, 16, v49
    v_and_b32 v167, s60, v49
    v_pk_fma_f32 v[14:15], v[164:165], v[24:25], v[14:15] op_sel_hi:[1,0,1]
    v_lshlrev_b32 v164, 16, v50
    v_and_b32 v165, s60, v50
    v_pk_fma_f32 v[16:17], v[166:167], v[24:25], v[16:17] op_sel_hi:[1,0,1]
    v_lshlrev_b32 v166, 16, v51
    v_and_b32 v167, s60, v51
    v_pk_fma_f32 v[18:19], v[164:165], v[24:25], v[18:19] op_sel_hi:[1,0,1]
    v_pk_fma_f32 v[20:21], v[166:167], v[24:25], v[20:21] op_sel_hi:[1,0,1]
    buffer_load_dwordx4 v[48:51], v2, s[36:39], s56 offen offset:3072 nt
    s_waitcnt vmcnt(4)
    s_cbranch_vccnz L_w228
    s_waitcnt vmcnt(2)
L_w228:
    v_lshlrev_b32 v164, 16, v32
    v_and_b32 v165, s60, v32
    v_lshlrev_b32 v166, 16, v33
    v_and_b32 v167, s60, v33
    v_pk_fma_f32 v[14:15], v[164:165], v[24:25], v[14:15] op_sel:[0,1,0] op_sel_hi:[1,1,1]
    v_lshlrev_b32 v164, 16, v34
    v_and_b32 v165, s60, v34
    v_pk_fma_f32 v[16:17], v[166:167], v[24:25], v[16:17] op_sel:[0,1,0] op_sel_hi:[1,1,1]
    v_lshlrev_b32 v166, 16, v35
    v_and_b32 v167, s60, v35
    v_pk_fma_f32 v[18:19], v[164:165], v[24:25], v[18:19] op_sel:[0,1,0] op_sel_hi:[1,1,1]
    v_pk_fma_f32 v[20:21], v[166:167], v[24:25], v[20:21] op_sel:[0,1,0] op_sel_hi:[1,1,1]
    s_add_u32 s56, s56, 65536
    buffer_load_dwordx4 v[32:35], v2, s[36:39], s56 offen offset:0 nt
    s_cmp_lg_u32 s16, 0
    s_cselect_b64 vcc, -1, 0
    s_subb_u32 s16, s16, 0
    ds_read_b128 v[22:25], v13 offset:1344
    s_waitcnt vmcnt(4)
    s_cbranch_vccnz L_w229
    s_waitcnt vmcnt(2)
L_w229:
    s_cmp_eq_u32 s21, 0
    s_cbranch_scc1 L_w230
    s_waitcnt vmcnt(1)
    s_sub_u32 s21, s21, 1
L_w230:
    s_barrier
    v_lshlrev_b32 v164, 16, v36
    v_and_b32 v165, s60, v36
    v_lshlrev_b32 v166, 16, v37
    v_and_b32 v167, s60, v37
    v_pk_fma_f32 v[14:15], v[164:165], v[8:9], v[14:15] op_sel_hi:[1,0,1]
    v_lshlrev_b32 v164, 16, v38
    v_and_b32 v165, s60, v38
    v_pk_fma_f32 v[16:17], v[166:167], v[8:9], v[16:17] op_sel_hi:[1,0,1]
    v_lshlrev_b32 v166, 16, v39
    v_and_b32 v167, s60, v39
    v_pk_fma_f32 v[18:19], v[164:165], v[8:9], v[18:19] op_sel_hi:[1,0,1]
    v_pk_fma_f32 v[20:21], v[166:167], v[8:9], v[20:21] op_sel_hi:[1,0,1]
    buffer_load_dwordx4 v[36:39], v2, s[36:39], s56 offen offset:1024 nt
    s_waitcnt vmcnt(4)
    s_cbranch_vccnz L_w231
    s_waitcnt vmcnt(2)
L_w231:
    v_lshlrev_b32 v164, 16, v40
    v_and_b32 v165, s60, v40
    v_lshlrev_b32 v166, 16, v41
    v_and_b32 v167, s60, v41
    v_pk_fma_f32 v[14:15], v[164:165], v[8:9], v[14:15] op_sel:[0,1,0] op_sel_hi:[1,1,1]
    v_lshlrev_b32 v164, 16, v42
    v_and_b32 v165, s60, v42
    v_pk_fma_f32 v[16:17], v[166:167], v[8:9], v[16:17] op_sel:[0,1,0] op_sel_hi:[1,1,1]
    v_lshlrev_b32 v166, 16, v43
    v_and_b32 v167, s60, v43
    v_pk_fma_f32 v[18:19], v[164:165], v[8:9], v[18:19] op_sel:[0,1,0] op_sel_hi:[1,1,1]
    v_pk_fma_f32 v[20:21], v[166:167], v[8:9], v[20:21] op_sel:[0,1,0] op_sel_hi:[1,1,1]
    buffer_load_dwordx4 v[40:43], v2, s[36:39], s56 offen offset:2048 nt
    s_waitcnt vmcnt(4)
    s_cbranch_vccnz L_w232
    s_waitcnt vmcnt(2)
L_w232:
    v_lshlrev_b32 v164, 16, v44
    v_and_b32 v165, s60, v44
    v_lshlrev_b32 v166, 16, v45
    v_and_b32 v167, s60, v45
    v_pk_fma_f32 v[14:15], v[164:165], v[10:11], v[14:15] op_sel_hi:[1,0,1]
    v_lshlrev_b32 v164, 16, v46
    v_and_b32 v165, s60, v46
    v_pk_fma_f32 v[16:17], v[166:167], v[10:11], v[16:17] op_sel_hi:[1,0,1]
    v_lshlrev_b32 v166, 16, v47
    v_and_b32 v167, s60, v47
    v_pk_fma_f32 v[18:19], v[164:165], v[10:11], v[18:19] op_sel_hi:[1,0,1]
    v_pk_fma_f32 v[20:21], v[166:167], v[10:11], v[20:21] op_sel_hi:[1,0,1]
    buffer_load_dwordx4 v[44:47], v2, s[36:39], s56 offen offset:3072 nt
    s_waitcnt vmcnt(4)
    s_cbranch_vccnz L_w233
    s_waitcnt vmcnt(2)
L_w233:
    v_lshlrev_b32 v164, 16, v48
    v_and_b32 v165, s60, v48
    v_lshlrev_b32 v166, 16, v49
    v_and_b32 v167, s60, v49
    v_pk_fma_f32 v[14:15], v[164:165], v[10:11], v[14:15] op_sel:[0,1,0] op_sel_hi:[1,1,1]
    v_lshlrev_b32 v164, 16, v50
    v_and_b32 v165, s60, v50
    v_pk_fma_f32 v[16:17], v[166:167], v[10:11], v[16:17] op_sel:[0,1,0] op_sel_hi:[1,1,1]
    v_lshlrev_b32 v166, 16, v51
    v_and_b32 v167, s60, v51
    v_pk_fma_f32 v[18:19], v[164:165], v[10:11], v[18:19] op_sel:[0,1,0] op_sel_hi:[1,1,1]
    v_pk_fma_f32 v[20:21], v[166:167], v[10:11], v[20:21] op_sel:[0,1,0] op_sel_hi:[1,1,1]
    s_add_u32 s56, s56, 65536
    buffer_load_dwordx4 v[48:51], v2, s[36:39], s56 offen offset:0 nt
    s_waitcnt lgkmcnt(0)
    s_cmp_lg_u32 s3, 0
    s_cbranch_scc1 L_h50
    s_add_u32 s22, s22, 1
    s_min_u32 s22, s22, 15
    s_lshl_b32 s22, s22, 2
    s_mov_b32 s24, 0xabcd
    s_mov_b32 s25, 0x75310000
    s_lshr_b64 s[24:25], s[24:25], s22
    s_and_b32 s22, s24, 15
    v_mov_b32 v31, s22
    ds_write_b32 v4, v31 offset:12564
L_h50:
    s_cmp_lg_u32 s16, 0
    s_cselect_b64 vcc, -1, 0
    s_subb_u32 s16, s16, 0
    ds_read_b128 v[8:11], v13 offset:1408
    s_waitcnt vmcnt(4)
    s_cbranch_vccnz L_w234
    s_waitcnt vmcnt(2)
L_w234:
    s_cmp_eq_u32 s21, 0
    s_cbranch_scc1 L_w235
    s_waitcnt vmcnt(1)
    s_sub_u32 s21, s21, 1
L_w235:
    s_barrier
    v_lshlrev_b32 v164, 16, v32
    v_and_b32 v165, s60, v32
    v_lshlrev_b32 v166, 16, v33
    v_and_b32 v167, s60, v33
    v_pk_fma_f32 v[14:15], v[164:165], v[22:23], v[14:15] op_sel_hi:[1,0,1]
    v_lshlrev_b32 v164, 16, v34
    v_and_b32 v165, s60, v34
    v_pk_fma_f32 v[16:17], v[166:167], v[22:23], v[16:17] op_sel_hi:[1,0,1]
    v_lshlrev_b32 v166, 16, v35
    v_and_b32 v167, s60, v35
    v_pk_fma_f32 v[18:19], v[164:165], v[22:23], v[18:19] op_sel_hi:[1,0,1]
    v_pk_fma_f32 v[20:21], v[166:167], v[22:23], v[20:21] op_sel_hi:[1,0,1]
    buffer_load_dwordx4 v[32:35], v2, s[36:39], s56 offen offset:1024 nt
    s_waitcnt vmcnt(4)
    s_cbranch_vccnz L_w236
    s_waitcnt vmcnt(2)
L_w236:
    v_lshlrev_b32 v164, 16, v36
    v_and_b32 v165, s60, v36
    v_lshlrev_b32 v166, 16, v37
    v_and_b32 v167, s60, v37
    v_pk_fma_f32 v[14:15], v[164:165], v[22:23], v[14:15] op_sel:[0,1,0] op_sel_hi:[1,1,1]
    v_lshlrev_b32 v164, 16, v38
    v_and_b32 v165, s60, v38
    v_pk_fma_f32 v[16:17], v[166:167], v[22:23], v[16:17] op_sel:[0,1,0] op_sel_hi:[1,1,1]
    v_lshlrev_b32 v166, 16, v39
    v_and_b32 v167, s60, v39
    v_pk_fma_f32 v[18:19], v[164:165], v[22:23], v[18:19] op_sel:[0,1,0] op_sel_hi:[1,1,1]
    v_pk_fma_f32 v[20:21], v[166:167], v[22:23], v[20:21] op_sel:[0,1,0] op_sel_hi:[1,1,1]
    buffer_load_dwordx4 v[36:39], v2, s[36:39], s56 offen offset:2048 nt
    s_waitcnt vmcnt(4)
    s_cbranch_vccnz L_w237
    s_waitcnt vmcnt(2)
L_w237:
    v_lshlrev_b32 v164, 16, v40
    v_and_b32 v165, s60, v40
    v_lshlrev_b32 v166, 16, v41
    v_and_b32 v167, s60, v41
    v_pk_fma_f32 v[14:15], v[164:165], v[24:25], v[14:15] op_sel_hi:[1,0,1]
    v_lshlrev_b32 v164, 16, v42
    v_and_b32 v165, s60, v42
    v_pk_fma_f32 v[16:17], v[166:167], v[24:25], v[16:17] op_sel_hi:[1,0,1]
    v_lshlrev_b32 v166, 16, v43
    v_and_b32 v167, s60, v43
    v_pk_fma_f32 v[18:19], v[164:165], v[24:25], v[18:19] op_sel_hi:[1,0,1]
    v_pk_fma_f32 v[20:21], v[166:167], v[24:25], v[20:21] op_sel_hi:[1,0,1]
    buffer_load_dwordx4 v[40:43], v2, s[36:39], s56 offen offset:3072 nt
    s_waitcnt vmcnt(4)
    s_cbranch_vccnz L_w238
    s_waitcnt vmcnt(2)
L_w238:
    v_lshlrev_b32 v164, 16, v44
    v_and_b32 v165, s60, v44
    v_lshlrev_b32 v166, 16, v45
    v_and_b32 v167, s60, v45
    v_pk_fma_f32 v[14:15], v[164:165], v[24:25], v[14:15] op_sel:[0,1,0] op_sel_hi:[1,1,1]
    v_lshlrev_b32 v164, 16, v46
    v_and_b32 v165, s60, v46
    v_pk_fma_f32 v[16:17], v[166:167], v[24:25], v[16:17] op_sel:[0,1,0] op_sel_hi:[1,1,1]
    v_lshlrev_b32 v166, 16, v47
    v_and_b32 v167, s60, v47
    v_pk_fma_f32 v[18:19], v[164:165], v[24:25], v[18:19] op_sel:[0,1,0] op_sel_hi:[1,1,1]
    v_pk_fma_f32 v[20:21], v[166:167], v[24:25], v[20:21] op_sel:[0,1,0] op_sel_hi:[1,1,1]
    s_add_u32 s56, s56, 65536
    buffer_load_dwordx4 v[44:47], v2, s[36:39], s56 offen offset:0 nt
    s_waitcnt lgkmcnt(0)
    s_cmp_lg_u32 s16, 0
    s_cselect_b64 vcc, -1, 0
    s_subb_u32 s16, s16, 0
    ds_read_b128 v[22:25], v13 offset:1472
    s_waitcnt vmcnt(4)
    s_cbranch_vccnz L_w239
    s_waitcnt vmcnt(2)
L_w239:
    s_cmp_eq_u32 s21, 0
    s_cbranch_scc1 L_w240
    s_waitcnt vmcnt(1)
    s_sub_u32 s21, s21, 1
L_w240:
    s_barrier
    ds_read_b32 v31, v4 offset:12564
    v_lshlrev_b32 v164, 16, v48
    v_and_b32 v165, s60, v48
    v_lshlrev_b32 v166, 16, v49
    v_and_b32 v167, s60, v49
    v_pk_fma_f32 v[14:15], v[164:165], v[8:9], v[14:15] op_sel_hi:[1,0,1]
    v_lshlrev_b32 v164, 16, v50
    v_and_b32 v165, s60, v50
    v_pk_fma_f32 v[16:17], v[166:167], v[8:9], v[16:17] op_sel_hi:[1,0,1]
    v_lshlrev_b32 v166, 16, v51
    v_and_b32 v167, s60, v51
    v_pk_fma_f32 v[18:19], v[164:165], v[8:9], v[18:19] op_sel_hi:[1,0,1]
    v_pk_fma_f32 v[20:21], v[166:167], v[8:9], v[20:21] op_sel_hi:[1,0,1]
    buffer_load_dwordx4 v[48:51], v2, s[36:39], s56 offen offset:1024 nt
    s_waitcnt vmcnt(4)
    s_cbranch_vccnz L_w241
    s_waitcnt vmcnt(2)
L_w241:
    v_lshlrev_b32 v164, 16, v32
    v_and_b32 v165, s60, v32
    v_lshlrev_b32 v166, 16, v33
    v_and_b32 v167, s60, v33
    v_pk_fma_f32 v[14:15], v[164:165], v[8:9], v[14:15] op_sel:[0,1,0] op_sel_hi:[1,1,1]
    v_lshlrev_b32 v164, 16, v34
    v_and_b32 v165, s60, v34
    v_pk_fma_f32 v[16:17], v[166:167], v[8:9], v[16:17] op_sel:[0,1,0] op_sel_hi:[1,1,1]
    v_lshlrev_b32 v166, 16, v35
    v_and_b32 v167, s60, v35
    v_pk_fma_f32 v[18:19], v[164:165], v[8:9], v[18:19] op_sel:[0,1,0] op_sel_hi:[1,1,1]
    v_pk_fma_f32 v[20:21], v[166:167], v[8:9], v[20:21] op_sel:[0,1,0] op_sel_hi:[1,1,1]
    buffer_load_dwordx4 v[32:35], v2, s[36:39], s56 offen offset:2048 nt
    s_waitcnt vmcnt(4)
    s_cbranch_vccnz L_w242
    s_waitcnt vmcnt(2)
L_w242:
    v_lshlrev_b32 v164, 16, v36
    v_and_b32 v165, s60, v36
    v_lshlrev_b32 v166, 16, v37
    v_and_b32 v167, s60, v37
    v_pk_fma_f32 v[14:15], v[164:165], v[10:11], v[14:15] op_sel_hi:[1,0,1]
    v_lshlrev_b32 v164, 16, v38
    v_and_b32 v165, s60, v38
    v_pk_fma_f32 v[16:17], v[166:167], v[10:11], v[16:17] op_sel_hi:[1,0,1]
    v_lshlrev_b32 v166, 16, v39
    v_and_b32 v167, s60, v39
    v_pk_fma_f32 v[18:19], v[164:165], v[10:11], v[18:19] op_sel_hi:[1,0,1]
    v_pk_fma_f32 v[20:21], v[166:167], v[10:11], v[20:21] op_sel_hi:[1,0,1]
    buffer_load_dwordx4 v[36:39], v2, s[36:39], s56 offen offset:3072 nt
    s_waitcnt vmcnt(4)
    s_cbranch_vccnz L_w243
    s_waitcnt vmcnt(2)
L_w243:
    v_lshlrev_b32 v164, 16, v40
    v_and_b32 v165, s60, v40
    v_lshlrev_b32 v166, 16, v41
    v_and_b32 v167, s60, v41
    v_pk_fma_f32 v[14:15], v[164:165], v[10:11], v[14:15] op_sel:[0,1,0] op_sel_hi:[1,1,1]
    v_lshlrev_b32 v164, 16, v42
    v_and_b32 v165, s60, v42
    v_pk_fma_f32 v[16:17], v[166:167], v[10:11], v[16:17] op_sel:[0,1,0] op_sel_hi:[1,1,1]
    v_lshlrev_b32 v166, 16, v43
    v_and_b32 v167, s60, v43
    v_pk_fma_f32 v[18:19], v[164:165], v[10:11], v[18:19] op_sel:[0,1,0] op_sel_hi:[1,1,1]
    v_pk_fma_f32 v[20:21], v[166:167], v[10:11], v[20:21] op_sel:[0,1,0] op_sel_hi:[1,1,1]
    s_add_u32 s56, s56, 65536
    buffer_load_dwordx4 v[40:43], v2, s[36:39], s56 offen offset:0 nt
    s_waitcnt lgkmcnt(0)
    v_readfirstlane_b32 s16, v31
    s_sub_u32 s21, s16, 8
    s_cselect_b32 s21, 0, s21
    s_cselect_b32 s16, s16, 0
    s_cmp_lg_u32 s16, 0
    s_cselect_b64 vcc, -1, 0
    s_subb_u32 s16, s16, 0
    ds_read_b128 v[8:11], v13 offset:1536
    s_waitcnt vmcnt(4)
    s_cbranch_vccnz L_w244
    s_waitcnt vmcnt(2)
L_w244:
    s_cmp_eq_u32 s21, 0
    s_cbranch_scc1 L_w245
    s_waitcnt vmcnt(1)
    s_sub_u32 s21, s21, 1
L_w245:
    s_barrier
    v_lshlrev_b32 v164, 16, v44
    v_and_b32 v165, s60, v44
    v_lshlrev_b32 v166, 16, v45
    v_and_b32 v167, s60, v45
    v_pk_fma_f32 v[14:15], v[164:165], v[22:23], v[14:15] op_sel_hi:[1,0,1]
    v_lshlrev_b32 v164, 16, v46
    v_and_b32 v165, s60, v46
    v_pk_fma_f32 v[16:17], v[166:167], v[22:23], v[16:17] op_sel_hi:[1,0,1]
    v_lshlrev_b32 v166, 16, v47
    v_and_b32 v167, s60, v47
    v_pk_fma_f32 v[18:19], v[164:165], v[22:23], v[18:19] op_sel_hi:[1,0,1]
    v_pk_fma_f32 v[20:21], v[166:167], v[22:23], v[20:21] op_sel_hi:[1,0,1]
    buffer_load_dwordx4 v[44:47], v2, s[36:39], s56 offen offset:1024 nt
    s_waitcnt vmcnt(4)
    s_cbranch_vccnz L_w246
    s_waitcnt vmcnt(2)
L_w246:
    v_lshlrev_b32 v164, 16, v48
    v_and_b32 v165, s60, v48
    v_lshlrev_b32 v166, 16, v49
    v_and_b32 v167, s60, v49
    v_pk_fma_f32 v[14:15], v[164:165], v[22:23], v[14:15] op_sel:[0,1,0] op_sel_hi:[1,1,1]
    v_lshlrev_b32 v164, 16, v50
    v_and_b32 v165, s60, v50
    v_pk_fma_f32 v[16:17], v[166:167], v[22:23], v[16:17] op_sel:[0,1,0] op_sel_hi:[1,1,1]
    v_lshlrev_b32 v166, 16, v51
    v_and_b32 v167, s60, v51
    v_pk_fma_f32 v[18:19], v[164:165], v[22:23], v[18:19] op_sel:[0,1,0] op_sel_hi:[1,1,1]
    v_pk_fma_f32 v[20:21], v[166:167], v[22:23], v[20:21] op_sel:[0,1,0] op_sel_hi:[1,1,1]
    buffer_load_dwordx4 v[48:51], v2, s[36:39], s56 offen offset:2048 nt
    s_waitcnt vmcnt(4)
    s_cbranch_vccnz L_w247
    s_waitcnt vmcnt(2)
L_w247:
    v_lshlrev_b32 v164, 16, v32
    v_and_b32 v165, s60, v32
    v_lshlrev_b32 v166, 16, v33
    v_and_b32 v167, s60, v33
    v_pk_fma_f32 v[14:15], v[164:165], v[24:25], v[14:15] op_sel_hi:[1,0,1]
    v_lshlrev_b32 v164, 16, v34
    v_and_b32 v165, s60, v34
    v_pk_fma_f32 v[16:17], v[166:167], v[24:25], v[16:17] op_sel_hi:[1,0,1]
    v_lshlrev_b32 v166, 16, v35
    v_and_b32 v167, s60, v35
    v_pk_fma_f32 v[18:19], v[164:165], v[24:25], v[18:19] op_sel_hi:[1,0,1]
    v_pk_fma_f32 v[20:21], v[166:167], v[24:25], v[20:21] op_sel_hi:[1,0,1]
    buffer_load_dwordx4 v[32:35], v2, s[36:39], s56 offen offset:3072 nt
    s_waitcnt vmcnt(4)
    s_cbranch_vccnz L_w248
    s_waitcnt vmcnt(2)
L_w248:
    v_lshlrev_b32 v164, 16, v36
    v_and_b32 v165, s60, v36
    v_lshlrev_b32 v166, 16, v37
    v_and_b32 v167, s60, v37
    v_pk_fma_f32 v[14:15], v[164:165], v[24:25], v[14:15] op_sel:[0,1,0] op_sel_hi:[1,1,1]
    v_lshlrev_b32 v164, 16, v38
    v_and_b32 v165, s60, v38
    v_pk_fma_f32 v[16:17], v[166:167], v[24:25], v[16:17] op_sel:[0,1,0] op_sel_hi:[1,1,1]
    v_lshlrev_b32 v166, 16, v39
    v_and_b32 v167, s60, v39
    v_pk_fma_f32 v[18:19], v[164:165], v[24:25], v[18:19] op_sel:[0,1,0] op_sel_hi:[1,1,1]
    v_pk_fma_f32 v[20:21], v[166:167], v[24:25], v[20:21] op_sel:[0,1,0] op_sel_hi:[1,1,1]
    s_add_u32 s56, s56, 65536
    buffer_load_dwordx4 v[36:39], v2, s[36:39], s56 offen offset:0 nt
    s_waitcnt lgkmcnt(0)
    s_cmp_lg_u32 s16, 0
    s_cselect_b64 vcc, -1, 0
    s_subb_u32 s16, s16, 0
    ds_read_b128 v[22:25], v13 offset:1600
    s_waitcnt vmcnt(4)
    s_cbranch_vccnz L_w249
    s_waitcnt vmcnt(2)
L_w249:
    s_cmp_eq_u32 s21, 0
    s_cbranch_scc1 L_w250
    s_waitcnt vmcnt(1)
    s_sub_u32 s21, s21, 1
L_w250:
    s_barrier
    ds_read_b32 v31, v4 offset:12568
    v_lshlrev_b32 v164, 16, v40
    v_and_b32 v165, s60, v40
    v_lshlrev_b32 v166, 16, v41
    v_and_b32 v167, s60, v41
    v_pk_fma_f32 v[14:15], v[164:165], v[8:9], v[14:15] op_sel_hi:[1,0,1]
    v_lshlrev_b32 v164, 16, v42
    v_and_b32 v165, s60, v42
    v_pk_fma_f32 v[16:17], v[166:167], v[8:9], v[16:17] op_sel_hi:[1,0,1]
    v_lshlrev_b32 v166, 16, v43
    v_and_b32 v167, s60, v43
    v_pk_fma_f32 v[18:19], v[164:165], v[8:9], v[18:19] op_sel_hi:[1,0,1]
    v_pk_fma_f32 v[20:21], v[166:167], v[8:9], v[20:21] op_sel_hi:[1,0,1]
    buffer_load_dwordx4 v[40:43], v2, s[36:39], s56 offen offset:1024 nt
    s_waitcnt vmcnt(4)
    s_cbranch_vccnz L_w251
    s_waitcnt vmcnt(2)
L_w251:
    v_lshlrev_b32 v164, 16, v44
    v_and_b32 v165, s60, v44
    v_lshlrev_b32 v166, 16, v45
    v_and_b32 v167, s60, v45
    v_pk_fma_f32 v[14:15], v[164:165], v[8:9], v[14:15] op_sel:[0,1,0] op_sel_hi:[1,1,1]
    v_lshlrev_b32 v164, 16, v46
    v_and_b32 v165, s60, v46
    v_pk_fma_f32 v[16:17], v[166:167], v[8:9], v[16:17] op_sel:[0,1,0] op_sel_hi:[1,1,1]
    v_lshlrev_b32 v166, 16, v47
    v_and_b32 v167, s60, v47
    v_pk_fma_f32 v[18:19], v[164:165], v[8:9], v[18:19] op_sel:[0,1,0] op_sel_hi:[1,1,1]
    v_pk_fma_f32 v[20:21], v[166:167], v[8:9], v[20:21] op_sel:[0,1,0] op_sel_hi:[1,1,1]
    buffer_load_dwordx4 v[44:47], v2, s[36:39], s56 offen offset:2048 nt
    s_waitcnt vmcnt(4)
    s_cbranch_vccnz L_w252
    s_waitcnt vmcnt(2)
L_w252:
    s_waitcnt lgkmcnt(0)
    v_readfirstlane_b32 s23, v31
    s_mov_b32 s22, -1
    s_cmp_lg_u32 s3, 0
    s_cbranch_scc1 L_m53
    s_cmp_eq_u32 s23, 0
    s_cbranch_scc1 L_m53
    s_mov_b32 s22, 1
    s_atomic_add s22, s[64:65], 28672 glc
L_m53:
    v_lshlrev_b32 v164, 16, v48
    v_and_b32 v165, s60, v48
    v_lshlrev_b32 v166, 16, v49
    v_and_b32 v167, s60, v49
    v_pk_fma_f32 v[14:15], v[164:165], v[10:11], v[14:15] op_sel_hi:[1,0,1]
    v_lshlrev_b32 v164, 16, v50
    v_and_b32 v165, s60, v50
    v_pk_fma_f32 v[16:17], v[166:167], v[10:11], v[16:17] op_sel_hi:[1,0,1]
    v_lshlrev_b32 v166, 16, v51
    v_and_b32 v167, s60, v51
    v_pk_fma_f32 v[18:19], v[164:165], v[10:11], v[18:19] op_sel_hi:[1,0,1]
    v_pk_fma_f32 v[20:21], v[166:167], v[10:11], v[20:21] op_sel_hi:[1,0,1]
    buffer_load_dwordx4 v[48:51], v2, s[36:39], s56 offen offset:3072 nt
    s_waitcnt vmcnt(4)
    s_cbranch_vccnz L_w253
    s_waitcnt vmcnt(2)
L_w253:
    v_lshlrev_b32 v164, 16, v32
    v_and_b32 v165, s60, v32
    v_lshlrev_b32 v166, 16, v33
    v_and_b32 v167, s60, v33
    v_pk_fma_f32 v[14:15], v[164:165], v[10:11], v[14:15] op_sel:[0,1,0] op_sel_hi:[1,1,1]
    v_lshlrev_b32 v164, 16, v34
    v_and_b32 v165, s60, v34
    v_pk_fma_f32 v[16:17], v[166:167], v[10:11], v[16:17] op_sel:[0,1,0] op_sel_hi:[1,1,1]
    v_lshlrev_b32 v166, 16, v35
    v_and_b32 v167, s60, v35
    v_pk_fma_f32 v[18:19], v[164:165], v[10:11], v[18:19] op_sel:[0,1,0] op_sel_hi:[1,1,1]
    v_pk_fma_f32 v[20:21], v[166:167], v[10:11], v[20:21] op_sel:[0,1,0] op_sel_hi:[1,1,1]
    s_add_u32 s56, s56, 65536
    buffer_load_dwordx4 v[32:35], v2, s[36:39], s56 offen offset:0 nt
    s_cmp_lg_u32 s16, 0
    s_cselect_b64 vcc, -1, 0
    s_subb_u32 s16, s16, 0
    ds_read_b128 v[8:11], v13 offset:1664
    s_waitcnt vmcnt(4)
    s_cbranch_vccnz L_w254
    s_waitcnt vmcnt(2)
L_w254:
    s_cmp_eq_u32 s21, 0
    s_cbranch_scc1 L_w255
    s_waitcnt vmcnt(1)
    s_sub_u32 s21, s21, 1
L_w255:
    s_barrier
    v_lshlrev_b32 v164, 16, v36
    v_and_b32 v165, s60, v36
    v_lshlrev_b32 v166, 16, v37
    v_and_b32 v167, s60, v37
    v_pk_fma_f32 v[14:15], v[164:165], v[22:23], v[14:15] op_sel_hi:[1,0,1]
    v_lshlrev_b32 v164, 16, v38
    v_and_b32 v165, s60, v38
    v_pk_fma_f32 v[16:17], v[166:167], v[22:23], v[16:17] op_sel_hi:[1,0,1]
    v_lshlrev_b32 v166, 16, v39
    v_and_b32 v167, s60, v39
    v_pk_fma_f32 v[18:19], v[164:165], v[22:23], v[18:19] op_sel_hi:[1,0,1]
    v_pk_fma_f32 v[20:21], v[166:167], v[22:23], v[20:21] op_sel_hi:[1,0,1]
    buffer_load_dwordx4 v[36:39], v2, s[36:39], s56 offen offset:1024 nt
    s_waitcnt vmcnt(4)
    s_cbranch_vccnz L_w256
    s_waitcnt vmcnt(2)
L_w256:
    v_lshlrev_b32 v164, 16, v40
    v_and_b32 v165, s60, v40
    v_lshlrev_b32 v166, 16, v41
    v_and_b32 v167, s60, v41
    v_pk_fma_f32 v[14:15], v[164:165], v[22:23], v[14:15] op_sel:[0,1,0] op_sel_hi:[1,1,1]
    v_lshlrev_b32 v164, 16, v42
    v_and_b32 v165, s60, v42
    v_pk_fma_f32 v[16:17], v[166:167], v[22:23], v[16:17] op_sel:[0,1,0] op_sel_hi:[1,1,1]
    v_lshlrev_b32 v166, 16, v43
    v_and_b32 v167, s60, v43
    v_pk_fma_f32 v[18:19], v[164:165], v[22:23], v[18:19] op_sel:[0,1,0] op_sel_hi:[1,1,1]
    v_pk_fma_f32 v[20:21], v[166:167], v[22:23], v[20:21] op_sel:[0,1,0] op_sel_hi:[1,1,1]
    buffer_load_dwordx4 v[40:43], v2, s[36:39], s56 offen offset:2048 nt
    s_waitcnt vmcnt(4)
    s_cbranch_vccnz L_w257
    s_waitcnt vmcnt(2)
L_w257:
    v_lshlrev_b32 v164, 16, v44
    v_and_b32 v165, s60, v44
    v_lshlrev_b32 v166, 16, v45
    v_and_b32 v167, s60, v45
    v_pk_fma_f32 v[14:15], v[164:165], v[24:25], v[14:15] op_sel_hi:[1,0,1]
    v_lshlrev_b32 v164, 16, v46
    v_and_b32 v165, s60, v46
    v_pk_fma_f32 v[16:17], v[166:167], v[24:25], v[16:17] op_sel_hi:[1,0,1]
    v_lshlrev_b32 v166, 16, v47
    v_and_b32 v167, s60, v47
    v_pk_fma_f32 v[18:19], v[164:165], v[24:25], v[18:19] op_sel_hi:[1,0,1]
    v_pk_fma_f32 v[20:21], v[166:167], v[24:25], v[20:21] op_sel_hi:[1,0,1]
    buffer_load_dwordx4 v[44:47], v2, s[36:39], s56 offen offset:3072 nt
    s_waitcnt vmcnt(4)
    s_cbranch_vccnz L_w258
    s_waitcnt vmcnt(2)
L_w258:
    v_lshlrev_b32 v164, 16, v48
    v_and_b32 v165, s60, v48
    v_lshlrev_b32 v166, 16, v49
    v_and_b32 v167, s60, v49
    v_pk_fma_f32 v[14:15], v[164:165], v[24:25], v[14:15] op_sel:[0,1,0] op_sel_hi:[1,1,1]
    v_lshlrev_b32 v164, 16, v50
    v_and_b32 v165, s60, v50
    v_pk_fma_f32 v[16:17], v[166:167], v[24:25], v[16:17] op_sel:[0,1,0] op_sel_hi:[1,1,1]
    v_lshlrev_b32 v166, 16, v51
    v_and_b32 v167, s60, v51
    v_pk_fma_f32 v[18:19], v[164:165], v[24:25], v[18:19] op_sel:[0,1,0] op_sel_hi:[1,1,1]
    v_pk_fma_f32 v[20:21], v[166:167], v[24:25], v[20:21] op_sel:[0,1,0] op_sel_hi:[1,1,1]
    s_add_u32 s56, s56, 65536
    buffer_load_dwordx4 v[48:51], v2, s[36:39], s56 offen offset:0 nt
    s_waitcnt lgkmcnt(0)
    s_cmp_lg_u32 s3, 0
    s_cbranch_scc1 L_h55
    s_add_u32 s22, s22, 1
    s_min_u32 s22, s22, 15
    s_lshl_b32 s22, s22, 2
    s_mov_b32 s24, 0x110000ab
    s_mov_b32 s25, 0x44443322
    s_lshr_b64 s[24:25], s[24:25], s22
    s_and_b32 s22, s24, 15
    v_mov_b32 v31, s22
    ds_write_b32 v4, v31 offset:12564
L_h55:
    s_cmp_lg_u32 s16, 0
    s_cselect_b64 vcc, -1, 0
    s_subb_u32 s16, s16, 0
    ds_read_b128 v[22:25], v13 offset:1728
    s_waitcnt vmcnt(4)
    s_cbranch_vccnz L_w259
    s_waitcnt vmcnt(2)
L_w259:
    s_cmp_eq_u32 s21, 0
    s_cbranch_scc1 L_w260
    s_waitcnt vmcnt(1)
    s_sub_u32 s21, s21, 1
L_w260:
    s_barrier
    v_lshlrev_b32 v164, 16, v32
    v_and_b32 v165, s60, v32
    v_lshlrev_b32 v166, 16, v33
    v_and_b32 v167, s60, v33
    v_pk_fma_f32 v[14:15], v[164:165], v[8:9], v[14:15] op_sel_hi:[1,0,1]
    v_lshlrev_b32 v164, 16, v34
    v_and_b32 v165, s60, v34
    v_pk_fma_f32 v[16:17], v[166:167], v[8:9], v[16:17] op_sel_hi:[1,0,1]
    v_lshlrev_b32 v166, 16, v35
    v_and_b32 v167, s60, v35
    v_pk_fma_f32 v[18:19], v[164:165], v[8:9], v[18:19] op_sel_hi:[1,0,1]
    v_pk_fma_f32 v[20:21], v[166:167], v[8:9], v[20:21] op_sel_hi:[1,0,1]
    buffer_load_dwordx4 v[32:35], v2, s[36:39], s56 offen offset:1024 nt
    s_waitcnt vmcnt(4)
    s_cbranch_vccnz L_w261
    s_waitcnt vmcnt(2)
L_w261:
    v_lshlrev_b32 v164, 16, v36
    v_and_b32 v165, s60, v36
    v_lshlrev_b32 v166, 16, v37
    v_and_b32 v167, s60, v37
    v_pk_fma_f32 v[14:15], v[164:165], v[8:9], v[14:15] op_sel:[0,1,0] op_sel_hi:[1,1,1]
    v_lshlrev_b32 v164, 16, v38
    v_and_b32 v165, s60, v38
    v_pk_fma_f32 v[16:17], v[166:167], v[8:9], v[16:17] op_sel:[0,1,0] op_sel_hi:[1,1,1]
    v_lshlrev_b32 v166, 16, v39
    v_and_b32 v167, s60, v39
    v_pk_fma_f32 v[18:19], v[164:165], v[8:9], v[18:19] op_sel:[0,1,0] op_sel_hi:[1,1,1]
    v_pk_fma_f32 v[20:21], v[166:167], v[8:9], v[20:21] op_sel:[0,1,0] op_sel_hi:[1,1,1]
    buffer_load_dwordx4 v[36:39], v2, s[36:39], s56 offen offset:2048 nt
    s_waitcnt vmcnt(4)
    s_cbranch_vccnz L_w262
    s_waitcnt vmcnt(2)
L_w262:
    v_lshlrev_b32 v164, 16, v40
    v_and_b32 v165, s60, v40
    v_lshlrev_b32 v166, 16, v41
    v_and_b32 v167, s60, v41
    v_pk_fma_f32 v[14:15], v[164:165], v[10:11], v[14:15] op_sel_hi:[1,0,1]
    v_lshlrev_b32 v164, 16, v42
    v_and_b32 v165, s60, v42
    v_pk_fma_f32 v[16:17], v[166:167], v[10:11], v[16:17] op_sel_hi:[1,0,1]
    v_lshlrev_b32 v166, 16, v43
    v_and_b32 v167, s60, v43
    v_pk_fma_f32 v[18:19], v[164:165], v[10:11], v[18:19] op_sel_hi:[1,0,1]
    v_pk_fma_f32 v[20:21], v[166:167], v[10:11], v[20:21] op_sel_hi:[1,0,1]
    buffer_load_dwordx4 v[40:43], v2, s[36:39], s56 offen offset:3072 nt
    s_waitcnt vmcnt(4)
    s_cbranch_vccnz L_w263
    s_waitcnt vmcnt(2)
L_w263:
    v_lshlrev_b32 v164, 16, v44
    v_and_b32 v165, s60, v44
    v_lshlrev_b32 v166, 16, v45
    v_and_b32 v167, s60, v45
    v_pk_fma_f32 v[14:15], v[164:165], v[10:11], v[14:15] op_sel:[0,1,0] op_sel_hi:[1,1,1]
    v_lshlrev_b32 v164, 16, v46
    v_and_b32 v165, s60, v46
    v_pk_fma_f32 v[16:17], v[166:167], v[10:11], v[16:17] op_sel:[0,1,0] op_sel_hi:[1,1,1]
    v_lshlrev_b32 v166, 16, v47
    v_and_b32 v167, s60, v47
    v_pk_fma_f32 v[18:19], v[164:165], v[10:11], v[18:19] op_sel:[0,1,0] op_sel_hi:[1,1,1]
    v_pk_fma_f32 v[20:21], v[166:167], v[10:11], v[20:21] op_sel:[0,1,0] op_sel_hi:[1,1,1]
    s_add_u32 s56, s56, 65536
    buffer_load_dwordx4 v[44:47], v2, s[36:39], s56 offen offset:0 nt
    s_waitcnt lgkmcnt(0)
    s_cmp_lg_u32 s16, 0
    s_cselect_b64 vcc, -1, 0
    s_subb_u32 s16, s16, 0
    ds_read_b128 v[8:11], v13 offset:1792
    s_waitcnt vmcnt(4)
    s_cbranch_vccnz L_w264
    s_waitcnt vmcnt(2)
L_w264:
    s_cmp_eq_u32 s21, 0
    s_cbranch_scc1 L_w265
    s_waitcnt vmcnt(1)
    s_sub_u32 s21, s21, 1
L_w265:
    s_barrier
    ds_read_b32 v31, v4 offset:12564
    v_lshlrev_b32 v164, 16, v48
    v_and_b32 v165, s60, v48
    v_lshlrev_b32 v166, 16, v49
    v_and_b32 v167, s60, v49
    v_pk_fma_f32 v[14:15], v[164:165], v[22:23], v[14:15] op_sel_hi:[1,0,1]
    v_lshlrev_b32 v164, 16, v50
    v_and_b32 v165, s60, v50
    v_pk_fma_f32 v[16:17], v[166:167], v[22:23], v[16:17] op_sel_hi:[1,0,1]
    v_lshlrev_b32 v166, 16, v51
    v_and_b32 v167, s60, v51
    v_pk_fma_f32 v[18:19], v[164:165], v[22:23], v[18:19] op_sel_hi:[1,0,1]
    v_pk_fma_f32 v[20:21], v[166:167], v[22:23], v[20:21] op_sel_hi:[1,0,1]
    buffer_load_dwordx4 v[48:51], v2, s[36:39], s56 offen offset:1024 nt
    s_waitcnt vmcnt(4)
    s_cbranch_vccnz L_w266
    s_waitcnt vmcnt(2)
L_w266:
    v_lshlrev_b32 v164, 16, v32
    v_and_b32 v165, s60, v32
    v_lshlrev_b32 v166, 16, v33
    v_and_b32 v167, s60, v33
    v_pk_fma_f32 v[14:15], v[164:165], v[22:23], v[14:15] op_sel:[0,1,0] op_sel_hi:[1,1,1]
    v_lshlrev_b32 v164, 16, v34
    v_and_b32 v165, s60, v34
    v_pk_fma_f32 v[16:17], v[166:167], v[22:23], v[16:17] op_sel:[0,1,0] op_sel_hi:[1,1,1]
    v_lshlrev_b32 v166, 16, v35
    v_and_b32 v167, s60, v35
    v_pk_fma_f32 v[18:19], v[164:165], v[22:23], v[18:19] op_sel:[0,1,0] op_sel_hi:[1,1,1]
    v_pk_fma_f32 v[20:21], v[166:167], v[22:23], v[20:21] op_sel:[0,1,0] op_sel_hi:[1,1,1]
    buffer_load_dwordx4 v[32:35], v2, s[36:39], s56 offen offset:2048 nt
    s_waitcnt vmcnt(4)
    s_cbranch_vccnz L_w267
    s_waitcnt vmcnt(2)
L_w267:
    v_lshlrev_b32 v164, 16, v36
    v_and_b32 v165, s60, v36
    v_lshlrev_b32 v166, 16, v37
    v_and_b32 v167, s60, v37
    v_pk_fma_f32 v[14:15], v[164:165], v[24:25], v[14:15] op_sel_hi:[1,0,1]
    v_lshlrev_b32 v164, 16, v38
    v_and_b32 v165, s60, v38
    v_pk_fma_f32 v[16:17], v[166:167], v[24:25], v[16:17] op_sel_hi:[1,0,1]
    v_lshlrev_b32 v166, 16, v39
    v_and_b32 v167, s60, v39
    v_pk_fma_f32 v[18:19], v[164:165], v[24:25], v[18:19] op_sel_hi:[1,0,1]
    v_pk_fma_f32 v[20:21], v[166:167], v[24:25], v[20:21] op_sel_hi:[1,0,1]
    buffer_load_dwordx4 v[36:39], v2, s[36:39], s56 offen offset:3072 nt
    s_waitcnt vmcnt(4)
    s_cbranch_vccnz L_w268
    s_waitcnt vmcnt(2)
L_w268:
    v_lshlrev_b32 v164, 16, v40
    v_and_b32 v165, s60, v40
    v_lshlrev_b32 v166, 16, v41
    v_and_b32 v167, s60, v41
    v_pk_fma_f32 v[14:15], v[164:165], v[24:25], v[14:15] op_sel:[0,1,0] op_sel_hi:[1,1,1]
    v_lshlrev_b32 v164, 16, v42
    v_and_b32 v165, s60, v42
    v_pk_fma_f32 v[16:17], v[166:167], v[24:25], v[16:17] op_sel:[0,1,0] op_sel_hi:[1,1,1]
    v_lshlrev_b32 v166, 16, v43
    v_and_b32 v167, s60, v43
    v_pk_fma_f32 v[18:19], v[164:165], v[24:25], v[18:19] op_sel:[0,1,0] op_sel_hi:[1,1,1]
    v_pk_fma_f32 v[20:21], v[166:167], v[24:25], v[20:21] op_sel:[0,1,0] op_sel_hi:[1,1,1]
    s_add_u32 s56, s56, 65536
    buffer_load_dwordx4 v[40:43], v2, s[36:39], s56 offen offset:0 nt
    s_waitcnt lgkmcnt(0)
    v_readfirstlane_b32 s16, v31
    s_sub_u32 s21, s16, 8
    s_cselect_b32 s21, 0, s21
    s_cselect_b32 s16, s16, 0
    s_cmp_ge_u32 s16, 3
    s_cselect_b64 vcc, -1, 0
    ds_read_b128 v[22:25], v13 offset:1856
    s_waitcnt vmcnt(4)
    s_cbranch_vccnz L_w269
    s_waitcnt vmcnt(2)
L_w269:
    s_cmp_eq_u32 s21, 0
    s_cbranch_scc1 L_w270
    s_waitcnt vmcnt(1)
    s_sub_u32 s21, s21, 1
L_w270:
    s_barrier
    v_lshlrev_b32 v164, 16, v44
    v_and_b32 v165, s60, v44
    v_lshlrev_b32 v166, 16, v45
    v_and_b32 v167, s60, v45
    v_pk_fma_f32 v[14:15], v[164:165], v[8:9], v[14:15] op_sel_hi:[1,0,1]
    v_lshlrev_b32 v164, 16, v46
    v_and_b32 v165, s60, v46
    v_pk_fma_f32 v[16:17], v[166:167], v[8:9], v[16:17] op_sel_hi:[1,0,1]
    v_lshlrev_b32 v166, 16, v47
    v_and_b32 v167, s60, v47
    v_pk_fma_f32 v[18:19], v[164:165], v[8:9], v[18:19] op_sel_hi:[1,0,1]
    v_pk_fma_f32 v[20:21], v[166:167], v[8:9], v[20:21] op_sel_hi:[1,0,1]
    buffer_load_dwordx4 v[44:47], v2, s[36:39], s56 offen offset:1024 nt
    s_waitcnt vmcnt(4)
    s_cbranch_vccnz L_w271
    s_waitcnt vmcnt(2)
L_w271:
    v_lshlrev_b32 v164, 16, v48
    v_and_b32 v165, s60, v48
    v_lshlrev_b32 v166, 16, v49
    v_and_b32 v167, s60, v49
    v_pk_fma_f32 v[14:15], v[164:165], v[8:9], v[14:15] op_sel:[0,1,0] op_sel_hi:[1,1,1]
    v_lshlrev_b32 v164, 16, v50
    v_and_b32 v165, s60, v50
    v_pk_fma_f32 v[16:17], v[166:167], v[8:9], v[16:17] op_sel:[0,1,0] op_sel_hi:[1,1,1]
    v_lshlrev_b32 v166, 16, v51
    v_and_b32 v167, s60, v51
    v_pk_fma_f32 v[18:19], v[164:165], v[8:9], v[18:19] op_sel:[0,1,0] op_sel_hi:[1,1,1]
    v_pk_fma_f32 v[20:21], v[166:167], v[8:9], v[20:21] op_sel:[0,1,0] op_sel_hi:[1,1,1]
    buffer_load_dwordx4 v[48:51], v2, s[36:39], s56 offen offset:2048 nt
    s_waitcnt vmcnt(4)
    s_cbranch_vccnz L_w272
    s_waitcnt vmcnt(2)
L_w272:
    v_lshlrev_b32 v164, 16, v32
    v_and_b32 v165, s60, v32
    v_lshlrev_b32 v166, 16, v33
    v_and_b32 v167, s60, v33
    v_pk_fma_f32 v[14:15], v[164:165], v[10:11], v[14:15] op_sel_hi:[1,0,1]
    v_lshlrev_b32 v164, 16, v34
    v_and_b32 v165, s60, v34
    v_pk_fma_f32 v[16:17], v[166:167], v[10:11], v[16:17] op_sel_hi:[1,0,1]
    v_lshlrev_b32 v166, 16, v35
    v_and_b32 v167, s60, v35
    v_pk_fma_f32 v[18:19], v[164:165], v[10:11], v[18:19] op_sel_hi:[1,0,1]
    v_pk_fma_f32 v[20:21], v[166:167], v[10:11], v[20:21] op_sel_hi:[1,0,1]
    buffer_load_dwordx4 v[32:35], v2, s[36:39], s56 offen offset:3072 nt
    s_waitcnt vmcnt(4)
    s_cbranch_vccnz L_w273
    s_waitcnt vmcnt(2)
L_w273:
    v_lshlrev_b32 v164, 16, v36
    v_and_b32 v165, s60, v36
    v_lshlrev_b32 v166, 16, v37
    v_and_b32 v167, s60, v37
    v_pk_fma_f32 v[14:15], v[164:165], v[10:11], v[14:15] op_sel:[0,1,0] op_sel_hi:[1,1,1]
    v_lshlrev_b32 v164, 16, v38
    v_and_b32 v165, s60, v38
    v_pk_fma_f32 v[16:17], v[166:167], v[10:11], v[16:17] op_sel:[0,1,0] op_sel_hi:[1,1,1]
    v_lshlrev_b32 v166, 16, v39
    v_and_b32 v167, s60, v39
    v_pk_fma_f32 v[18:19], v[164:165], v[10:11], v[18:19] op_sel:[0,1,0] op_sel_hi:[1,1,1]
    v_pk_fma_f32 v[20:21], v[166:167], v[10:11], v[20:21] op_sel:[0,1,0] op_sel_hi:[1,1,1]
    s_add_u32 s56, s56, 65536
    buffer_load_dwordx4 v[36:39], v2, s[36:39], s56 offen offset:0 nt
    s_waitcnt lgkmcnt(0)
    s_cmp_ge_u32 s16, 2
    s_cselect_b64 vcc, -1, 0
    ds_read_b128 v[8:11], v13 offset:1920
    s_waitcnt vmcnt(4)
    s_cbranch_vccnz L_w274
    s_waitcnt vmcnt(2)
L_w274:
    s_cmp_eq_u32 s21, 0
    s_cbranch_scc1 L_w275
    s_waitcnt vmcnt(1)
    s_sub_u32 s21, s21, 1
L_w275:
    s_barrier
    v_lshlrev_b32 v164, 16, v40
    v_and_b32 v165, s60, v40
    v_lshlrev_b32 v166, 16, v41
    v_and_b32 v167, s60, v41
    v_pk_fma_f32 v[14:15], v[164:165], v[22:23], v[14:15] op_sel_hi:[1,0,1]
    v_lshlrev_b32 v164, 16, v42
    v_and_b32 v165, s60, v42
    v_pk_fma_f32 v[16:17], v[166:167], v[22:23], v[16:17] op_sel_hi:[1,0,1]
    v_lshlrev_b32 v166, 16, v43
    v_and_b32 v167, s60, v43
    v_pk_fma_f32 v[18:19], v[164:165], v[22:23], v[18:19] op_sel_hi:[1,0,1]
    v_pk_fma_f32 v[20:21], v[166:167], v[22:23], v[20:21] op_sel_hi:[1,0,1]
    buffer_load_dwordx4 v[40:43], v2, s[36:39], s56 offen offset:1024 nt
    s_waitcnt vmcnt(4)
    s_cbranch_vccnz L_w276
    s_waitcnt vmcnt(2)
L_w276:
    v_lshlrev_b32 v164, 16, v44
    v_and_b32 v165, s60, v44
    v_lshlrev_b32 v166, 16, v45
    v_and_b32 v167, s60, v45
    v_pk_fma_f32 v[14:15], v[164:165], v[22:23], v[14:15] op_sel:[0,1,0] op_sel_hi:[1,1,1]
    v_lshlrev_b32 v164, 16, v46
    v_and_b32 v165, s60, v46
    v_pk_fma_f32 v[16:17], v[166:167], v[22:23], v[16:17] op_sel:[0,1,0] op_sel_hi:[1,1,1]
    v_lshlrev_b32 v166, 16, v47
    v_and_b32 v167, s60, v47
    v_pk_fma_f32 v[18:19], v[164:165], v[22:23], v[18:19] op_sel:[0,1,0] op_sel_hi:[1,1,1]
    v_pk_fma_f32 v[20:21], v[166:167], v[22:23], v[20:21] op_sel:[0,1,0] op_sel_hi:[1,1,1]
    buffer_load_dwordx4 v[44:47], v2, s[36:39], s56 offen offset:2048 nt
    s_waitcnt vmcnt(4)
    s_cbranch_vccnz L_w277
    s_waitcnt vmcnt(2)
L_w277:
    v_lshlrev_b32 v164, 16, v48
    v_and_b32 v165, s60, v48
    v_lshlrev_b32 v166, 16, v49
    v_and_b32 v167, s60, v49
    v_pk_fma_f32 v[14:15], v[164:165], v[24:25], v[14:15] op_sel_hi:[1,0,1]
    v_lshlrev_b32 v164, 16, v50
    v_and_b32 v165, s60, v50
    v_pk_fma_f32 v[16:17], v[166:167], v[24:25], v[16:17] op_sel_hi:[1,0,1]
    v_lshlrev_b32 v166, 16, v51
    v_and_b32 v167, s60, v51
    v_pk_fma_f32 v[18:19], v[164:165], v[24:25], v[18:19] op_sel_hi:[1,0,1]
    v_pk_fma_f32 v[20:21], v[166:167], v[24:25], v[20:21] op_sel_hi:[1,0,1]
    buffer_load_dwordx4 v[48:51], v2, s[36:39], s56 offen offset:3072 nt
    s_waitcnt vmcnt(4)
    s_cbranch_vccnz L_w278
    s_waitcnt vmcnt(2)
L_w278:
    v_lshlrev_b32 v164, 16, v32
    v_and_b32 v165, s60, v32
    v_lshlrev_b32 v166, 16, v33
    v_and_b32 v167, s60, v33
    v_pk_fma_f32 v[14:15], v[164:165], v[24:25], v[14:15] op_sel:[0,1,0] op_sel_hi:[1,1,1]
    v_lshlrev_b32 v164, 16, v34
    v_and_b32 v165, s60, v34
    v_pk_fma_f32 v[16:17], v[166:167], v[24:25], v[16:17] op_sel:[0,1,0] op_sel_hi:[1,1,1]
    v_lshlrev_b32 v166, 16, v35
    v_and_b32 v167, s60, v35
    v_pk_fma_f32 v[18:19], v[164:165], v[24:25], v[18:19] op_sel:[0,1,0] op_sel_hi:[1,1,1]
    v_pk_fma_f32 v[20:21], v[166:167], v[24:25], v[20:21] op_sel:[0,1,0] op_sel_hi:[1,1,1]
    s_add_u32 s56, s56, 65536
    buffer_load_dwordx4 v[32:35], v2, s[36:39], s56 offen offset:0 nt
    s_waitcnt lgkmcnt(0)
    s_cmp_ge_u32 s16, 1
    s_cselect_b64 vcc, -1, 0
    ds_read_b128 v[22:25], v13 offset:1984
    s_waitcnt vmcnt(4)
    s_cbranch_vccnz L_w279
    s_waitcnt vmcnt(2)
L_w279:
    s_cmp_eq_u32 s21, 0
    s_cbranch_scc1 L_w280
    s_waitcnt vmcnt(1)
    s_sub_u32 s21, s21, 1
L_w280:
    s_barrier
    v_lshlrev_b32 v164, 16, v36
    v_and_b32 v165, s60, v36
    v_lshlrev_b32 v166, 16, v37
    v_and_b32 v167, s60, v37
    v_pk_fma_f32 v[14:15], v[164:165], v[8:9], v[14:15] op_sel_hi:[1,0,1]
    v_lshlrev_b32 v164, 16, v38
    v_and_b32 v165, s60, v38
    v_pk_fma_f32 v[16:17], v[166:167], v[8:9], v[16:17] op_sel_hi:[1,0,1]
    v_lshlrev_b32 v166, 16, v39
    v_and_b32 v167, s60, v39
    v_pk_fma_f32 v[18:19], v[164:165], v[8:9], v[18:19] op_sel_hi:[1,0,1]
    v_pk_fma_f32 v[20:21], v[166:167], v[8:9], v[20:21] op_sel_hi:[1,0,1]
    buffer_load_dwordx4 v[36:39], v2, s[36:39], s56 offen offset:1024 nt
    s_waitcnt vmcnt(4)
    s_cbranch_vccnz L_w281
    s_waitcnt vmcnt(2)
L_w281:
    v_lshlrev_b32 v164, 16, v40
    v_and_b32 v165, s60, v40
    v_lshlrev_b32 v166, 16, v41
    v_and_b32 v167, s60, v41
    v_pk_fma_f32 v[14:15], v[164:165], v[8:9], v[14:15] op_sel:[0,1,0] op_sel_hi:[1,1,1]
    v_lshlrev_b32 v164, 16, v42
    v_and_b32 v165, s60, v42
    v_pk_fma_f32 v[16:17], v[166:167], v[8:9], v[16:17] op_sel:[0,1,0] op_sel_hi:[1,1,1]
    v_lshlrev_b32 v166, 16, v43
    v_and_b32 v167, s60, v43
    v_pk_fma_f32 v[18:19], v[164:165], v[8:9], v[18:19] op_sel:[0,1,0] op_sel_hi:[1,1,1]
    v_pk_fma_f32 v[20:21], v[166:167], v[8:9], v[20:21] op_sel:[0,1,0] op_sel_hi:[1,1,1]
    buffer_load_dwordx4 v[40:43], v2, s[36:39], s56 offen offset:2048 nt
    s_waitcnt vmcnt(4)
    s_cbranch_vccnz L_w282
    s_waitcnt vmcnt(2)
L_w282:
    v_lshlrev_b32 v164, 16, v44
    v_and_b32 v165, s60, v44
    v_lshlrev_b32 v166, 16, v45
    v_and_b32 v167, s60, v45
    v_pk_fma_f32 v[14:15], v[164:165], v[10:11], v[14:15] op_sel_hi:[1,0,1]
    v_lshlrev_b32 v164, 16, v46
    v_and_b32 v165, s60, v46
    v_pk_fma_f32 v[16:17], v[166:167], v[10:11], v[16:17] op_sel_hi:[1,0,1]
    v_lshlrev_b32 v166, 16, v47
    v_and_b32 v167, s60, v47
    v_pk_fma_f32 v[18:19], v[164:165], v[10:11], v[18:19] op_sel_hi:[1,0,1]
    v_pk_fma_f32 v[20:21], v[166:167], v[10:11], v[20:21] op_sel_hi:[1,0,1]
    buffer_load_dwordx4 v[44:47], v2, s[36:39], s56 offen offset:3072 nt
    s_waitcnt vmcnt(4)
    v_lshlrev_b32 v164, 16, v48
    v_and_b32 v165, s60, v48
    v_lshlrev_b32 v166, 16, v49
    v_and_b32 v167, s60, v49
    v_pk_fma_f32 v[14:15], v[164:165], v[10:11], v[14:15] op_sel:[0,1,0] op_sel_hi:[1,1,1]
    v_lshlrev_b32 v164, 16, v50
    v_and_b32 v165, s60, v50
    v_pk_fma_f32 v[16:17], v[166:167], v[10:11], v[16:17] op_sel:[0,1,0] op_sel_hi:[1,1,1]
    v_lshlrev_b32 v166, 16, v51
    v_and_b32 v167, s60, v51
    v_pk_fma_f32 v[18:19], v[164:165], v[10:11], v[18:19] op_sel:[0,1,0] op_sel_hi:[1,1,1]
    v_pk_fma_f32 v[20:21], v[166:167], v[10:11], v[20:21] op_sel:[0,1,0] op_sel_hi:[1,1,1]
    s_waitcnt lgkmcnt(0)
    s_cmp_ge_u32 s16, 0
    s_cselect_b64 vcc, -1, 0
    s_waitcnt vmcnt(3)
    v_lshlrev_b32 v164, 16, v32
    v_and_b32 v165, s60, v32
    v_lshlrev_b32 v166, 16, v33
    v_and_b32 v167, s60, v33
    v_pk_fma_f32 v[14:15], v[164:165], v[22:23], v[14:15] op_sel_hi:[1,0,1]
    v_lshlrev_b32 v164, 16, v34
    v_and_b32 v165, s60, v34
    v_pk_fma_f32 v[16:17], v[166:167], v[22:23], v[16:17] op_sel_hi:[1,0,1]
    v_lshlrev_b32 v166, 16, v35
    v_and_b32 v167, s60, v35
    v_pk_fma_f32 v[18:19], v[164:165], v[22:23], v[18:19] op_sel_hi:[1,0,1]
    v_pk_fma_f32 v[20:21], v[166:167], v[22:23], v[20:21] op_sel_hi:[1,0,1]
    s_waitcnt vmcnt(2)
    v_lshlrev_b32 v164, 16, v36
    v_and_b32 v165, s60, v36
    v_lshlrev_b32 v166, 16, v37
    v_and_b32 v167, s60, v37
    v_pk_fma_f32 v[14:15], v[164:165], v[22:23], v[14:15] op_sel:[0,1,0] op_sel_hi:[1,1,1]
    v_lshlrev_b32 v164, 16, v38
    v_and_b32 v165, s60, v38
    v_pk_fma_f32 v[16:17], v[166:167], v[22:23], v[16:17] op_sel:[0,1,0] op_sel_hi:[1,1,1]
    v_lshlrev_b32 v166, 16, v39
    v_and_b32 v167, s60, v39
    v_pk_fma_f32 v[18:19], v[164:165], v[22:23], v[18:19] op_sel:[0,1,0] op_sel_hi:[1,1,1]
    v_pk_fma_f32 v[20:21], v[166:167], v[22:23], v[20:21] op_sel:[0,1,0] op_sel_hi:[1,1,1]
    s_waitcnt vmcnt(1)
    v_lshlrev_b32 v164, 16, v40
    v_and_b32 v165, s60, v40
    v_lshlrev_b32 v166, 16, v41
    v_and_b32 v167, s60, v41
    v_pk_fma_f32 v[14:15], v[164:165], v[24:25], v[14:15] op_sel_hi:[1,0,1]
    v_lshlrev_b32 v164, 16, v42
    v_and_b32 v165, s60, v42
    v_pk_fma_f32 v[16:17], v[166:167], v[24:25], v[16:17] op_sel_hi:[1,0,1]
    v_lshlrev_b32 v166, 16, v43
    v_and_b32 v167, s60, v43
    v_pk_fma_f32 v[18:19], v[164:165], v[24:25], v[18:19] op_sel_hi:[1,0,1]
    v_pk_fma_f32 v[20:21], v[166:167], v[24:25], v[20:21] op_sel_hi:[1,0,1]
    s_waitcnt vmcnt(0)
    v_lshlrev_b32 v164, 16, v44
    v_and_b32 v165, s60, v44
    v_lshlrev_b32 v166, 16, v45
    v_and_b32 v167, s60, v45
    v_pk_fma_f32 v[14:15], v[164:165], v[24:25], v[14:15] op_sel:[0,1,0] op_sel_hi:[1,1,1]
    v_lshlrev_b32 v164, 16, v46
    v_and_b32 v165, s60, v46
    v_pk_fma_f32 v[16:17], v[166:167], v[24:25], v[16:17] op_sel:[0,1,0] op_sel_hi:[1,1,1]
    v_lshlrev_b32 v166, 16, v47
    v_and_b32 v167, s60, v47
    v_pk_fma_f32 v[18:19], v[164:165], v[24:25], v[18:19] op_sel:[0,1,0] op_sel_hi:[1,1,1]
    v_pk_fma_f32 v[20:21], v[166:167], v[24:25], v[20:21] op_sel:[0,1,0] op_sel_hi:[1,1,1]
    s_nop 0
    v_permlane32_swap_b32 v14, v18
    v_permlane32_swap_b32 v15, v19
    v_permlane32_swap_b32 v16, v20
    v_permlane32_swap_b32 v17, v21
    v_pk_add_f32 v[14:15], v[14:15], v[18:19]
    v_pk_add_f32 v[16:17], v[16:17], v[20:21]
    s_nop 1
    v_permlane16_swap_b32 v14, v16
    v_permlane16_swap_b32 v15, v17
    v_pk_add_f32 v[14:15], v[14:15], v[16:17]
    v_pk_mul_f32 v[14:15], v[14:15], v[30:31] op_sel_hi:[1,0]
    ds_write_b64 v1, v[14:15] offset:6144
    s_waitcnt lgkmcnt(0)
    s_barrier
    ds_read_b64 v[52:53], v7 offset:6144
    ds_read_b64 v[54:55], v7 offset:6656
    ds_read_b64 v[56:57], v7 offset:7168
    ds_read_b64 v[58:59], v7 offset:7680
    ds_read_b64 v[60:61], v7 offset:8192
    ds_read_b64 v[62:63], v7 offset:8704
    ds_read_b64 v[64:65], v7 offset:9216
    ds_read_b64 v[66:67], v7 offset:9728
    s_cmp_lg_u32 s3, 0
    s_cbranch_scc1 L_noml
    s_mov_b64 exec, 1
    buffer_store_dwordx2 v[26:27], off, s[52:55], s69 sc1
    s_mov_b64 exec, -1
L_noml:
    s_waitcnt lgkmcnt(4)
    v_pk_add_f32 v[52:53], v[52:53], v[54:55]
    v_pk_add_f32 v[56:57], v[56:57], v[58:59]
    s_waitcnt lgkmcnt(0)
    v_pk_add_f32 v[60:61], v[60:61], v[62:63]
    v_pk_add_f32 v[64:65], v[64:65], v[66:67]
    v_pk_add_f32 v[52:53], v[52:53], v[56:57]
    v_pk_add_f32 v[60:61], v[60:61], v[64:65]
    v_pk_add_f32 v[14:15], v[52:53], v[60:61]
    v_cvt_pk_bf16_f32 v14, v14, v15
    ds_write_b32 v95, v14 offset:10496
    s_waitcnt lgkmcnt(0)
    ds_read_b128 v[32:35], v96 offset:10496
    ds_read_b128 v[36:39], v96 offset:10512
    s_waitcnt lgkmcnt(1)
    v_dot2_f32_bf16 v14, v12, v32, 0
    v_dot2_f32_bf16 v15, v104, v32, 0
    v_dot2_f32_bf16 v16, v100, v32, 0
    v_dot2_f32_bf16 v17, v105, v32, 0
    v_dot2_f32_bf16 v18, v101, v32, 0
    v_dot2_f32_bf16 v19, v106, v32, 0
    v_dot2_f32_bf16 v20, v102, v32, 0
    v_dot2_f32_bf16 v21, v107, v32, 0
    v_dot2_f32_bf16 v14, v103, v33, v14
    v_dot2_f32_bf16 v15, v112, v33, v15
    v_dot2_f32_bf16 v16, v108, v33, v16
    v_dot2_f32_bf16 v17, v113, v33, v17
    v_dot2_f32_bf16 v18, v109, v33, v18
    v_dot2_f32_bf16 v19, v114, v33, v19
    v_dot2_f32_bf16 v20, v110, v33, v20
    v_dot2_f32_bf16 v21, v115, v33, v21
    v_dot2_f32_bf16 v14, v111, v34, v14
    v_dot2_f32_bf16 v15, v120, v34, v15
    v_dot2_f32_bf16 v16, v116, v34, v16
    v_dot2_f32_bf16 v17, v121, v34, v17
    v_dot2_f32_bf16 v18, v117, v34, v18
    v_dot2_f32_bf16 v19, v122, v34, v19
    v_dot2_f32_bf16 v20, v118, v34, v20
    v_dot2_f32_bf16 v21, v123, v34, v21
    v_dot2_f32_bf16 v14, v119, v35, v14
    v_dot2_f32_bf16 v15, v128, v35, v15
    v_dot2_f32_bf16 v16, v124, v35, v16
    v_dot2_f32_bf16 v17, v129, v35, v17
    v_dot2_f32_bf16 v18, v125, v35, v18
    v_dot2_f32_bf16 v19, v130, v35, v19
    v_dot2_f32_bf16 v20, v126, v35, v20
    v_dot2_f32_bf16 v21, v131, v35, v21
    s_waitcnt lgkmcnt(0)
    v_dot2_f32_bf16 v14, v127, v36, v14
    v_dot2_f32_bf16 v15, v136, v36, v15
    v_dot2_f32_bf16 v16, v132, v36, v16
    v_dot2_f32_bf16 v17, v137, v36, v17
    v_dot2_f32_bf16 v18, v133, v36, v18
    v_dot2_f32_bf16 v19, v138, v36, v19
    v_dot2_f32_bf16 v20, v134, v36, v20
    v_dot2_f32_bf16 v21, v139, v36, v21
    v_dot2_f32_bf16 v14, v135, v37, v14
    v_dot2_f32_bf16 v15, v144, v37, v15
    v_dot2_f32_bf16 v16, v140, v37, v16
    v_dot2_f32_bf16 v17, v145, v37, v17
    v_dot2_f32_bf16 v18, v141, v37, v18
    v_dot2_f32_bf16 v19, v146, v37, v19
    v_dot2_f32_bf16 v20, v142, v37, v20
    v_dot2_f32_bf16 v21, v147, v37, v21
    v_dot2_f32_bf16 v14, v143, v38, v14
    v_dot2_f32_bf16 v15, v152, v38, v15
    v_dot2_f32_bf16 v16, v148, v38, v16
    v_dot2_f32_bf16 v17, v153, v38, v17
    v_dot2_f32_bf16 v18, v149, v38, v18
    v_dot2_f32_bf16 v19, v154, v38, v19
    v_dot2_f32_bf16 v20, v150, v38, v20
    v_dot2_f32_bf16 v21, v155, v38, v21
    v_dot2_f32_bf16 v14, v151, v39, v14
    v_dot2_f32_bf16 v15, v160, v39, v15
    v_dot2_f32_bf16 v16, v156, v39, v16
    v_dot2_f32_bf16 v17, v161, v39, v17
    v_dot2_f32_bf16 v18, v157, v39, v18
    v_dot2_f32_bf16 v19, v162, v39, v19
    v_dot2_f32_bf16 v20, v158, v39, v20
    v_dot2_f32_bf16 v21, v163, v39, v21
    v_permlane32_swap_b32 v14, v18
    v_permlane32_swap_b32 v15, v19
    v_permlane32_swap_b32 v16, v20
    v_permlane32_swap_b32 v17, v21
    v_pk_add_f32 v[20:21], v[16:17], v[20:21]
    v_pk_add_f32 v[18:19], v[14:15], v[18:19]
    s_nop 1
    v_add_f32_dpp v18, v18, v18 row_ror:8 row_mask:0xf bank_mask:0xf
    v_add_f32_dpp v19, v19, v19 row_ror:8 row_mask:0xf bank_mask:0xf
    v_add_f32_dpp v20, v20, v20 row_ror:8 row_mask:0xf bank_mask:0xf
    v_add_f32_dpp v21, v21, v21 row_ror:8 row_mask:0xf bank_mask:0xf
    v_mov_b32 v22, v18
    v_mov_b32 v23, v19
    v_mov_b32 v24, v20
    v_mov_b32 v25, v21
    v_permlane16_swap_b32 v18, v22
    v_permlane16_swap_b32 v19, v23
    v_permlane16_swap_b32 v20, v24
    v_permlane16_swap_b32 v21, v25
    v_pk_add_f32 v[16:17], v[18:19], v[22:23]
    v_pk_add_f32 v[18:19], v[20:21], v[24:25]
    s_mov_b32 exec_lo, 0xff
    s_mov_b32 exec_hi, 0xff
    buffer_store_dwordx4 v[16:19], v3, s[52:55], s68 offen sc1
    s_mov_b64 exec, -1
    s_cmp_lt_u32 s2, 224
    s_cbranch_scc1 L_fin
    v_lshlrev_b32 v8, 2, v0
    ds_read_b32 v30, v28 offset:12544
    ds_read_b32 v31, v8 offset:12608
    v_lshlrev_b32 v9, 1, v0
    s_mov_b32 s11, 524288
L_sweep:
    buffer_load_dwordx2 v[32:33], v99, s[52:55], s58 offen sc1
    buffer_load_dwordx2 v[34:35], v99, s[52:55], s58 offen offset:128 sc1
    buffer_load_dwordx4 v[36:39], v97, s[92:95], 0 offen sc1
    buffer_load_dwordx4 v[40:43], v97, s[92:95], 0 offen offset:256 sc1
    s_waitcnt vmcnt(2)
    v_max3_u32 v24, v32, v33, v34
    v_max_u32 v24, v24, v35
    v_cmp_eq_u32 vcc, -1, v24
    s_sub_u32 s11, s11, 1
    s_cbranch_scc1 L_mlok
    s_cbranch_vccz L_mlok
    s_mov_b64 exec, vcc
    s_sleep 2
    s_branch L_sweep
L_mlok:
    s_mov_b64 exec, -1
    s_mov_b32 s11, 524288
    v_max_f32 v24, v32, v34
    v_sub_f32 v32, v32, v24
    v_sub_f32 v34, v34, v24
    v_exp_f32 v32, v32
    v_exp_f32 v34, v34
    v_mul_f32 v24, v32, v33
    v_fmac_f32 v24, v34, v35
    v_rcp_f32 v24, v24
    s_nop 0
    v_mul_f32 v32, v32, v24
    v_mul_f32 v34, v34, v24
L_ychk:
    s_waitcnt vmcnt(0)
    v_max3_u32 v24, v36, v37, v38
    v_max3_u32 v25, v39, v40, v41
    v_max3_u32 v24, v24, v42, v43
    v_max_u32 v24, v24, v25
    v_cmp_eq_u32 vcc, -1, v24
    s_sub_u32 s11, s11, 1
    s_cbranch_scc1 L_swept
    s_cbranch_vccz L_swept
    s_mov_b64 exec, vcc
    buffer_load_dwordx4 v[36:39], v97, s[92:95], 0 offen sc1
    buffer_load_dwordx4 v[40:43], v97, s[92:95], 0 offen offset:256 sc1
    s_branch L_ychk
L_swept:
    s_mov_b64 exec, -1
    v_pk_mul_f32 v[14:15], v[36:37], v[32:33] op_sel_hi:[1,0]
    v_pk_mul_f32 v[16:17], v[38:39], v[32:33] op_sel_hi:[1,0]
    v_pk_fma_f32 v[14:15], v[40:41], v[34:35], v[14:15] op_sel_hi:[1,0,1]
    v_pk_fma_f32 v[16:17], v[42:43], v[34:35], v[16:17] op_sel_hi:[1,0,1]
    s_nop 1
    v_permlane32_swap_b32 v14, v16
    v_permlane32_swap_b32 v15, v17
    v_pk_add_f32 v[14:15], v[14:15], v[16:17]
    s_nop 1
    v_permlane16_swap_b32 v14, v15
    v_add_f32 v14, v14, v15
    ds_write_b32 v98, v14 offset:0
    s_waitcnt lgkmcnt(0)
    s_barrier
    s_cmp_lg_u32 s3, 0
    s_cbranch_scc1 L_fin
    ds_read2st64_b32 v[32:33], v8 offset0:0 offset1:1
    ds_read2st64_b32 v[34:35], v8 offset0:2 offset1:3
    ds_read2st64_b32 v[36:37], v8 offset0:4 offset1:5
    ds_read2st64_b32 v[38:39], v8 offset0:6 offset1:7
    s_waitcnt lgkmcnt(0)
    v_pk_add_f32 v[32:33], v[32:33], v[34:35]
    v_pk_add_f32 v[36:37], v[36:37], v[38:39]
    v_pk_add_f32 v[32:33], v[32:33], v[36:37]
    v_add_f32 v24, v32, v33
    v_cvt_pk_bf16_f32 v24, v24, v24
    v_lshlrev_b32 v24, 16, v24
    v_mul_f32 v24, v24, v30
    v_cvt_pk_bf16_f32 v24, v24, v24
    v_lshlrev_b32 v24, 16, v24
    v_add_f32 v24, v24, v31
    v_cvt_pk_bf16_f32 v24, v24, v24
    buffer_store_short v24, v9, s[96:99], s59 offen
L_fin:
L_end:
    s_endpgm
L_side:
    v_lshlrev_b32 v2, 4, v0
    v_mov_b32 v8, -1
    v_mov_b32 v9, -1
    v_mov_b32 v10, -1
    v_mov_b32 v11, -1
    v_mov_b32 v12, 1
    v_mov_b32 v14, 0
    v_mov_b32 v15, 0
    ds_write_b64 v14, v[14:15] offset:12560
    ds_write_b32 v14, v14 offset:12568
    s_mov_b32 s66, 256
    s_mov_b32 s67, 0x20000
    s_and_b32 s6, s2, 7
    s_lshr_b32 s7, s2, 3
    s_mul_i32 s14, s6, 43
    s_add_u32 s15, s14, 43
    s_lshr_b32 s14, s14, 3
    s_lshr_b32 s15, s15, 3
    s_sub_u32 s15, s15, s14
    v_lshrrev_b32 v5, 2, v0
    v_and_b32 v6, 3, v0
    s_movk_i32 s9, 2752
    v_mul_lo_u32 v3, v5, s9
    v_lshlrev_b32 v4, 7, v6
    s_lshl_b32 s9, s15, 6
    s_sub_u32 s9, s9, 4
    v_min_u32 v4, s9, v4
    v_add_u32 v4, v3, v4
    v_lshl_add_u32 v3, v6, 4, v3
    v_lshlrev_b32 v7, 10, v0
    s_mov_b32 s34, 1409024
    s_mov_b32 s38, 1409024
    s_mov_b32 s42, 1409024
    s_waitcnt lgkmcnt(0)
    s_mov_b32 s48, s16
    s_mov_b32 s49, s17
    s_mov_b32 s52, s12
    s_mov_b32 s53, s13
    s_mov_b32 s64, s90
    s_mov_b32 s65, s91
    s_mov_b32 s32, s28
    s_mov_b32 s33, s29
    s_mov_b32 s36, s30
    s_mov_b32 s37, s31
    s_mov_b32 s40, s84
    s_mov_b32 s41, s85
    s_cmp_lt_u32 s2, 224
    s_cbranch_scc1 L_noclr
    s_sub_u32 s10, s2, 224
    s_lshl_b32 s11, s10, 15
    s_add_u32 s92, s12, s11
    s_addc_u32 s93, s13, 0
    s_mov_b32 s57, 0
    buffer_store_dwordx4 v[8:11], v2, s[92:95], s57 offen offset:0 sc1
    buffer_store_dwordx4 v[8:11], v2, s[92:95], s57 offen offset:1024 sc1
    buffer_store_dwordx4 v[8:11], v2, s[92:95], s57 offen offset:2048 sc1
    buffer_store_dwordx4 v[8:11], v2, s[92:95], s57 offen offset:3072 sc1
    s_mov_b32 s57, 4096
    buffer_store_dwordx4 v[8:11], v2, s[92:95], s57 offen offset:0 sc1
    buffer_store_dwordx4 v[8:11], v2, s[92:95], s57 offen offset:1024 sc1
    buffer_store_dwordx4 v[8:11], v2, s[92:95], s57 offen offset:2048 sc1
    buffer_store_dwordx4 v[8:11], v2, s[92:95], s57 offen offset:3072 sc1
    s_mov_b32 s57, 8192
    buffer_store_dwordx4 v[8:11], v2, s[92:95], s57 offen offset:0 sc1
    buffer_store_dwordx4 v[8:11], v2, s[92:95], s57 offen offset:1024 sc1
    buffer_store_dwordx4 v[8:11], v2, s[92:95], s57 offen offset:2048 sc1
    buffer_store_dwordx4 v[8:11], v2, s[92:95], s57 offen offset:3072 sc1
    s_mov_b32 s57, 12288
    buffer_store_dwordx4 v[8:11], v2, s[92:95], s57 offen offset:0 sc1
    buffer_store_dwordx4 v[8:11], v2, s[92:95], s57 offen offset:1024 sc1
    buffer_store_dwordx4 v[8:11], v2, s[92:95], s57 offen offset:2048 sc1
    buffer_store_dwordx4 v[8:11], v2, s[92:95], s57 offen offset:3072 sc1
    s_lshl_b32 s57, s10, 10
    s_add_u32 s57, s57, 1310720
    buffer_store_dwordx4 v[8:11], v2, s[52:55], s57 offen sc1
    s_mul_i32 s57, s10, 768
    s_add_u32 s57, s57, 1048576
    s_mov_b32 exec_hi, 0xffff
    buffer_store_dwordx4 v[8:11], v2, s[52:55], s57 offen sc1
    s_mov_b64 exec, -1
    s_mov_b32 s44, s86
    s_mov_b32 s45, s87
    s_mov_b32 s46, 1024
    s_lshr_b32 s9, s10, 3
    s_lshl_b32 s9, s9, 10
    buffer_load_dwordx4 v[16:19], v2, s[48:51], s9 offen
    buffer_load_dwordx4 v[20:23], v2, s[44:47], 0 offen
L_noclr:
    s_mov_b32 s18, 60
    s_barrier
    s_cmp_eq_u32 s18, 0
    s_cbranch_scc1 L_nb0
    s_sub_u32 s18, s18, 1
    s_barrier
L_nb0:
    s_cmp_eq_u32 s18, 0
    s_cbranch_scc1 L_nb1
    s_sub_u32 s18, s18, 1
    s_barrier
L_nb1:
    s_cmp_lt_u32 s2, 224
    s_cbranch_scc1 L_nosig
    s_waitcnt vmcnt(0)
    s_mov_b64 exec, 1
    buffer_atomic_add v12, off, s[64:67], 0 sc1
    s_mov_b64 exec, -1
L_nosig:
    s_mul_i32 s9, s7, 44032
    s_lshl_b32 s11, s14, 6
    s_add_u32 s9, s9, s11
    s_mul_i32 s11, s7, 44032
    s_lshl_b32 s57, s6, 7
    s_add_u32 s11, s11, s57
    buffer_load_dword v13, v4, s[32:35], s9 offen
    s_cmp_eq_u32 s18, 0
    s_cbranch_scc1 L_nb2
    s_sub_u32 s18, s18, 1
    s_barrier
L_nb2:
    buffer_load_dword v14, v4, s[36:39], s9 offen
    s_cmp_eq_u32 s18, 0
    s_cbranch_scc1 L_nb3
    s_sub_u32 s18, s18, 1
    s_barrier
L_nb3:
    s_mov_b32 exec_hi, 0x7ff
    buffer_load_dword v15, v7, s[40:43], s11 offen
    s_mov_b64 exec, -1
    s_cmp_ge_u32 s2, 224
    s_cbranch_scc1 L_red
    s_cmp_lt_u32 s7, s15
    s_cbranch_scc1 L_stage1
L_idle:
    s_mov_b32 s19, 5
L_bl4:
    s_cmp_eq_u32 s18, 0
    s_cbranch_scc1 L_nb5
    s_sub_u32 s18, s18, 1
    s_barrier
L_nb5:
    s_sub_u32 s19, s19, 1
    s_cmp_lg_u32 s19, 0
    s_cbranch_scc1 L_bl4
    s_mov_b64 exec, 1
    buffer_load_dword v30, off, s[64:67], 0 offset:0
    s_mov_b32 s11, 524288
L_ci0:
    s_cmp_eq_u32 s18, 0
    s_cbranch_scc1 L_nb6
    s_sub_u32 s18, s18, 1
    s_barrier
L_nb6:
    s_cmp_eq_u32 s18, 0
    s_cbranch_scc1 L_nb7
    s_sub_u32 s18, s18, 1
    s_barrier
L_nb7:
    s_waitcnt vmcnt(0)
    v_cmp_gt_u32 vcc, 32, v30
    s_sub_u32 s11, s11, 1
    s_cbranch_scc1 L_cid0
    s_cbranch_vccz L_cid0
    buffer_load_dword v30, off, s[64:67], 0 offset:0 sc1
    s_branch L_ci0
L_cid0:
    v_mov_b32 v30, 1
    v_mov_b32 v1, 0
    ds_write_b32 v1, v30 offset:12568
    s_waitcnt lgkmcnt(0)
    s_mov_b64 exec, -1
L_rank:
    s_endpgm
L_stage1:
    s_add_u32 s7, s7, s14
    s_lshl_b32 s10, s7, 6
    v_add_u32 v3, s10, v3
    v_lshlrev_b32 v7, 7, v0
    buffer_load_dwordx4 v[80:83], v2, s[48:51], 0 offen offset:0
    buffer_load_dwordx4 v[84:87], v2, s[48:51], 0 offen offset:1024
    buffer_load_dwordx4 v[88:91], v2, s[48:51], 0 offen offset:2048
    buffer_load_dwordx4 v[92:95], v2, s[48:51], 0 offen offset:3072
    s_mov_b32 s19, 2
L_bl8:
    s_cmp_eq_u32 s18, 0
    s_cbranch_scc1 L_nb9
    s_sub_u32 s18, s18, 1
    s_barrier
L_nb9:
    s_sub_u32 s19, s19, 1
    s_cmp_lg_u32 s19, 0
    s_cbranch_scc1 L_bl8
    s_waitcnt vmcnt(0)
    s_mov_b32 s57, 0
    buffer_load_dwordx4 v[32:35], v3, s[32:35], s57 offen
    buffer_load_dwordx4 v[36:39], v3, s[36:39], s57 offen
    s_mov_b32 s57, 44032
    buffer_load_dwordx4 v[40:43], v3, s[32:35], s57 offen
    buffer_load_dwordx4 v[44:47], v3, s[36:39], s57 offen
    v_lshlrev_b32 v8, 16, v80
    v_lshlrev_b32 v9, 16, v84
    v_lshlrev_b32 v10, 16, v88
    v_lshlrev_b32 v11, 16, v92
    ds_write_b128 v7, v[8:11] offset:16384
    v_and_b32 v12, s60, v80
    v_and_b32 v13, s60, v84
    v_and_b32 v14, s60, v88
    v_and_b32 v15, s60, v92
    ds_write_b128 v7, v[12:15] offset:16400
    v_lshlrev_b32 v8, 16, v81
    v_lshlrev_b32 v9, 16, v85
    v_lshlrev_b32 v10, 16, v89
    v_lshlrev_b32 v11, 16, v93
    ds_write_b128 v7, v[8:11] offset:16416
    v_and_b32 v12, s60, v81
    v_and_b32 v13, s60, v85
    v_and_b32 v14, s60, v89
    v_and_b32 v15, s60, v93
    ds_write_b128 v7, v[12:15] offset:16432
    v_lshlrev_b32 v8, 16, v82
    v_lshlrev_b32 v9, 16, v86
    v_lshlrev_b32 v10, 16, v90
    v_lshlrev_b32 v11, 16, v94
    ds_write_b128 v7, v[8:11] offset:16448
    v_and_b32 v12, s60, v82
    v_and_b32 v13, s60, v86
    v_and_b32 v14, s60, v90
    v_and_b32 v15, s60, v94
    ds_write_b128 v7, v[12:15] offset:16464
    v_lshlrev_b32 v8, 16, v83
    v_lshlrev_b32 v9, 16, v87
    v_lshlrev_b32 v10, 16, v91
    v_lshlrev_b32 v11, 16, v95
    ds_write_b128 v7, v[8:11] offset:16480
    v_and_b32 v12, s60, v83
    v_and_b32 v13, s60, v87
    v_and_b32 v14, s60, v91
    v_and_b32 v15, s60, v95
    ds_write_b128 v7, v[12:15] offset:16496
    v_lshlrev_b32 v7, 4, v5
    s_waitcnt lgkmcnt(0)
    v_mov_b32 v80, 0
    v_mov_b32 v81, 0
    v_mov_b32 v82, 0
    v_mov_b32 v83, 0
    v_mov_b32 v84, 0
    v_mov_b32 v85, 0
    v_mov_b32 v86, 0
    v_mov_b32 v87, 0
    v_mov_b32 v88, 0
    v_mov_b32 v89, 0
    v_mov_b32 v90, 0
    v_mov_b32 v91, 0
    v_mov_b32 v92, 0
    v_mov_b32 v93, 0
    v_mov_b32 v94, 0
    v_mov_b32 v95, 0
    v_mov_b32 v96, 0
    v_mov_b32 v97, 0
    v_mov_b32 v98, 0
    v_mov_b32 v99, 0
    v_mov_b32 v100, 0
    v_mov_b32 v101, 0
    v_mov_b32 v102, 0
    v_mov_b32 v103, 0
    v_mov_b32 v104, 0
    v_mov_b32 v105, 0
    v_mov_b32 v106, 0
    v_mov_b32 v107, 0
    v_mov_b32 v108, 0
    v_mov_b32 v109, 0
    v_mov_b32 v110, 0
    v_mov_b32 v111, 0
    v_mov_b32 v112, 0
    v_mov_b32 v113, 0
    v_mov_b32 v114, 0
    v_mov_b32 v115, 0
    v_mov_b32 v116, 0
    v_mov_b32 v117, 0
    v_mov_b32 v118, 0
    v_mov_b32 v119, 0
    v_mov_b32 v120, 0
    v_mov_b32 v121, 0
    v_mov_b32 v122, 0
    v_mov_b32 v123, 0
    v_mov_b32 v124, 0
    v_mov_b32 v125, 0
    v_mov_b32 v126, 0
    v_mov_b32 v127, 0
    v_mov_b32 v128, 0
    v_mov_b32 v129, 0
    v_mov_b32 v130, 0
    v_mov_b32 v131, 0
    v_mov_b32 v132, 0
    v_mov_b32 v133, 0
    v_mov_b32 v134, 0
    v_mov_b32 v135, 0
    v_mov_b32 v136, 0
    v_mov_b32 v137, 0
    v_mov_b32 v138, 0
    v_mov_b32 v139, 0
    v_mov_b32 v140, 0
    v_mov_b32 v141, 0
    v_mov_b32 v142, 0
    v_mov_b32 v143, 0
    ds_read_b128 v[8:11], v7 offset:16384
    s_cmp_eq_u32 s18, 0
    s_cbranch_scc1 L_nb10
    s_sub_u32 s18, s18, 1
    s_barrier
L_nb10:
    s_mov_b32 s57, 88064
    buffer_load_dwordx4 v[48:51], v3, s[32:35], s57 offen
    buffer_load_dwordx4 v[52:55], v3, s[36:39], s57 offen
    s_mov_b32 s57, 132096
    buffer_load_dwordx4 v[56:59], v3, s[32:35], s57 offen
    buffer_load_dwordx4 v[60:63], v3, s[36:39], s57 offen
    ds_read_b128 v[12:15], v7 offset:16640
    s_waitcnt vmcnt(6) lgkmcnt(1)
    v_lshlrev_b32 v16, 16, v32
    v_and_b32 v17, s60, v32
    v_lshlrev_b32 v18, 16, v33
    v_and_b32 v19, s60, v33
    v_lshlrev_b32 v20, 16, v34
    v_and_b32 v21, s60, v34
    v_lshlrev_b32 v22, 16, v35
    v_and_b32 v23, s60, v35
    v_lshlrev_b32 v24, 16, v36
    v_and_b32 v25, s60, v36
    v_lshlrev_b32 v26, 16, v37
    v_and_b32 v27, s60, v37
    v_lshlrev_b32 v28, 16, v38
    v_and_b32 v29, s60, v38
    v_lshlrev_b32 v30, 16, v39
    v_and_b32 v31, s60, v39
    v_pk_fma_f32 v[80:81], v[16:17], v[8:9], v[80:81] op_sel_hi:[1,0,1]
    v_pk_fma_f32 v[82:83], v[18:19], v[8:9], v[82:83] op_sel_hi:[1,0,1]
    v_pk_fma_f32 v[84:85], v[20:21], v[8:9], v[84:85] op_sel_hi:[1,0,1]
    v_pk_fma_f32 v[86:87], v[22:23], v[8:9], v[86:87] op_sel_hi:[1,0,1]
    v_pk_fma_f32 v[88:89], v[16:17], v[8:9], v[88:89] op_sel:[0,1,0] op_sel_hi:[1,1,1]
    v_pk_fma_f32 v[90:91], v[18:19], v[8:9], v[90:91] op_sel:[0,1,0] op_sel_hi:[1,1,1]
    v_pk_fma_f32 v[92:93], v[20:21], v[8:9], v[92:93] op_sel:[0,1,0] op_sel_hi:[1,1,1]
    v_pk_fma_f32 v[94:95], v[22:23], v[8:9], v[94:95] op_sel:[0,1,0] op_sel_hi:[1,1,1]
    v_pk_fma_f32 v[96:97], v[16:17], v[10:11], v[96:97] op_sel_hi:[1,0,1]
    v_pk_fma_f32 v[98:99], v[18:19], v[10:11], v[98:99] op_sel_hi:[1,0,1]
    v_pk_fma_f32 v[100:101], v[20:21], v[10:11], v[100:101] op_sel_hi:[1,0,1]
    v_pk_fma_f32 v[102:103], v[22:23], v[10:11], v[102:103] op_sel_hi:[1,0,1]
    v_pk_fma_f32 v[104:105], v[16:17], v[10:11], v[104:105] op_sel:[0,1,0] op_sel_hi:[1,1,1]
    v_pk_fma_f32 v[106:107], v[18:19], v[10:11], v[106:107] op_sel:[0,1,0] op_sel_hi:[1,1,1]
    v_pk_fma_f32 v[108:109], v[20:21], v[10:11], v[108:109] op_sel:[0,1,0] op_sel_hi:[1,1,1]
    v_pk_fma_f32 v[110:111], v[22:23], v[10:11], v[110:111] op_sel:[0,1,0] op_sel_hi:[1,1,1]
    v_pk_fma_f32 v[112:113], v[24:25], v[8:9], v[112:113] op_sel_hi:[1,0,1]
    v_pk_fma_f32 v[114:115], v[26:27], v[8:9], v[114:115] op_sel_hi:[1,0,1]
    v_pk_fma_f32 v[116:117], v[28:29], v[8:9], v[116:117] op_sel_hi:[1,0,1]
    v_pk_fma_f32 v[118:119], v[30:31], v[8:9], v[118:119] op_sel_hi:[1,0,1]
    v_pk_fma_f32 v[120:121], v[24:25], v[8:9], v[120:121] op_sel:[0,1,0] op_sel_hi:[1,1,1]
    v_pk_fma_f32 v[122:123], v[26:27], v[8:9], v[122:123] op_sel:[0,1,0] op_sel_hi:[1,1,1]
    v_pk_fma_f32 v[124:125], v[28:29], v[8:9], v[124:125] op_sel:[0,1,0] op_sel_hi:[1,1,1]
    v_pk_fma_f32 v[126:127], v[30:31], v[8:9], v[126:127] op_sel:[0,1,0] op_sel_hi:[1,1,1]
    v_pk_fma_f32 v[128:129], v[24:25], v[10:11], v[128:129] op_sel_hi:[1,0,1]
    v_pk_fma_f32 v[130:131], v[26:27], v[10:11], v[130:131] op_sel_hi:[1,0,1]
    v_pk_fma_f32 v[132:133], v[28:29], v[10:11], v[132:133] op_sel_hi:[1,0,1]
    v_pk_fma_f32 v[134:135], v[30:31], v[10:11], v[134:135] op_sel_hi:[1,0,1]
    v_pk_fma_f32 v[136:137], v[24:25], v[10:11], v[136:137] op_sel:[0,1,0] op_sel_hi:[1,1,1]
    v_pk_fma_f32 v[138:139], v[26:27], v[10:11], v[138:139] op_sel:[0,1,0] op_sel_hi:[1,1,1]
    v_pk_fma_f32 v[140:141], v[28:29], v[10:11], v[140:141] op_sel:[0,1,0] op_sel_hi:[1,1,1]
    v_pk_fma_f32 v[142:143], v[30:31], v[10:11], v[142:143] op_sel:[0,1,0] op_sel_hi:[1,1,1]
    ds_read_b128 v[8:11], v7 offset:16896
    s_waitcnt vmcnt(4) lgkmcnt(1)
    v_lshlrev_b32 v16, 16, v40
    v_and_b32 v17, s60, v40
    v_lshlrev_b32 v18, 16, v41
    v_and_b32 v19, s60, v41
    v_lshlrev_b32 v20, 16, v42
    v_and_b32 v21, s60, v42
    v_lshlrev_b32 v22, 16, v43
    v_and_b32 v23, s60, v43
    v_lshlrev_b32 v24, 16, v44
    v_and_b32 v25, s60, v44
    v_lshlrev_b32 v26, 16, v45
    v_and_b32 v27, s60, v45
    v_lshlrev_b32 v28, 16, v46
    v_and_b32 v29, s60, v46
    v_lshlrev_b32 v30, 16, v47
    v_and_b32 v31, s60, v47
    v_pk_fma_f32 v[80:81], v[16:17], v[12:13], v[80:81] op_sel_hi:[1,0,1]
    v_pk_fma_f32 v[82:83], v[18:19], v[12:13], v[82:83] op_sel_hi:[1,0,1]
    v_pk_fma_f32 v[84:85], v[20:21], v[12:13], v[84:85] op_sel_hi:[1,0,1]
    v_pk_fma_f32 v[86:87], v[22:23], v[12:13], v[86:87] op_sel_hi:[1,0,1]
    v_pk_fma_f32 v[88:89], v[16:17], v[12:13], v[88:89] op_sel:[0,1,0] op_sel_hi:[1,1,1]
    v_pk_fma_f32 v[90:91], v[18:19], v[12:13], v[90:91] op_sel:[0,1,0] op_sel_hi:[1,1,1]
    v_pk_fma_f32 v[92:93], v[20:21], v[12:13], v[92:93] op_sel:[0,1,0] op_sel_hi:[1,1,1]
    v_pk_fma_f32 v[94:95], v[22:23], v[12:13], v[94:95] op_sel:[0,1,0] op_sel_hi:[1,1,1]
    v_pk_fma_f32 v[96:97], v[16:17], v[14:15], v[96:97] op_sel_hi:[1,0,1]
    v_pk_fma_f32 v[98:99], v[18:19], v[14:15], v[98:99] op_sel_hi:[1,0,1]
    v_pk_fma_f32 v[100:101], v[20:21], v[14:15], v[100:101] op_sel_hi:[1,0,1]
    v_pk_fma_f32 v[102:103], v[22:23], v[14:15], v[102:103] op_sel_hi:[1,0,1]
    v_pk_fma_f32 v[104:105], v[16:17], v[14:15], v[104:105] op_sel:[0,1,0] op_sel_hi:[1,1,1]
    v_pk_fma_f32 v[106:107], v[18:19], v[14:15], v[106:107] op_sel:[0,1,0] op_sel_hi:[1,1,1]
    v_pk_fma_f32 v[108:109], v[20:21], v[14:15], v[108:109] op_sel:[0,1,0] op_sel_hi:[1,1,1]
    v_pk_fma_f32 v[110:111], v[22:23], v[14:15], v[110:111] op_sel:[0,1,0] op_sel_hi:[1,1,1]
    v_pk_fma_f32 v[112:113], v[24:25], v[12:13], v[112:113] op_sel_hi:[1,0,1]
    v_pk_fma_f32 v[114:115], v[26:27], v[12:13], v[114:115] op_sel_hi:[1,0,1]
    v_pk_fma_f32 v[116:117], v[28:29], v[12:13], v[116:117] op_sel_hi:[1,0,1]
    v_pk_fma_f32 v[118:119], v[30:31], v[12:13], v[118:119] op_sel_hi:[1,0,1]
    v_pk_fma_f32 v[120:121], v[24:25], v[12:13], v[120:121] op_sel:[0,1,0] op_sel_hi:[1,1,1]
    v_pk_fma_f32 v[122:123], v[26:27], v[12:13], v[122:123] op_sel:[0,1,0] op_sel_hi:[1,1,1]
    v_pk_fma_f32 v[124:125], v[28:29], v[12:13], v[124:125] op_sel:[0,1,0] op_sel_hi:[1,1,1]
    v_pk_fma_f32 v[126:127], v[30:31], v[12:13], v[126:127] op_sel:[0,1,0] op_sel_hi:[1,1,1]
    v_pk_fma_f32 v[128:129], v[24:25], v[14:15], v[128:129] op_sel_hi:[1,0,1]
    v_pk_fma_f32 v[130:131], v[26:27], v[14:15], v[130:131] op_sel_hi:[1,0,1]
    v_pk_fma_f32 v[132:133], v[28:29], v[14:15], v[132:133] op_sel_hi:[1,0,1]
    v_pk_fma_f32 v[134:135], v[30:31], v[14:15], v[134:135] op_sel_hi:[1,0,1]
    v_pk_fma_f32 v[136:137], v[24:25], v[14:15], v[136:137] op_sel:[0,1,0] op_sel_hi:[1,1,1]
    v_pk_fma_f32 v[138:139], v[26:27], v[14:15], v[138:139] op_sel:[0,1,0] op_sel_hi:[1,1,1]
    v_pk_fma_f32 v[140:141], v[28:29], v[14:15], v[140:141] op_sel:[0,1,0] op_sel_hi:[1,1,1]
    v_pk_fma_f32 v[142:143], v[30:31], v[14:15], v[142:143] op_sel:[0,1,0] op_sel_hi:[1,1,1]
    s_cmp_eq_u32 s18, 0
    s_cbranch_scc1 L_nb11
    s_sub_u32 s18, s18, 1
    s_barrier
L_nb11:
    s_mov_b32 s57, 176128
    buffer_load_dwordx4 v[32:35], v3, s[32:35], s57 offen
    buffer_load_dwordx4 v[36:39], v3, s[36:39], s57 offen
    s_mov_b32 s57, 220160
    buffer_load_dwordx4 v[40:43], v3, s[32:35], s57 offen
    buffer_load_dwordx4 v[44:47], v3, s[36:39], s57 offen
    ds_read_b128 v[12:15], v7 offset:17152
    s_waitcnt vmcnt(6) lgkmcnt(1)
    v_lshlrev_b32 v16, 16, v48
    v_and_b32 v17, s60, v48
    v_lshlrev_b32 v18, 16, v49
    v_and_b32 v19, s60, v49
    v_lshlrev_b32 v20, 16, v50
    v_and_b32 v21, s60, v50
    v_lshlrev_b32 v22, 16, v51
    v_and_b32 v23, s60, v51
    v_lshlrev_b32 v24, 16, v52
    v_and_b32 v25, s60, v52
    v_lshlrev_b32 v26, 16, v53
    v_and_b32 v27, s60, v53
    v_lshlrev_b32 v28, 16, v54
    v_and_b32 v29, s60, v54
    v_lshlrev_b32 v30, 16, v55
    v_and_b32 v31, s60, v55
    v_pk_fma_f32 v[80:81], v[16:17], v[8:9], v[80:81] op_sel_hi:[1,0,1]
    v_pk_fma_f32 v[82:83], v[18:19], v[8:9], v[82:83] op_sel_hi:[1,0,1]
    v_pk_fma_f32 v[84:85], v[20:21], v[8:9], v[84:85] op_sel_hi:[1,0,1]
    v_pk_fma_f32 v[86:87], v[22:23], v[8:9], v[86:87] op_sel_hi:[1,0,1]
    v_pk_fma_f32 v[88:89], v[16:17], v[8:9], v[88:89] op_sel:[0,1,0] op_sel_hi:[1,1,1]
    v_pk_fma_f32 v[90:91], v[18:19], v[8:9], v[90:91] op_sel:[0,1,0] op_sel_hi:[1,1,1]
    v_pk_fma_f32 v[92:93], v[20:21], v[8:9], v[92:93] op_sel:[0,1,0] op_sel_hi:[1,1,1]
    v_pk_fma_f32 v[94:95], v[22:23], v[8:9], v[94:95] op_sel:[0,1,0] op_sel_hi:[1,1,1]
    v_pk_fma_f32 v[96:97], v[16:17], v[10:11], v[96:97] op_sel_hi:[1,0,1]
    v_pk_fma_f32 v[98:99], v[18:19], v[10:11], v[98:99] op_sel_hi:[1,0,1]
    v_pk_fma_f32 v[100:101], v[20:21], v[10:11], v[100:101] op_sel_hi:[1,0,1]
    v_pk_fma_f32 v[102:103], v[22:23], v[10:11], v[102:103] op_sel_hi:[1,0,1]
    v_pk_fma_f32 v[104:105], v[16:17], v[10:11], v[104:105] op_sel:[0,1,0] op_sel_hi:[1,1,1]
    v_pk_fma_f32 v[106:107], v[18:19], v[10:11], v[106:107] op_sel:[0,1,0] op_sel_hi:[1,1,1]
    v_pk_fma_f32 v[108:109], v[20:21], v[10:11], v[108:109] op_sel:[0,1,0] op_sel_hi:[1,1,1]
    v_pk_fma_f32 v[110:111], v[22:23], v[10:11], v[110:111] op_sel:[0,1,0] op_sel_hi:[1,1,1]
    v_pk_fma_f32 v[112:113], v[24:25], v[8:9], v[112:113] op_sel_hi:[1,0,1]
    v_pk_fma_f32 v[114:115], v[26:27], v[8:9], v[114:115] op_sel_hi:[1,0,1]
    v_pk_fma_f32 v[116:117], v[28:29], v[8:9], v[116:117] op_sel_hi:[1,0,1]
    v_pk_fma_f32 v[118:119], v[30:31], v[8:9], v[118:119] op_sel_hi:[1,0,1]
    v_pk_fma_f32 v[120:121], v[24:25], v[8:9], v[120:121] op_sel:[0,1,0] op_sel_hi:[1,1,1]
    v_pk_fma_f32 v[122:123], v[26:27], v[8:9], v[122:123] op_sel:[0,1,0] op_sel_hi:[1,1,1]
    v_pk_fma_f32 v[124:125], v[28:29], v[8:9], v[124:125] op_sel:[0,1,0] op_sel_hi:[1,1,1]
    v_pk_fma_f32 v[126:127], v[30:31], v[8:9], v[126:127] op_sel:[0,1,0] op_sel_hi:[1,1,1]
    v_pk_fma_f32 v[128:129], v[24:25], v[10:11], v[128:129] op_sel_hi:[1,0,1]
    v_pk_fma_f32 v[130:131], v[26:27], v[10:11], v[130:131] op_sel_hi:[1,0,1]
    v_pk_fma_f32 v[132:133], v[28:29], v[10:11], v[132:133] op_sel_hi:[1,0,1]
    v_pk_fma_f32 v[134:135], v[30:31], v[10:11], v[134:135] op_sel_hi:[1,0,1]
    v_pk_fma_f32 v[136:137], v[24:25], v[10:11], v[136:137] op_sel:[0,1,0] op_sel_hi:[1,1,1]
    v_pk_fma_f32 v[138:139], v[26:27], v[10:11], v[138:139] op_sel:[0,1,0] op_sel_hi:[1,1,1]
    v_pk_fma_f32 v[140:141], v[28:29], v[10:11], v[140:141] op_sel:[0,1,0] op_sel_hi:[1,1,1]
    v_pk_fma_f32 v[142:143], v[30:31], v[10:11], v[142:143] op_sel:[0,1,0] op_sel_hi:[1,1,1]
    ds_read_b128 v[8:11], v7 offset:17408
    s_waitcnt vmcnt(4) lgkmcnt(1)
    v_lshlrev_b32 v16, 16, v56
    v_and_b32 v17, s60, v56
    v_lshlrev_b32 v18, 16, v57
    v_and_b32 v19, s60, v57
    v_lshlrev_b32 v20, 16, v58
    v_and_b32 v21, s60, v58
    v_lshlrev_b32 v22, 16, v59
    v_and_b32 v23, s60, v59
    v_lshlrev_b32 v24, 16, v60
    v_and_b32 v25, s60, v60
    v_lshlrev_b32 v26, 16, v61
    v_and_b32 v27, s60, v61
    v_lshlrev_b32 v28, 16, v62
    v_and_b32 v29, s60, v62
    v_lshlrev_b32 v30, 16, v63
    v_and_b32 v31, s60, v63
    v_pk_fma_f32 v[80:81], v[16:17], v[12:13], v[80:81] op_sel_hi:[1,0,1]
    v_pk_fma_f32 v[82:83], v[18:19], v[12:13], v[82:83] op_sel_hi:[1,0,1]
    v_pk_fma_f32 v[84:85], v[20:21], v[12:13], v[84:85] op_sel_hi:[1,0,1]
    v_pk_fma_f32 v[86:87], v[22:23], v[12:13], v[86:87] op_sel_hi:[1,0,1]
    v_pk_fma_f32 v[88:89], v[16:17], v[12:13], v[88:89] op_sel:[0,1,0] op_sel_hi:[1,1,1]
    v_pk_fma_f32 v[90:91], v[18:19], v[12:13], v[90:91] op_sel:[0,1,0] op_sel_hi:[1,1,1]
    v_pk_fma_f32 v[92:93], v[20:21], v[12:13], v[92:93] op_sel:[0,1,0] op_sel_hi:[1,1,1]
    v_pk_fma_f32 v[94:95], v[22:23], v[12:13], v[94:95] op_sel:[0,1,0] op_sel_hi:[1,1,1]
    v_pk_fma_f32 v[96:97], v[16:17], v[14:15], v[96:97] op_sel_hi:[1,0,1]
    v_pk_fma_f32 v[98:99], v[18:19], v[14:15], v[98:99] op_sel_hi:[1,0,1]
    v_pk_fma_f32 v[100:101], v[20:21], v[14:15], v[100:101] op_sel_hi:[1,0,1]
    v_pk_fma_f32 v[102:103], v[22:23], v[14:15], v[102:103] op_sel_hi:[1,0,1]
    v_pk_fma_f32 v[104:105], v[16:17], v[14:15], v[104:105] op_sel:[0,1,0] op_sel_hi:[1,1,1]
    v_pk_fma_f32 v[106:107], v[18:19], v[14:15], v[106:107] op_sel:[0,1,0] op_sel_hi:[1,1,1]
    v_pk_fma_f32 v[108:109], v[20:21], v[14:15], v[108:109] op_sel:[0,1,0] op_sel_hi:[1,1,1]
    v_pk_fma_f32 v[110:111], v[22:23], v[14:15], v[110:111] op_sel:[0,1,0] op_sel_hi:[1,1,1]
    v_pk_fma_f32 v[112:113], v[24:25], v[12:13], v[112:113] op_sel_hi:[1,0,1]
    v_pk_fma_f32 v[114:115], v[26:27], v[12:13], v[114:115] op_sel_hi:[1,0,1]
    v_pk_fma_f32 v[116:117], v[28:29], v[12:13], v[116:117] op_sel_hi:[1,0,1]
    v_pk_fma_f32 v[118:119], v[30:31], v[12:13], v[118:119] op_sel_hi:[1,0,1]
    v_pk_fma_f32 v[120:121], v[24:25], v[12:13], v[120:121] op_sel:[0,1,0] op_sel_hi:[1,1,1]
    v_pk_fma_f32 v[122:123], v[26:27], v[12:13], v[122:123] op_sel:[0,1,0] op_sel_hi:[1,1,1]
    v_pk_fma_f32 v[124:125], v[28:29], v[12:13], v[124:125] op_sel:[0,1,0] op_sel_hi:[1,1,1]
    v_pk_fma_f32 v[126:127], v[30:31], v[12:13], v[126:127] op_sel:[0,1,0] op_sel_hi:[1,1,1]
    v_pk_fma_f32 v[128:129], v[24:25], v[14:15], v[128:129] op_sel_hi:[1,0,1]
    v_pk_fma_f32 v[130:131], v[26:27], v[14:15], v[130:131] op_sel_hi:[1,0,1]
    v_pk_fma_f32 v[132:133], v[28:29], v[14:15], v[132:133] op_sel_hi:[1,0,1]
    v_pk_fma_f32 v[134:135], v[30:31], v[14:15], v[134:135] op_sel_hi:[1,0,1]
    v_pk_fma_f32 v[136:137], v[24:25], v[14:15], v[136:137] op_sel:[0,1,0] op_sel_hi:[1,1,1]
    v_pk_fma_f32 v[138:139], v[26:27], v[14:15], v[138:139] op_sel:[0,1,0] op_sel_hi:[1,1,1]
    v_pk_fma_f32 v[140:141], v[28:29], v[14:15], v[140:141] op_sel:[0,1,0] op_sel_hi:[1,1,1]
    v_pk_fma_f32 v[142:143], v[30:31], v[14:15], v[142:143] op_sel:[0,1,0] op_sel_hi:[1,1,1]
    s_cmp_eq_u32 s18, 0
    s_cbranch_scc1 L_nb12
    s_sub_u32 s18, s18, 1
    s_barrier
L_nb12:
    s_mov_b32 s57, 264192
    buffer_load_dwordx4 v[48:51], v3, s[32:35], s57 offen
    buffer_load_dwordx4 v[52:55], v3, s[36:39], s57 offen
    s_mov_b32 s57, 308224
    buffer_load_dwordx4 v[56:59], v3, s[32:35], s57 offen
    buffer_load_dwordx4 v[60:63], v3, s[36:39], s57 offen
    ds_read_b128 v[12:15], v7 offset:17664
    s_waitcnt vmcnt(6) lgkmcnt(1)
    v_lshlrev_b32 v16, 16, v32
    v_and_b32 v17, s60, v32
    v_lshlrev_b32 v18, 16, v33
    v_and_b32 v19, s60, v33
    v_lshlrev_b32 v20, 16, v34
    v_and_b32 v21, s60, v34
    v_lshlrev_b32 v22, 16, v35
    v_and_b32 v23, s60, v35
    v_lshlrev_b32 v24, 16, v36
    v_and_b32 v25, s60, v36
    v_lshlrev_b32 v26, 16, v37
    v_and_b32 v27, s60, v37
    v_lshlrev_b32 v28, 16, v38
    v_and_b32 v29, s60, v38
    v_lshlrev_b32 v30, 16, v39
    v_and_b32 v31, s60, v39
    v_pk_fma_f32 v[80:81], v[16:17], v[8:9], v[80:81] op_sel_hi:[1,0,1]
    v_pk_fma_f32 v[82:83], v[18:19], v[8:9], v[82:83] op_sel_hi:[1,0,1]
    v_pk_fma_f32 v[84:85], v[20:21], v[8:9], v[84:85] op_sel_hi:[1,0,1]
    v_pk_fma_f32 v[86:87], v[22:23], v[8:9], v[86:87] op_sel_hi:[1,0,1]
    v_pk_fma_f32 v[88:89], v[16:17], v[8:9], v[88:89] op_sel:[0,1,0] op_sel_hi:[1,1,1]
    v_pk_fma_f32 v[90:91], v[18:19], v[8:9], v[90:91] op_sel:[0,1,0] op_sel_hi:[1,1,1]
    v_pk_fma_f32 v[92:93], v[20:21], v[8:9], v[92:93] op_sel:[0,1,0] op_sel_hi:[1,1,1]
    v_pk_fma_f32 v[94:95], v[22:23], v[8:9], v[94:95] op_sel:[0,1,0] op_sel_hi:[1,1,1]
    v_pk_fma_f32 v[96:97], v[16:17], v[10:11], v[96:97] op_sel_hi:[1,0,1]
    v_pk_fma_f32 v[98:99], v[18:19], v[10:11], v[98:99] op_sel_hi:[1,0,1]
    v_pk_fma_f32 v[100:101], v[20:21], v[10:11], v[100:101] op_sel_hi:[1,0,1]
    v_pk_fma_f32 v[102:103], v[22:23], v[10:11], v[102:103] op_sel_hi:[1,0,1]
    v_pk_fma_f32 v[104:105], v[16:17], v[10:11], v[104:105] op_sel:[0,1,0] op_sel_hi:[1,1,1]
    v_pk_fma_f32 v[106:107], v[18:19], v[10:11], v[106:107] op_sel:[0,1,0] op_sel_hi:[1,1,1]
    v_pk_fma_f32 v[108:109], v[20:21], v[10:11], v[108:109] op_sel:[0,1,0] op_sel_hi:[1,1,1]
    v_pk_fma_f32 v[110:111], v[22:23], v[10:11], v[110:111] op_sel:[0,1,0] op_sel_hi:[1,1,1]
    v_pk_fma_f32 v[112:113], v[24:25], v[8:9], v[112:113] op_sel_hi:[1,0,1]
    v_pk_fma_f32 v[114:115], v[26:27], v[8:9], v[114:115] op_sel_hi:[1,0,1]
    v_pk_fma_f32 v[116:117], v[28:29], v[8:9], v[116:117] op_sel_hi:[1,0,1]
    v_pk_fma_f32 v[118:119], v[30:31], v[8:9], v[118:119] op_sel_hi:[1,0,1]
    v_pk_fma_f32 v[120:121], v[24:25], v[8:9], v[120:121] op_sel:[0,1,0] op_sel_hi:[1,1,1]
    v_pk_fma_f32 v[122:123], v[26:27], v[8:9], v[122:123] op_sel:[0,1,0] op_sel_hi:[1,1,1]
    v_pk_fma_f32 v[124:125], v[28:29], v[8:9], v[124:125] op_sel:[0,1,0] op_sel_hi:[1,1,1]
    v_pk_fma_f32 v[126:127], v[30:31], v[8:9], v[126:127] op_sel:[0,1,0] op_sel_hi:[1,1,1]
    v_pk_fma_f32 v[128:129], v[24:25], v[10:11], v[128:129] op_sel_hi:[1,0,1]
    v_pk_fma_f32 v[130:131], v[26:27], v[10:11], v[130:131] op_sel_hi:[1,0,1]
    v_pk_fma_f32 v[132:133], v[28:29], v[10:11], v[132:133] op_sel_hi:[1,0,1]
    v_pk_fma_f32 v[134:135], v[30:31], v[10:11], v[134:135] op_sel_hi:[1,0,1]
    v_pk_fma_f32 v[136:137], v[24:25], v[10:11], v[136:137] op_sel:[0,1,0] op_sel_hi:[1,1,1]
    v_pk_fma_f32 v[138:139], v[26:27], v[10:11], v[138:139] op_sel:[0,1,0] op_sel_hi:[1,1,1]
    v_pk_fma_f32 v[140:141], v[28:29], v[10:11], v[140:141] op_sel:[0,1,0] op_sel_hi:[1,1,1]
    v_pk_fma_f32 v[142:143], v[30:31], v[10:11], v[142:143] op_sel:[0,1,0] op_sel_hi:[1,1,1]
    ds_read_b128 v[8:11], v7 offset:17920
    s_waitcnt vmcnt(4) lgkmcnt(1)
    v_lshlrev_b32 v16, 16, v40
    v_and_b32 v17, s60, v40
    v_lshlrev_b32 v18, 16, v41
    v_and_b32 v19, s60, v41
    v_lshlrev_b32 v20, 16, v42
    v_and_b32 v21, s60, v42
    v_lshlrev_b32 v22, 16, v43
    v_and_b32 v23, s60, v43
    v_lshlrev_b32 v24, 16, v44
    v_and_b32 v25, s60, v44
    v_lshlrev_b32 v26, 16, v45
    v_and_b32 v27, s60, v45
    v_lshlrev_b32 v28, 16, v46
    v_and_b32 v29, s60, v46
    v_lshlrev_b32 v30, 16, v47
    v_and_b32 v31, s60, v47
    v_pk_fma_f32 v[80:81], v[16:17], v[12:13], v[80:81] op_sel_hi:[1,0,1]
    v_pk_fma_f32 v[82:83], v[18:19], v[12:13], v[82:83] op_sel_hi:[1,0,1]
    v_pk_fma_f32 v[84:85], v[20:21], v[12:13], v[84:85] op_sel_hi:[1,0,1]
    v_pk_fma_f32 v[86:87], v[22:23], v[12:13], v[86:87] op_sel_hi:[1,0,1]
    v_pk_fma_f32 v[88:89], v[16:17], v[12:13], v[88:89] op_sel:[0,1,0] op_sel_hi:[1,1,1]
    v_pk_fma_f32 v[90:91], v[18:19], v[12:13], v[90:91] op_sel:[0,1,0] op_sel_hi:[1,1,1]
    v_pk_fma_f32 v[92:93], v[20:21], v[12:13], v[92:93] op_sel:[0,1,0] op_sel_hi:[1,1,1]
    v_pk_fma_f32 v[94:95], v[22:23], v[12:13], v[94:95] op_sel:[0,1,0] op_sel_hi:[1,1,1]
    v_pk_fma_f32 v[96:97], v[16:17], v[14:15], v[96:97] op_sel_hi:[1,0,1]
    v_pk_fma_f32 v[98:99], v[18:19], v[14:15], v[98:99] op_sel_hi:[1,0,1]
    v_pk_fma_f32 v[100:101], v[20:21], v[14:15], v[100:101] op_sel_hi:[1,0,1]
    v_pk_fma_f32 v[102:103], v[22:23], v[14:15], v[102:103] op_sel_hi:[1,0,1]
    v_pk_fma_f32 v[104:105], v[16:17], v[14:15], v[104:105] op_sel:[0,1,0] op_sel_hi:[1,1,1]
    v_pk_fma_f32 v[106:107], v[18:19], v[14:15], v[106:107] op_sel:[0,1,0] op_sel_hi:[1,1,1]
    v_pk_fma_f32 v[108:109], v[20:21], v[14:15], v[108:109] op_sel:[0,1,0] op_sel_hi:[1,1,1]
    v_pk_fma_f32 v[110:111], v[22:23], v[14:15], v[110:111] op_sel:[0,1,0] op_sel_hi:[1,1,1]
    v_pk_fma_f32 v[112:113], v[24:25], v[12:13], v[112:113] op_sel_hi:[1,0,1]
    v_pk_fma_f32 v[114:115], v[26:27], v[12:13], v[114:115] op_sel_hi:[1,0,1]
    v_pk_fma_f32 v[116:117], v[28:29], v[12:13], v[116:117] op_sel_hi:[1,0,1]
    v_pk_fma_f32 v[118:119], v[30:31], v[12:13], v[118:119] op_sel_hi:[1,0,1]
    v_pk_fma_f32 v[120:121], v[24:25], v[12:13], v[120:121] op_sel:[0,1,0] op_sel_hi:[1,1,1]
    v_pk_fma_f32 v[122:123], v[26:27], v[12:13], v[122:123] op_sel:[0,1,0] op_sel_hi:[1,1,1]
    v_pk_fma_f32 v[124:125], v[28:29], v[12:13], v[124:125] op_sel:[0,1,0] op_sel_hi:[1,1,1]
    v_pk_fma_f32 v[126:127], v[30:31], v[12:13], v[126:127] op_sel:[0,1,0] op_sel_hi:[1,1,1]
    v_pk_fma_f32 v[128:129], v[24:25], v[14:15], v[128:129] op_sel_hi:[1,0,1]
    v_pk_fma_f32 v[130:131], v[26:27], v[14:15], v[130:131] op_sel_hi:[1,0,1]
    v_pk_fma_f32 v[132:133], v[28:29], v[14:15], v[132:133] op_sel_hi:[1,0,1]
    v_pk_fma_f32 v[134:135], v[30:31], v[14:15], v[134:135] op_sel_hi:[1,0,1]
    v_pk_fma_f32 v[136:137], v[24:25], v[14:15], v[136:137] op_sel:[0,1,0] op_sel_hi:[1,1,1]
    v_pk_fma_f32 v[138:139], v[26:27], v[14:15], v[138:139] op_sel:[0,1,0] op_sel_hi:[1,1,1]
    v_pk_fma_f32 v[140:141], v[28:29], v[14:15], v[140:141] op_sel:[0,1,0] op_sel_hi:[1,1,1]
    v_pk_fma_f32 v[142:143], v[30:31], v[14:15], v[142:143] op_sel:[0,1,0] op_sel_hi:[1,1,1]
    s_mov_b64 exec, 1
    buffer_load_dword v30, off, s[64:67], 0 offset:0
    s_mov_b32 s11, 524288
L_ci1:
    s_cmp_eq_u32 s18, 0
    s_cbranch_scc1 L_nb13
    s_sub_u32 s18, s18, 1
    s_barrier
L_nb13:
    s_cmp_eq_u32 s18, 0
    s_cbranch_scc1 L_nb14
    s_sub_u32 s18, s18, 1
    s_barrier
L_nb14:
    s_waitcnt vmcnt(0)
    v_cmp_gt_u32 vcc, 32, v30
    s_sub_u32 s11, s11, 1
    s_cbranch_scc1 L_cid1
    s_cbranch_vccz L_cid1
    buffer_load_dword v30, off, s[64:67], 0 offset:0 sc1
    s_branch L_ci1
L_cid1:
    v_mov_b32 v30, 1
    v_mov_b32 v1, 0
    ds_write_b32 v1, v30 offset:12568
    s_waitcnt lgkmcnt(0)
    s_mov_b64 exec, -1
    s_mov_b32 s57, 352256
    buffer_load_dwordx4 v[32:35], v3, s[32:35], s57 offen
    buffer_load_dwordx4 v[36:39], v3, s[36:39], s57 offen
    s_mov_b32 s57, 396288
    buffer_load_dwordx4 v[40:43], v3, s[32:35], s57 offen
    buffer_load_dwordx4 v[44:47], v3, s[36:39], s57 offen
    ds_read_b128 v[12:15], v7 offset:18176
    s_waitcnt vmcnt(6) lgkmcnt(1)
    v_lshlrev_b32 v16, 16, v48
    v_and_b32 v17, s60, v48
    v_lshlrev_b32 v18, 16, v49
    v_and_b32 v19, s60, v49
    v_lshlrev_b32 v20, 16, v50
    v_and_b32 v21, s60, v50
    v_lshlrev_b32 v22, 16, v51
    v_and_b32 v23, s60, v51
    v_lshlrev_b32 v24, 16, v52
    v_and_b32 v25, s60, v52
    v_lshlrev_b32 v26, 16, v53
    v_and_b32 v27, s60, v53
    v_lshlrev_b32 v28, 16, v54
    v_and_b32 v29, s60, v54
    v_lshlrev_b32 v30, 16, v55
    v_and_b32 v31, s60, v55
    v_pk_fma_f32 v[80:81], v[16:17], v[8:9], v[80:81] op_sel_hi:[1,0,1]
    v_pk_fma_f32 v[82:83], v[18:19], v[8:9], v[82:83] op_sel_hi:[1,0,1]
    v_pk_fma_f32 v[84:85], v[20:21], v[8:9], v[84:85] op_sel_hi:[1,0,1]
    v_pk_fma_f32 v[86:87], v[22:23], v[8:9], v[86:87] op_sel_hi:[1,0,1]
    v_pk_fma_f32 v[88:89], v[16:17], v[8:9], v[88:89] op_sel:[0,1,0] op_sel_hi:[1,1,1]
    v_pk_fma_f32 v[90:91], v[18:19], v[8:9], v[90:91] op_sel:[0,1,0] op_sel_hi:[1,1,1]
    v_pk_fma_f32 v[92:93], v[20:21], v[8:9], v[92:93] op_sel:[0,1,0] op_sel_hi:[1,1,1]
    v_pk_fma_f32 v[94:95], v[22:23], v[8:9], v[94:95] op_sel:[0,1,0] op_sel_hi:[1,1,1]
    v_pk_fma_f32 v[96:97], v[16:17], v[10:11], v[96:97] op_sel_hi:[1,0,1]
    v_pk_fma_f32 v[98:99], v[18:19], v[10:11], v[98:99] op_sel_hi:[1,0,1]
    v_pk_fma_f32 v[100:101], v[20:21], v[10:11], v[100:101] op_sel_hi:[1,0,1]
    v_pk_fma_f32 v[102:103], v[22:23], v[10:11], v[102:103] op_sel_hi:[1,0,1]
    v_pk_fma_f32 v[104:105], v[16:17], v[10:11], v[104:105] op_sel:[0,1,0] op_sel_hi:[1,1,1]
    v_pk_fma_f32 v[106:107], v[18:19], v[10:11], v[106:107] op_sel:[0,1,0] op_sel_hi:[1,1,1]
    v_pk_fma_f32 v[108:109], v[20:21], v[10:11], v[108:109] op_sel:[0,1,0] op_sel_hi:[1,1,1]
    v_pk_fma_f32 v[110:111], v[22:23], v[10:11], v[110:111] op_sel:[0,1,0] op_sel_hi:[1,1,1]
    v_pk_fma_f32 v[112:113], v[24:25], v[8:9], v[112:113] op_sel_hi:[1,0,1]
    v_pk_fma_f32 v[114:115], v[26:27], v[8:9], v[114:115] op_sel_hi:[1,0,1]
    v_pk_fma_f32 v[116:117], v[28:29], v[8:9], v[116:117] op_sel_hi:[1,0,1]
    v_pk_fma_f32 v[118:119], v[30:31], v[8:9], v[118:119] op_sel_hi:[1,0,1]
    v_pk_fma_f32 v[120:121], v[24:25], v[8:9], v[120:121] op_sel:[0,1,0] op_sel_hi:[1,1,1]
    v_pk_fma_f32 v[122:123], v[26:27], v[8:9], v[122:123] op_sel:[0,1,0] op_sel_hi:[1,1,1]
    v_pk_fma_f32 v[124:125], v[28:29], v[8:9], v[124:125] op_sel:[0,1,0] op_sel_hi:[1,1,1]
    v_pk_fma_f32 v[126:127], v[30:31], v[8:9], v[126:127] op_sel:[0,1,0] op_sel_hi:[1,1,1]
    v_pk_fma_f32 v[128:129], v[24:25], v[10:11], v[128:129] op_sel_hi:[1,0,1]
    v_pk_fma_f32 v[130:131], v[26:27], v[10:11], v[130:131] op_sel_hi:[1,0,1]
    v_pk_fma_f32 v[132:133], v[28:29], v[10:11], v[132:133] op_sel_hi:[1,0,1]
    v_pk_fma_f32 v[134:135], v[30:31], v[10:11], v[134:135] op_sel_hi:[1,0,1]
    v_pk_fma_f32 v[136:137], v[24:25], v[10:11], v[136:137] op_sel:[0,1,0] op_sel_hi:[1,1,1]
    v_pk_fma_f32 v[138:139], v[26:27], v[10:11], v[138:139] op_sel:[0,1,0] op_sel_hi:[1,1,1]
    v_pk_fma_f32 v[140:141], v[28:29], v[10:11], v[140:141] op_sel:[0,1,0] op_sel_hi:[1,1,1]
    v_pk_fma_f32 v[142:143], v[30:31], v[10:11], v[142:143] op_sel:[0,1,0] op_sel_hi:[1,1,1]
    ds_read_b128 v[8:11], v7 offset:18432
    s_waitcnt vmcnt(4) lgkmcnt(1)
    v_lshlrev_b32 v16, 16, v56
    v_and_b32 v17, s60, v56
    v_lshlrev_b32 v18, 16, v57
    v_and_b32 v19, s60, v57
    v_lshlrev_b32 v20, 16, v58
    v_and_b32 v21, s60, v58
    v_lshlrev_b32 v22, 16, v59
    v_and_b32 v23, s60, v59
    v_lshlrev_b32 v24, 16, v60
    v_and_b32 v25, s60, v60
    v_lshlrev_b32 v26, 16, v61
    v_and_b32 v27, s60, v61
    v_lshlrev_b32 v28, 16, v62
    v_and_b32 v29, s60, v62
    v_lshlrev_b32 v30, 16, v63
    v_and_b32 v31, s60, v63
    v_pk_fma_f32 v[80:81], v[16:17], v[12:13], v[80:81] op_sel_hi:[1,0,1]
    v_pk_fma_f32 v[82:83], v[18:19], v[12:13], v[82:83] op_sel_hi:[1,0,1]
    v_pk_fma_f32 v[84:85], v[20:21], v[12:13], v[84:85] op_sel_hi:[1,0,1]
    v_pk_fma_f32 v[86:87], v[22:23], v[12:13], v[86:87] op_sel_hi:[1,0,1]
    v_pk_fma_f32 v[88:89], v[16:17], v[12:13], v[88:89] op_sel:[0,1,0] op_sel_hi:[1,1,1]
    v_pk_fma_f32 v[90:91], v[18:19], v[12:13], v[90:91] op_sel:[0,1,0] op_sel_hi:[1,1,1]
    v_pk_fma_f32 v[92:93], v[20:21], v[12:13], v[92:93] op_sel:[0,1,0] op_sel_hi:[1,1,1]
    v_pk_fma_f32 v[94:95], v[22:23], v[12:13], v[94:95] op_sel:[0,1,0] op_sel_hi:[1,1,1]
    v_pk_fma_f32 v[96:97], v[16:17], v[14:15], v[96:97] op_sel_hi:[1,0,1]
    v_pk_fma_f32 v[98:99], v[18:19], v[14:15], v[98:99] op_sel_hi:[1,0,1]
    v_pk_fma_f32 v[100:101], v[20:21], v[14:15], v[100:101] op_sel_hi:[1,0,1]
    v_pk_fma_f32 v[102:103], v[22:23], v[14:15], v[102:103] op_sel_hi:[1,0,1]
    v_pk_fma_f32 v[104:105], v[16:17], v[14:15], v[104:105] op_sel:[0,1,0] op_sel_hi:[1,1,1]
    v_pk_fma_f32 v[106:107], v[18:19], v[14:15], v[106:107] op_sel:[0,1,0] op_sel_hi:[1,1,1]
    v_pk_fma_f32 v[108:109], v[20:21], v[14:15], v[108:109] op_sel:[0,1,0] op_sel_hi:[1,1,1]
    v_pk_fma_f32 v[110:111], v[22:23], v[14:15], v[110:111] op_sel:[0,1,0] op_sel_hi:[1,1,1]
    v_pk_fma_f32 v[112:113], v[24:25], v[12:13], v[112:113] op_sel_hi:[1,0,1]
    v_pk_fma_f32 v[114:115], v[26:27], v[12:13], v[114:115] op_sel_hi:[1,0,1]
    v_pk_fma_f32 v[116:117], v[28:29], v[12:13], v[116:117] op_sel_hi:[1,0,1]
    v_pk_fma_f32 v[118:119], v[30:31], v[12:13], v[118:119] op_sel_hi:[1,0,1]
    v_pk_fma_f32 v[120:121], v[24:25], v[12:13], v[120:121] op_sel:[0,1,0] op_sel_hi:[1,1,1]
    v_pk_fma_f32 v[122:123], v[26:27], v[12:13], v[122:123] op_sel:[0,1,0] op_sel_hi:[1,1,1]
    v_pk_fma_f32 v[124:125], v[28:29], v[12:13], v[124:125] op_sel:[0,1,0] op_sel_hi:[1,1,1]
    v_pk_fma_f32 v[126:127], v[30:31], v[12:13], v[126:127] op_sel:[0,1,0] op_sel_hi:[1,1,1]
    v_pk_fma_f32 v[128:129], v[24:25], v[14:15], v[128:129] op_sel_hi:[1,0,1]
    v_pk_fma_f32 v[130:131], v[26:27], v[14:15], v[130:131] op_sel_hi:[1,0,1]
    v_pk_fma_f32 v[132:133], v[28:29], v[14:15], v[132:133] op_sel_hi:[1,0,1]
    v_pk_fma_f32 v[134:135], v[30:31], v[14:15], v[134:135] op_sel_hi:[1,0,1]
    v_pk_fma_f32 v[136:137], v[24:25], v[14:15], v[136:137] op_sel:[0,1,0] op_sel_hi:[1,1,1]
    v_pk_fma_f32 v[138:139], v[26:27], v[14:15], v[138:139] op_sel:[0,1,0] op_sel_hi:[1,1,1]
    v_pk_fma_f32 v[140:141], v[28:29], v[14:15], v[140:141] op_sel:[0,1,0] op_sel_hi:[1,1,1]
    v_pk_fma_f32 v[142:143], v[30:31], v[14:15], v[142:143] op_sel:[0,1,0] op_sel_hi:[1,1,1]
    s_cmp_eq_u32 s18, 0
    s_cbranch_scc1 L_nb15
    s_sub_u32 s18, s18, 1
    s_barrier
L_nb15:
    s_mov_b32 s57, 440320
    buffer_load_dwordx4 v[48:51], v3, s[32:35], s57 offen
    buffer_load_dwordx4 v[52:55], v3, s[36:39], s57 offen
    s_mov_b32 s57, 484352
    buffer_load_dwordx4 v[56:59], v3, s[32:35], s57 offen
    buffer_load_dwordx4 v[60:63], v3, s[36:39], s57 offen
    ds_read_b128 v[12:15], v7 offset:18688
    s_waitcnt vmcnt(6) lgkmcnt(1)
    v_lshlrev_b32 v16, 16, v32
    v_and_b32 v17, s60, v32
    v_lshlrev_b32 v18, 16, v33
    v_and_b32 v19, s60, v33
    v_lshlrev_b32 v20, 16, v34
    v_and_b32 v21, s60, v34
    v_lshlrev_b32 v22, 16, v35
    v_and_b32 v23, s60, v35
    v_lshlrev_b32 v24, 16, v36
    v_and_b32 v25, s60, v36
    v_lshlrev_b32 v26, 16, v37
    v_and_b32 v27, s60, v37
    v_lshlrev_b32 v28, 16, v38
    v_and_b32 v29, s60, v38
    v_lshlrev_b32 v30, 16, v39
    v_and_b32 v31, s60, v39
    v_pk_fma_f32 v[80:81], v[16:17], v[8:9], v[80:81] op_sel_hi:[1,0,1]
    v_pk_fma_f32 v[82:83], v[18:19], v[8:9], v[82:83] op_sel_hi:[1,0,1]
    v_pk_fma_f32 v[84:85], v[20:21], v[8:9], v[84:85] op_sel_hi:[1,0,1]
    v_pk_fma_f32 v[86:87], v[22:23], v[8:9], v[86:87] op_sel_hi:[1,0,1]
    v_pk_fma_f32 v[88:89], v[16:17], v[8:9], v[88:89] op_sel:[0,1,0] op_sel_hi:[1,1,1]
    v_pk_fma_f32 v[90:91], v[18:19], v[8:9], v[90:91] op_sel:[0,1,0] op_sel_hi:[1,1,1]
    v_pk_fma_f32 v[92:93], v[20:21], v[8:9], v[92:93] op_sel:[0,1,0] op_sel_hi:[1,1,1]
    v_pk_fma_f32 v[94:95], v[22:23], v[8:9], v[94:95] op_sel:[0,1,0] op_sel_hi:[1,1,1]
    v_pk_fma_f32 v[96:97], v[16:17], v[10:11], v[96:97] op_sel_hi:[1,0,1]
    v_pk_fma_f32 v[98:99], v[18:19], v[10:11], v[98:99] op_sel_hi:[1,0,1]
    v_pk_fma_f32 v[100:101], v[20:21], v[10:11], v[100:101] op_sel_hi:[1,0,1]
    v_pk_fma_f32 v[102:103], v[22:23], v[10:11], v[102:103] op_sel_hi:[1,0,1]
    v_pk_fma_f32 v[104:105], v[16:17], v[10:11], v[104:105] op_sel:[0,1,0] op_sel_hi:[1,1,1]
    v_pk_fma_f32 v[106:107], v[18:19], v[10:11], v[106:107] op_sel:[0,1,0] op_sel_hi:[1,1,1]
    v_pk_fma_f32 v[108:109], v[20:21], v[10:11], v[108:109] op_sel:[0,1,0] op_sel_hi:[1,1,1]
    v_pk_fma_f32 v[110:111], v[22:23], v[10:11], v[110:111] op_sel:[0,1,0] op_sel_hi:[1,1,1]
    v_pk_fma_f32 v[112:113], v[24:25], v[8:9], v[112:113] op_sel_hi:[1,0,1]
    v_pk_fma_f32 v[114:115], v[26:27], v[8:9], v[114:115] op_sel_hi:[1,0,1]
    v_pk_fma_f32 v[116:117], v[28:29], v[8:9], v[116:117] op_sel_hi:[1,0,1]
    v_pk_fma_f32 v[118:119], v[30:31], v[8:9], v[118:119] op_sel_hi:[1,0,1]
    v_pk_fma_f32 v[120:121], v[24:25], v[8:9], v[120:121] op_sel:[0,1,0] op_sel_hi:[1,1,1]
    v_pk_fma_f32 v[122:123], v[26:27], v[8:9], v[122:123] op_sel:[0,1,0] op_sel_hi:[1,1,1]
    v_pk_fma_f32 v[124:125], v[28:29], v[8:9], v[124:125] op_sel:[0,1,0] op_sel_hi:[1,1,1]
    v_pk_fma_f32 v[126:127], v[30:31], v[8:9], v[126:127] op_sel:[0,1,0] op_sel_hi:[1,1,1]
    v_pk_fma_f32 v[128:129], v[24:25], v[10:11], v[128:129] op_sel_hi:[1,0,1]
    v_pk_fma_f32 v[130:131], v[26:27], v[10:11], v[130:131] op_sel_hi:[1,0,1]
    v_pk_fma_f32 v[132:133], v[28:29], v[10:11], v[132:133] op_sel_hi:[1,0,1]
    v_pk_fma_f32 v[134:135], v[30:31], v[10:11], v[134:135] op_sel_hi:[1,0,1]
    v_pk_fma_f32 v[136:137], v[24:25], v[10:11], v[136:137] op_sel:[0,1,0] op_sel_hi:[1,1,1]
    v_pk_fma_f32 v[138:139], v[26:27], v[10:11], v[138:139] op_sel:[0,1,0] op_sel_hi:[1,1,1]
    v_pk_fma_f32 v[140:141], v[28:29], v[10:11], v[140:141] op_sel:[0,1,0] op_sel_hi:[1,1,1]
    v_pk_fma_f32 v[142:143], v[30:31], v[10:11], v[142:143] op_sel:[0,1,0] op_sel_hi:[1,1,1]
    ds_read_b128 v[8:11], v7 offset:18944
    s_waitcnt vmcnt(4) lgkmcnt(1)
    v_lshlrev_b32 v16, 16, v40
    v_and_b32 v17, s60, v40
    v_lshlrev_b32 v18, 16, v41
    v_and_b32 v19, s60, v41
    v_lshlrev_b32 v20, 16, v42
    v_and_b32 v21, s60, v42
    v_lshlrev_b32 v22, 16, v43
    v_and_b32 v23, s60, v43
    v_lshlrev_b32 v24, 16, v44
    v_and_b32 v25, s60, v44
    v_lshlrev_b32 v26, 16, v45
    v_and_b32 v27, s60, v45
    v_lshlrev_b32 v28, 16, v46
    v_and_b32 v29, s60, v46
    v_lshlrev_b32 v30, 16, v47
    v_and_b32 v31, s60, v47
    v_pk_fma_f32 v[80:81], v[16:17], v[12:13], v[80:81] op_sel_hi:[1,0,1]
    v_pk_fma_f32 v[82:83], v[18:19], v[12:13], v[82:83] op_sel_hi:[1,0,1]
    v_pk_fma_f32 v[84:85], v[20:21], v[12:13], v[84:85] op_sel_hi:[1,0,1]
    v_pk_fma_f32 v[86:87], v[22:23], v[12:13], v[86:87] op_sel_hi:[1,0,1]
    v_pk_fma_f32 v[88:89], v[16:17], v[12:13], v[88:89] op_sel:[0,1,0] op_sel_hi:[1,1,1]
    v_pk_fma_f32 v[90:91], v[18:19], v[12:13], v[90:91] op_sel:[0,1,0] op_sel_hi:[1,1,1]
    v_pk_fma_f32 v[92:93], v[20:21], v[12:13], v[92:93] op_sel:[0,1,0] op_sel_hi:[1,1,1]
    v_pk_fma_f32 v[94:95], v[22:23], v[12:13], v[94:95] op_sel:[0,1,0] op_sel_hi:[1,1,1]
    v_pk_fma_f32 v[96:97], v[16:17], v[14:15], v[96:97] op_sel_hi:[1,0,1]
    v_pk_fma_f32 v[98:99], v[18:19], v[14:15], v[98:99] op_sel_hi:[1,0,1]
    v_pk_fma_f32 v[100:101], v[20:21], v[14:15], v[100:101] op_sel_hi:[1,0,1]
    v_pk_fma_f32 v[102:103], v[22:23], v[14:15], v[102:103] op_sel_hi:[1,0,1]
    v_pk_fma_f32 v[104:105], v[16:17], v[14:15], v[104:105] op_sel:[0,1,0] op_sel_hi:[1,1,1]
    v_pk_fma_f32 v[106:107], v[18:19], v[14:15], v[106:107] op_sel:[0,1,0] op_sel_hi:[1,1,1]
    v_pk_fma_f32 v[108:109], v[20:21], v[14:15], v[108:109] op_sel:[0,1,0] op_sel_hi:[1,1,1]
    v_pk_fma_f32 v[110:111], v[22:23], v[14:15], v[110:111] op_sel:[0,1,0] op_sel_hi:[1,1,1]
    v_pk_fma_f32 v[112:113], v[24:25], v[12:13], v[112:113] op_sel_hi:[1,0,1]
    v_pk_fma_f32 v[114:115], v[26:27], v[12:13], v[114:115] op_sel_hi:[1,0,1]
    v_pk_fma_f32 v[116:117], v[28:29], v[12:13], v[116:117] op_sel_hi:[1,0,1]
    v_pk_fma_f32 v[118:119], v[30:31], v[12:13], v[118:119] op_sel_hi:[1,0,1]
    v_pk_fma_f32 v[120:121], v[24:25], v[12:13], v[120:121] op_sel:[0,1,0] op_sel_hi:[1,1,1]
    v_pk_fma_f32 v[122:123], v[26:27], v[12:13], v[122:123] op_sel:[0,1,0] op_sel_hi:[1,1,1]
    v_pk_fma_f32 v[124:125], v[28:29], v[12:13], v[124:125] op_sel:[0,1,0] op_sel_hi:[1,1,1]
    v_pk_fma_f32 v[126:127], v[30:31], v[12:13], v[126:127] op_sel:[0,1,0] op_sel_hi:[1,1,1]
    v_pk_fma_f32 v[128:129], v[24:25], v[14:15], v[128:129] op_sel_hi:[1,0,1]
    v_pk_fma_f32 v[130:131], v[26:27], v[14:15], v[130:131] op_sel_hi:[1,0,1]
    v_pk_fma_f32 v[132:133], v[28:29], v[14:15], v[132:133] op_sel_hi:[1,0,1]
    v_pk_fma_f32 v[134:135], v[30:31], v[14:15], v[134:135] op_sel_hi:[1,0,1]
    v_pk_fma_f32 v[136:137], v[24:25], v[14:15], v[136:137] op_sel:[0,1,0] op_sel_hi:[1,1,1]
    v_pk_fma_f32 v[138:139], v[26:27], v[14:15], v[138:139] op_sel:[0,1,0] op_sel_hi:[1,1,1]
    v_pk_fma_f32 v[140:141], v[28:29], v[14:15], v[140:141] op_sel:[0,1,0] op_sel_hi:[1,1,1]
    v_pk_fma_f32 v[142:143], v[30:31], v[14:15], v[142:143] op_sel:[0,1,0] op_sel_hi:[1,1,1]
    s_cmp_eq_u32 s18, 0
    s_cbranch_scc1 L_nb16
    s_sub_u32 s18, s18, 1
    s_barrier
L_nb16:
    s_mov_b32 s57, 528384
    buffer_load_dwordx4 v[32:35], v3, s[32:35], s57 offen
    buffer_load_dwordx4 v[36:39], v3, s[36:39], s57 offen
    s_mov_b32 s57, 572416
    buffer_load_dwordx4 v[40:43], v3, s[32:35], s57 offen
    buffer_load_dwordx4 v[44:47], v3, s[36:39], s57 offen
    ds_read_b128 v[12:15], v7 offset:19200
    s_waitcnt vmcnt(6) lgkmcnt(1)
    v_lshlrev_b32 v16, 16, v48
    v_and_b32 v17, s60, v48
    v_lshlrev_b32 v18, 16, v49
    v_and_b32 v19, s60, v49
    v_lshlrev_b32 v20, 16, v50
    v_and_b32 v21, s60, v50
    v_lshlrev_b32 v22, 16, v51
    v_and_b32 v23, s60, v51
    v_lshlrev_b32 v24, 16, v52
    v_and_b32 v25, s60, v52
    v_lshlrev_b32 v26, 16, v53
    v_and_b32 v27, s60, v53
    v_lshlrev_b32 v28, 16, v54
    v_and_b32 v29, s60, v54
    v_lshlrev_b32 v30, 16, v55
    v_and_b32 v31, s60, v55
    v_pk_fma_f32 v[80:81], v[16:17], v[8:9], v[80:81] op_sel_hi:[1,0,1]
    v_pk_fma_f32 v[82:83], v[18:19], v[8:9], v[82:83] op_sel_hi:[1,0,1]
    v_pk_fma_f32 v[84:85], v[20:21], v[8:9], v[84:85] op_sel_hi:[1,0,1]
    v_pk_fma_f32 v[86:87], v[22:23], v[8:9], v[86:87] op_sel_hi:[1,0,1]
    v_pk_fma_f32 v[88:89], v[16:17], v[8:9], v[88:89] op_sel:[0,1,0] op_sel_hi:[1,1,1]
    v_pk_fma_f32 v[90:91], v[18:19], v[8:9], v[90:91] op_sel:[0,1,0] op_sel_hi:[1,1,1]
    v_pk_fma_f32 v[92:93], v[20:21], v[8:9], v[92:93] op_sel:[0,1,0] op_sel_hi:[1,1,1]
    v_pk_fma_f32 v[94:95], v[22:23], v[8:9], v[94:95] op_sel:[0,1,0] op_sel_hi:[1,1,1]
    v_pk_fma_f32 v[96:97], v[16:17], v[10:11], v[96:97] op_sel_hi:[1,0,1]
    v_pk_fma_f32 v[98:99], v[18:19], v[10:11], v[98:99] op_sel_hi:[1,0,1]
    v_pk_fma_f32 v[100:101], v[20:21], v[10:11], v[100:101] op_sel_hi:[1,0,1]
    v_pk_fma_f32 v[102:103], v[22:23], v[10:11], v[102:103] op_sel_hi:[1,0,1]
    v_pk_fma_f32 v[104:105], v[16:17], v[10:11], v[104:105] op_sel:[0,1,0] op_sel_hi:[1,1,1]
    v_pk_fma_f32 v[106:107], v[18:19], v[10:11], v[106:107] op_sel:[0,1,0] op_sel_hi:[1,1,1]
    v_pk_fma_f32 v[108:109], v[20:21], v[10:11], v[108:109] op_sel:[0,1,0] op_sel_hi:[1,1,1]
    v_pk_fma_f32 v[110:111], v[22:23], v[10:11], v[110:111] op_sel:[0,1,0] op_sel_hi:[1,1,1]
    v_pk_fma_f32 v[112:113], v[24:25], v[8:9], v[112:113] op_sel_hi:[1,0,1]
    v_pk_fma_f32 v[114:115], v[26:27], v[8:9], v[114:115] op_sel_hi:[1,0,1]
    v_pk_fma_f32 v[116:117], v[28:29], v[8:9], v[116:117] op_sel_hi:[1,0,1]
    v_pk_fma_f32 v[118:119], v[30:31], v[8:9], v[118:119] op_sel_hi:[1,0,1]
    v_pk_fma_f32 v[120:121], v[24:25], v[8:9], v[120:121] op_sel:[0,1,0] op_sel_hi:[1,1,1]
    v_pk_fma_f32 v[122:123], v[26:27], v[8:9], v[122:123] op_sel:[0,1,0] op_sel_hi:[1,1,1]
    v_pk_fma_f32 v[124:125], v[28:29], v[8:9], v[124:125] op_sel:[0,1,0] op_sel_hi:[1,1,1]
    v_pk_fma_f32 v[126:127], v[30:31], v[8:9], v[126:127] op_sel:[0,1,0] op_sel_hi:[1,1,1]
    v_pk_fma_f32 v[128:129], v[24:25], v[10:11], v[128:129] op_sel_hi:[1,0,1]
    v_pk_fma_f32 v[130:131], v[26:27], v[10:11], v[130:131] op_sel_hi:[1,0,1]
    v_pk_fma_f32 v[132:133], v[28:29], v[10:11], v[132:133] op_sel_hi:[1,0,1]
    v_pk_fma_f32 v[134:135], v[30:31], v[10:11], v[134:135] op_sel_hi:[1,0,1]
    v_pk_fma_f32 v[136:137], v[24:25], v[10:11], v[136:137] op_sel:[0,1,0] op_sel_hi:[1,1,1]
    v_pk_fma_f32 v[138:139], v[26:27], v[10:11], v[138:139] op_sel:[0,1,0] op_sel_hi:[1,1,1]
    v_pk_fma_f32 v[140:141], v[28:29], v[10:11], v[140:141] op_sel:[0,1,0] op_sel_hi:[1,1,1]
    v_pk_fma_f32 v[142:143], v[30:31], v[10:11], v[142:143] op_sel:[0,1,0] op_sel_hi:[1,1,1]
    ds_read_b128 v[8:11], v7 offset:19456
    s_waitcnt vmcnt(4) lgkmcnt(1)
    v_lshlrev_b32 v16, 16, v56
    v_and_b32 v17, s60, v56
    v_lshlrev_b32 v18, 16, v57
    v_and_b32 v19, s60, v57
    v_lshlrev_b32 v20, 16, v58
    v_and_b32 v21, s60, v58
    v_lshlrev_b32 v22, 16, v59
    v_and_b32 v23, s60, v59
    v_lshlrev_b32 v24, 16, v60
    v_and_b32 v25, s60, v60
    v_lshlrev_b32 v26, 16, v61
    v_and_b32 v27, s60, v61
    v_lshlrev_b32 v28, 16, v62
    v_and_b32 v29, s60, v62
    v_lshlrev_b32 v30, 16, v63
    v_and_b32 v31, s60, v63
    v_pk_fma_f32 v[80:81], v[16:17], v[12:13], v[80:81] op_sel_hi:[1,0,1]
    v_pk_fma_f32 v[82:83], v[18:19], v[12:13], v[82:83] op_sel_hi:[1,0,1]
    v_pk_fma_f32 v[84:85], v[20:21], v[12:13], v[84:85] op_sel_hi:[1,0,1]
    v_pk_fma_f32 v[86:87], v[22:23], v[12:13], v[86:87] op_sel_hi:[1,0,1]
    v_pk_fma_f32 v[88:89], v[16:17], v[12:13], v[88:89] op_sel:[0,1,0] op_sel_hi:[1,1,1]
    v_pk_fma_f32 v[90:91], v[18:19], v[12:13], v[90:91] op_sel:[0,1,0] op_sel_hi:[1,1,1]
    v_pk_fma_f32 v[92:93], v[20:21], v[12:13], v[92:93] op_sel:[0,1,0] op_sel_hi:[1,1,1]
    v_pk_fma_f32 v[94:95], v[22:23], v[12:13], v[94:95] op_sel:[0,1,0] op_sel_hi:[1,1,1]
    v_pk_fma_f32 v[96:97], v[16:17], v[14:15], v[96:97] op_sel_hi:[1,0,1]
    v_pk_fma_f32 v[98:99], v[18:19], v[14:15], v[98:99] op_sel_hi:[1,0,1]
    v_pk_fma_f32 v[100:101], v[20:21], v[14:15], v[100:101] op_sel_hi:[1,0,1]
    v_pk_fma_f32 v[102:103], v[22:23], v[14:15], v[102:103] op_sel_hi:[1,0,1]
    v_pk_fma_f32 v[104:105], v[16:17], v[14:15], v[104:105] op_sel:[0,1,0] op_sel_hi:[1,1,1]
    v_pk_fma_f32 v[106:107], v[18:19], v[14:15], v[106:107] op_sel:[0,1,0] op_sel_hi:[1,1,1]
    v_pk_fma_f32 v[108:109], v[20:21], v[14:15], v[108:109] op_sel:[0,1,0] op_sel_hi:[1,1,1]
    v_pk_fma_f32 v[110:111], v[22:23], v[14:15], v[110:111] op_sel:[0,1,0] op_sel_hi:[1,1,1]
    v_pk_fma_f32 v[112:113], v[24:25], v[12:13], v[112:113] op_sel_hi:[1,0,1]
    v_pk_fma_f32 v[114:115], v[26:27], v[12:13], v[114:115] op_sel_hi:[1,0,1]
    v_pk_fma_f32 v[116:117], v[28:29], v[12:13], v[116:117] op_sel_hi:[1,0,1]
    v_pk_fma_f32 v[118:119], v[30:31], v[12:13], v[118:119] op_sel_hi:[1,0,1]
    v_pk_fma_f32 v[120:121], v[24:25], v[12:13], v[120:121] op_sel:[0,1,0] op_sel_hi:[1,1,1]
    v_pk_fma_f32 v[122:123], v[26:27], v[12:13], v[122:123] op_sel:[0,1,0] op_sel_hi:[1,1,1]
    v_pk_fma_f32 v[124:125], v[28:29], v[12:13], v[124:125] op_sel:[0,1,0] op_sel_hi:[1,1,1]
    v_pk_fma_f32 v[126:127], v[30:31], v[12:13], v[126:127] op_sel:[0,1,0] op_sel_hi:[1,1,1]
    v_pk_fma_f32 v[128:129], v[24:25], v[14:15], v[128:129] op_sel_hi:[1,0,1]
    v_pk_fma_f32 v[130:131], v[26:27], v[14:15], v[130:131] op_sel_hi:[1,0,1]
    v_pk_fma_f32 v[132:133], v[28:29], v[14:15], v[132:133] op_sel_hi:[1,0,1]
    v_pk_fma_f32 v[134:135], v[30:31], v[14:15], v[134:135] op_sel_hi:[1,0,1]
    v_pk_fma_f32 v[136:137], v[24:25], v[14:15], v[136:137] op_sel:[0,1,0] op_sel_hi:[1,1,1]
    v_pk_fma_f32 v[138:139], v[26:27], v[14:15], v[138:139] op_sel:[0,1,0] op_sel_hi:[1,1,1]
    v_pk_fma_f32 v[140:141], v[28:29], v[14:15], v[140:141] op_sel:[0,1,0] op_sel_hi:[1,1,1]
    v_pk_fma_f32 v[142:143], v[30:31], v[14:15], v[142:143] op_sel:[0,1,0] op_sel_hi:[1,1,1]
    s_cmp_eq_u32 s18, 0
    s_cbranch_scc1 L_nb17
    s_sub_u32 s18, s18, 1
    s_barrier
L_nb17:
    s_mov_b32 s57, 616448
    buffer_load_dwordx4 v[48:51], v3, s[32:35], s57 offen
    buffer_load_dwordx4 v[52:55], v3, s[36:39], s57 offen
    s_mov_b32 s57, 660480
    buffer_load_dwordx4 v[56:59], v3, s[32:35], s57 offen
    buffer_load_dwordx4 v[60:63], v3, s[36:39], s57 offen
    ds_read_b128 v[12:15], v7 offset:19712
    s_waitcnt vmcnt(6) lgkmcnt(1)
    v_lshlrev_b32 v16, 16, v32
    v_and_b32 v17, s60, v32
    v_lshlrev_b32 v18, 16, v33
    v_and_b32 v19, s60, v33
    v_lshlrev_b32 v20, 16, v34
    v_and_b32 v21, s60, v34
    v_lshlrev_b32 v22, 16, v35
    v_and_b32 v23, s60, v35
    v_lshlrev_b32 v24, 16, v36
    v_and_b32 v25, s60, v36
    v_lshlrev_b32 v26, 16, v37
    v_and_b32 v27, s60, v37
    v_lshlrev_b32 v28, 16, v38
    v_and_b32 v29, s60, v38
    v_lshlrev_b32 v30, 16, v39
    v_and_b32 v31, s60, v39
    v_pk_fma_f32 v[80:81], v[16:17], v[8:9], v[80:81] op_sel_hi:[1,0,1]
    v_pk_fma_f32 v[82:83], v[18:19], v[8:9], v[82:83] op_sel_hi:[1,0,1]
    v_pk_fma_f32 v[84:85], v[20:21], v[8:9], v[84:85] op_sel_hi:[1,0,1]
    v_pk_fma_f32 v[86:87], v[22:23], v[8:9], v[86:87] op_sel_hi:[1,0,1]
    v_pk_fma_f32 v[88:89], v[16:17], v[8:9], v[88:89] op_sel:[0,1,0] op_sel_hi:[1,1,1]
    v_pk_fma_f32 v[90:91], v[18:19], v[8:9], v[90:91] op_sel:[0,1,0] op_sel_hi:[1,1,1]
    v_pk_fma_f32 v[92:93], v[20:21], v[8:9], v[92:93] op_sel:[0,1,0] op_sel_hi:[1,1,1]
    v_pk_fma_f32 v[94:95], v[22:23], v[8:9], v[94:95] op_sel:[0,1,0] op_sel_hi:[1,1,1]
    v_pk_fma_f32 v[96:97], v[16:17], v[10:11], v[96:97] op_sel_hi:[1,0,1]
    v_pk_fma_f32 v[98:99], v[18:19], v[10:11], v[98:99] op_sel_hi:[1,0,1]
    v_pk_fma_f32 v[100:101], v[20:21], v[10:11], v[100:101] op_sel_hi:[1,0,1]
    v_pk_fma_f32 v[102:103], v[22:23], v[10:11], v[102:103] op_sel_hi:[1,0,1]
    v_pk_fma_f32 v[104:105], v[16:17], v[10:11], v[104:105] op_sel:[0,1,0] op_sel_hi:[1,1,1]
    v_pk_fma_f32 v[106:107], v[18:19], v[10:11], v[106:107] op_sel:[0,1,0] op_sel_hi:[1,1,1]
    v_pk_fma_f32 v[108:109], v[20:21], v[10:11], v[108:109] op_sel:[0,1,0] op_sel_hi:[1,1,1]
    v_pk_fma_f32 v[110:111], v[22:23], v[10:11], v[110:111] op_sel:[0,1,0] op_sel_hi:[1,1,1]
    v_pk_fma_f32 v[112:113], v[24:25], v[8:9], v[112:113] op_sel_hi:[1,0,1]
    v_pk_fma_f32 v[114:115], v[26:27], v[8:9], v[114:115] op_sel_hi:[1,0,1]
    v_pk_fma_f32 v[116:117], v[28:29], v[8:9], v[116:117] op_sel_hi:[1,0,1]
    v_pk_fma_f32 v[118:119], v[30:31], v[8:9], v[118:119] op_sel_hi:[1,0,1]
    v_pk_fma_f32 v[120:121], v[24:25], v[8:9], v[120:121] op_sel:[0,1,0] op_sel_hi:[1,1,1]
    v_pk_fma_f32 v[122:123], v[26:27], v[8:9], v[122:123] op_sel:[0,1,0] op_sel_hi:[1,1,1]
    v_pk_fma_f32 v[124:125], v[28:29], v[8:9], v[124:125] op_sel:[0,1,0] op_sel_hi:[1,1,1]
    v_pk_fma_f32 v[126:127], v[30:31], v[8:9], v[126:127] op_sel:[0,1,0] op_sel_hi:[1,1,1]
    v_pk_fma_f32 v[128:129], v[24:25], v[10:11], v[128:129] op_sel_hi:[1,0,1]
    v_pk_fma_f32 v[130:131], v[26:27], v[10:11], v[130:131] op_sel_hi:[1,0,1]
    v_pk_fma_f32 v[132:133], v[28:29], v[10:11], v[132:133] op_sel_hi:[1,0,1]
    v_pk_fma_f32 v[134:135], v[30:31], v[10:11], v[134:135] op_sel_hi:[1,0,1]
    v_pk_fma_f32 v[136:137], v[24:25], v[10:11], v[136:137] op_sel:[0,1,0] op_sel_hi:[1,1,1]
    v_pk_fma_f32 v[138:139], v[26:27], v[10:11], v[138:139] op_sel:[0,1,0] op_sel_hi:[1,1,1]
    v_pk_fma_f32 v[140:141], v[28:29], v[10:11], v[140:141] op_sel:[0,1,0] op_sel_hi:[1,1,1]
    v_pk_fma_f32 v[142:143], v[30:31], v[10:11], v[142:143] op_sel:[0,1,0] op_sel_hi:[1,1,1]
    ds_read_b128 v[8:11], v7 offset:19968
    s_waitcnt vmcnt(4) lgkmcnt(1)
    v_lshlrev_b32 v16, 16, v40
    v_and_b32 v17, s60, v40
    v_lshlrev_b32 v18, 16, v41
    v_and_b32 v19, s60, v41
    v_lshlrev_b32 v20, 16, v42
    v_and_b32 v21, s60, v42
    v_lshlrev_b32 v22, 16, v43
    v_and_b32 v23, s60, v43
    v_lshlrev_b32 v24, 16, v44
    v_and_b32 v25, s60, v44
    v_lshlrev_b32 v26, 16, v45
    v_and_b32 v27, s60, v45
    v_lshlrev_b32 v28, 16, v46
    v_and_b32 v29, s60, v46
    v_lshlrev_b32 v30, 16, v47
    v_and_b32 v31, s60, v47
    v_pk_fma_f32 v[80:81], v[16:17], v[12:13], v[80:81] op_sel_hi:[1,0,1]
    v_pk_fma_f32 v[82:83], v[18:19], v[12:13], v[82:83] op_sel_hi:[1,0,1]
    v_pk_fma_f32 v[84:85], v[20:21], v[12:13], v[84:85] op_sel_hi:[1,0,1]
    v_pk_fma_f32 v[86:87], v[22:23], v[12:13], v[86:87] op_sel_hi:[1,0,1]
    v_pk_fma_f32 v[88:89], v[16:17], v[12:13], v[88:89] op_sel:[0,1,0] op_sel_hi:[1,1,1]
    v_pk_fma_f32 v[90:91], v[18:19], v[12:13], v[90:91] op_sel:[0,1,0] op_sel_hi:[1,1,1]
    v_pk_fma_f32 v[92:93], v[20:21], v[12:13], v[92:93] op_sel:[0,1,0] op_sel_hi:[1,1,1]
    v_pk_fma_f32 v[94:95], v[22:23], v[12:13], v[94:95] op_sel:[0,1,0] op_sel_hi:[1,1,1]
    v_pk_fma_f32 v[96:97], v[16:17], v[14:15], v[96:97] op_sel_hi:[1,0,1]
    v_pk_fma_f32 v[98:99], v[18:19], v[14:15], v[98:99] op_sel_hi:[1,0,1]
    v_pk_fma_f32 v[100:101], v[20:21], v[14:15], v[100:101] op_sel_hi:[1,0,1]
    v_pk_fma_f32 v[102:103], v[22:23], v[14:15], v[102:103] op_sel_hi:[1,0,1]
    v_pk_fma_f32 v[104:105], v[16:17], v[14:15], v[104:105] op_sel:[0,1,0] op_sel_hi:[1,1,1]
    v_pk_fma_f32 v[106:107], v[18:19], v[14:15], v[106:107] op_sel:[0,1,0] op_sel_hi:[1,1,1]
    v_pk_fma_f32 v[108:109], v[20:21], v[14:15], v[108:109] op_sel:[0,1,0] op_sel_hi:[1,1,1]
    v_pk_fma_f32 v[110:111], v[22:23], v[14:15], v[110:111] op_sel:[0,1,0] op_sel_hi:[1,1,1]
    v_pk_fma_f32 v[112:113], v[24:25], v[12:13], v[112:113] op_sel_hi:[1,0,1]
    v_pk_fma_f32 v[114:115], v[26:27], v[12:13], v[114:115] op_sel_hi:[1,0,1]
    v_pk_fma_f32 v[116:117], v[28:29], v[12:13], v[116:117] op_sel_hi:[1,0,1]
    v_pk_fma_f32 v[118:119], v[30:31], v[12:13], v[118:119] op_sel_hi:[1,0,1]
    v_pk_fma_f32 v[120:121], v[24:25], v[12:13], v[120:121] op_sel:[0,1,0] op_sel_hi:[1,1,1]
    v_pk_fma_f32 v[122:123], v[26:27], v[12:13], v[122:123] op_sel:[0,1,0] op_sel_hi:[1,1,1]
    v_pk_fma_f32 v[124:125], v[28:29], v[12:13], v[124:125] op_sel:[0,1,0] op_sel_hi:[1,1,1]
    v_pk_fma_f32 v[126:127], v[30:31], v[12:13], v[126:127] op_sel:[0,1,0] op_sel_hi:[1,1,1]
    v_pk_fma_f32 v[128:129], v[24:25], v[14:15], v[128:129] op_sel_hi:[1,0,1]
    v_pk_fma_f32 v[130:131], v[26:27], v[14:15], v[130:131] op_sel_hi:[1,0,1]
    v_pk_fma_f32 v[132:133], v[28:29], v[14:15], v[132:133] op_sel_hi:[1,0,1]
    v_pk_fma_f32 v[134:135], v[30:31], v[14:15], v[134:135] op_sel_hi:[1,0,1]
    v_pk_fma_f32 v[136:137], v[24:25], v[14:15], v[136:137] op_sel:[0,1,0] op_sel_hi:[1,1,1]
    v_pk_fma_f32 v[138:139], v[26:27], v[14:15], v[138:139] op_sel:[0,1,0] op_sel_hi:[1,1,1]
    v_pk_fma_f32 v[140:141], v[28:29], v[14:15], v[140:141] op_sel:[0,1,0] op_sel_hi:[1,1,1]
    v_pk_fma_f32 v[142:143], v[30:31], v[14:15], v[142:143] op_sel:[0,1,0] op_sel_hi:[1,1,1]
    s_cmp_eq_u32 s18, 0
    s_cbranch_scc1 L_nb18
    s_sub_u32 s18, s18, 1
    s_barrier
L_nb18:
    s_mov_b32 s57, 704512
    buffer_load_dwordx4 v[32:35], v3, s[32:35], s57 offen
    buffer_load_dwordx4 v[36:39], v3, s[36:39], s57 offen
    s_mov_b32 s57, 748544
    buffer_load_dwordx4 v[40:43], v3, s[32:35], s57 offen
    buffer_load_dwordx4 v[44:47], v3, s[36:39], s57 offen
    ds_read_b128 v[12:15], v7 offset:20224
    s_waitcnt vmcnt(6) lgkmcnt(1)
    v_lshlrev_b32 v16, 16, v48
    v_and_b32 v17, s60, v48
    v_lshlrev_b32 v18, 16, v49
    v_and_b32 v19, s60, v49
    v_lshlrev_b32 v20, 16, v50
    v_and_b32 v21, s60, v50
    v_lshlrev_b32 v22, 16, v51
    v_and_b32 v23, s60, v51
    v_lshlrev_b32 v24, 16, v52
    v_and_b32 v25, s60, v52
    v_lshlrev_b32 v26, 16, v53
    v_and_b32 v27, s60, v53
    v_lshlrev_b32 v28, 16, v54
    v_and_b32 v29, s60, v54
    v_lshlrev_b32 v30, 16, v55
    v_and_b32 v31, s60, v55
    v_pk_fma_f32 v[80:81], v[16:17], v[8:9], v[80:81] op_sel_hi:[1,0,1]
    v_pk_fma_f32 v[82:83], v[18:19], v[8:9], v[82:83] op_sel_hi:[1,0,1]
    v_pk_fma_f32 v[84:85], v[20:21], v[8:9], v[84:85] op_sel_hi:[1,0,1]
    v_pk_fma_f32 v[86:87], v[22:23], v[8:9], v[86:87] op_sel_hi:[1,0,1]
    v_pk_fma_f32 v[88:89], v[16:17], v[8:9], v[88:89] op_sel:[0,1,0] op_sel_hi:[1,1,1]
    v_pk_fma_f32 v[90:91], v[18:19], v[8:9], v[90:91] op_sel:[0,1,0] op_sel_hi:[1,1,1]
    v_pk_fma_f32 v[92:93], v[20:21], v[8:9], v[92:93] op_sel:[0,1,0] op_sel_hi:[1,1,1]
    v_pk_fma_f32 v[94:95], v[22:23], v[8:9], v[94:95] op_sel:[0,1,0] op_sel_hi:[1,1,1]
    v_pk_fma_f32 v[96:97], v[16:17], v[10:11], v[96:97] op_sel_hi:[1,0,1]
    v_pk_fma_f32 v[98:99], v[18:19], v[10:11], v[98:99] op_sel_hi:[1,0,1]
    v_pk_fma_f32 v[100:101], v[20:21], v[10:11], v[100:101] op_sel_hi:[1,0,1]
    v_pk_fma_f32 v[102:103], v[22:23], v[10:11], v[102:103] op_sel_hi:[1,0,1]
    v_pk_fma_f32 v[104:105], v[16:17], v[10:11], v[104:105] op_sel:[0,1,0] op_sel_hi:[1,1,1]
    v_pk_fma_f32 v[106:107], v[18:19], v[10:11], v[106:107] op_sel:[0,1,0] op_sel_hi:[1,1,1]
    v_pk_fma_f32 v[108:109], v[20:21], v[10:11], v[108:109] op_sel:[0,1,0] op_sel_hi:[1,1,1]
    v_pk_fma_f32 v[110:111], v[22:23], v[10:11], v[110:111] op_sel:[0,1,0] op_sel_hi:[1,1,1]
    v_pk_fma_f32 v[112:113], v[24:25], v[8:9], v[112:113] op_sel_hi:[1,0,1]
    v_pk_fma_f32 v[114:115], v[26:27], v[8:9], v[114:115] op_sel_hi:[1,0,1]
    v_pk_fma_f32 v[116:117], v[28:29], v[8:9], v[116:117] op_sel_hi:[1,0,1]
    v_pk_fma_f32 v[118:119], v[30:31], v[8:9], v[118:119] op_sel_hi:[1,0,1]
    v_pk_fma_f32 v[120:121], v[24:25], v[8:9], v[120:121] op_sel:[0,1,0] op_sel_hi:[1,1,1]
    v_pk_fma_f32 v[122:123], v[26:27], v[8:9], v[122:123] op_sel:[0,1,0] op_sel_hi:[1,1,1]
    v_pk_fma_f32 v[124:125], v[28:29], v[8:9], v[124:125] op_sel:[0,1,0] op_sel_hi:[1,1,1]
    v_pk_fma_f32 v[126:127], v[30:31], v[8:9], v[126:127] op_sel:[0,1,0] op_sel_hi:[1,1,1]
    v_pk_fma_f32 v[128:129], v[24:25], v[10:11], v[128:129] op_sel_hi:[1,0,1]
    v_pk_fma_f32 v[130:131], v[26:27], v[10:11], v[130:131] op_sel_hi:[1,0,1]
    v_pk_fma_f32 v[132:133], v[28:29], v[10:11], v[132:133] op_sel_hi:[1,0,1]
    v_pk_fma_f32 v[134:135], v[30:31], v[10:11], v[134:135] op_sel_hi:[1,0,1]
    v_pk_fma_f32 v[136:137], v[24:25], v[10:11], v[136:137] op_sel:[0,1,0] op_sel_hi:[1,1,1]
    v_pk_fma_f32 v[138:139], v[26:27], v[10:11], v[138:139] op_sel:[0,1,0] op_sel_hi:[1,1,1]
    v_pk_fma_f32 v[140:141], v[28:29], v[10:11], v[140:141] op_sel:[0,1,0] op_sel_hi:[1,1,1]
    v_pk_fma_f32 v[142:143], v[30:31], v[10:11], v[142:143] op_sel:[0,1,0] op_sel_hi:[1,1,1]
    ds_read_b128 v[8:11], v7 offset:20480
    s_waitcnt vmcnt(4) lgkmcnt(1)
    v_lshlrev_b32 v16, 16, v56
    v_and_b32 v17, s60, v56
    v_lshlrev_b32 v18, 16, v57
    v_and_b32 v19, s60, v57
    v_lshlrev_b32 v20, 16, v58
    v_and_b32 v21, s60, v58
    v_lshlrev_b32 v22, 16, v59
    v_and_b32 v23, s60, v59
    v_lshlrev_b32 v24, 16, v60
    v_and_b32 v25, s60, v60
    v_lshlrev_b32 v26, 16, v61
    v_and_b32 v27, s60, v61
    v_lshlrev_b32 v28, 16, v62
    v_and_b32 v29, s60, v62
    v_lshlrev_b32 v30, 16, v63
    v_and_b32 v31, s60, v63
    v_pk_fma_f32 v[80:81], v[16:17], v[12:13], v[80:81] op_sel_hi:[1,0,1]
    v_pk_fma_f32 v[82:83], v[18:19], v[12:13], v[82:83] op_sel_hi:[1,0,1]
    v_pk_fma_f32 v[84:85], v[20:21], v[12:13], v[84:85] op_sel_hi:[1,0,1]
    v_pk_fma_f32 v[86:87], v[22:23], v[12:13], v[86:87] op_sel_hi:[1,0,1]
    v_pk_fma_f32 v[88:89], v[16:17], v[12:13], v[88:89] op_sel:[0,1,0] op_sel_hi:[1,1,1]
    v_pk_fma_f32 v[90:91], v[18:19], v[12:13], v[90:91] op_sel:[0,1,0] op_sel_hi:[1,1,1]
    v_pk_fma_f32 v[92:93], v[20:21], v[12:13], v[92:93] op_sel:[0,1,0] op_sel_hi:[1,1,1]
    v_pk_fma_f32 v[94:95], v[22:23], v[12:13], v[94:95] op_sel:[0,1,0] op_sel_hi:[1,1,1]
    v_pk_fma_f32 v[96:97], v[16:17], v[14:15], v[96:97] op_sel_hi:[1,0,1]
    v_pk_fma_f32 v[98:99], v[18:19], v[14:15], v[98:99] op_sel_hi:[1,0,1]
    v_pk_fma_f32 v[100:101], v[20:21], v[14:15], v[100:101] op_sel_hi:[1,0,1]
    v_pk_fma_f32 v[102:103], v[22:23], v[14:15], v[102:103] op_sel_hi:[1,0,1]
    v_pk_fma_f32 v[104:105], v[16:17], v[14:15], v[104:105] op_sel:[0,1,0] op_sel_hi:[1,1,1]
    v_pk_fma_f32 v[106:107], v[18:19], v[14:15], v[106:107] op_sel:[0,1,0] op_sel_hi:[1,1,1]
    v_pk_fma_f32 v[108:109], v[20:21], v[14:15], v[108:109] op_sel:[0,1,0] op_sel_hi:[1,1,1]
    v_pk_fma_f32 v[110:111], v[22:23], v[14:15], v[110:111] op_sel:[0,1,0] op_sel_hi:[1,1,1]
    v_pk_fma_f32 v[112:113], v[24:25], v[12:13], v[112:113] op_sel_hi:[1,0,1]
    v_pk_fma_f32 v[114:115], v[26:27], v[12:13], v[114:115] op_sel_hi:[1,0,1]
    v_pk_fma_f32 v[116:117], v[28:29], v[12:13], v[116:117] op_sel_hi:[1,0,1]
    v_pk_fma_f32 v[118:119], v[30:31], v[12:13], v[118:119] op_sel_hi:[1,0,1]
    v_pk_fma_f32 v[120:121], v[24:25], v[12:13], v[120:121] op_sel:[0,1,0] op_sel_hi:[1,1,1]
    v_pk_fma_f32 v[122:123], v[26:27], v[12:13], v[122:123] op_sel:[0,1,0] op_sel_hi:[1,1,1]
    v_pk_fma_f32 v[124:125], v[28:29], v[12:13], v[124:125] op_sel:[0,1,0] op_sel_hi:[1,1,1]
    v_pk_fma_f32 v[126:127], v[30:31], v[12:13], v[126:127] op_sel:[0,1,0] op_sel_hi:[1,1,1]
    v_pk_fma_f32 v[128:129], v[24:25], v[14:15], v[128:129] op_sel_hi:[1,0,1]
    v_pk_fma_f32 v[130:131], v[26:27], v[14:15], v[130:131] op_sel_hi:[1,0,1]
    v_pk_fma_f32 v[132:133], v[28:29], v[14:15], v[132:133] op_sel_hi:[1,0,1]
    v_pk_fma_f32 v[134:135], v[30:31], v[14:15], v[134:135] op_sel_hi:[1,0,1]
    v_pk_fma_f32 v[136:137], v[24:25], v[14:15], v[136:137] op_sel:[0,1,0] op_sel_hi:[1,1,1]
    v_pk_fma_f32 v[138:139], v[26:27], v[14:15], v[138:139] op_sel:[0,1,0] op_sel_hi:[1,1,1]
    v_pk_fma_f32 v[140:141], v[28:29], v[14:15], v[140:141] op_sel:[0,1,0] op_sel_hi:[1,1,1]
    v_pk_fma_f32 v[142:143], v[30:31], v[14:15], v[142:143] op_sel:[0,1,0] op_sel_hi:[1,1,1]
    s_cmp_eq_u32 s18, 0
    s_cbranch_scc1 L_nb19
    s_sub_u32 s18, s18, 1
    s_barrier
L_nb19:
    s_mov_b32 s57, 792576
    buffer_load_dwordx4 v[48:51], v3, s[32:35], s57 offen
    buffer_load_dwordx4 v[52:55], v3, s[36:39], s57 offen
    s_mov_b32 s57, 836608
    buffer_load_dwordx4 v[56:59], v3, s[32:35], s57 offen
    buffer_load_dwordx4 v[60:63], v3, s[36:39], s57 offen
    ds_read_b128 v[12:15], v7 offset:20736
    s_waitcnt vmcnt(6) lgkmcnt(1)
    v_lshlrev_b32 v16, 16, v32
    v_and_b32 v17, s60, v32
    v_lshlrev_b32 v18, 16, v33
    v_and_b32 v19, s60, v33
    v_lshlrev_b32 v20, 16, v34
    v_and_b32 v21, s60, v34
    v_lshlrev_b32 v22, 16, v35
    v_and_b32 v23, s60, v35
    v_lshlrev_b32 v24, 16, v36
    v_and_b32 v25, s60, v36
    v_lshlrev_b32 v26, 16, v37
    v_and_b32 v27, s60, v37
    v_lshlrev_b32 v28, 16, v38
    v_and_b32 v29, s60, v38
    v_lshlrev_b32 v30, 16, v39
    v_and_b32 v31, s60, v39
    v_pk_fma_f32 v[80:81], v[16:17], v[8:9], v[80:81] op_sel_hi:[1,0,1]
    v_pk_fma_f32 v[82:83], v[18:19], v[8:9], v[82:83] op_sel_hi:[1,0,1]
    v_pk_fma_f32 v[84:85], v[20:21], v[8:9], v[84:85] op_sel_hi:[1,0,1]
    v_pk_fma_f32 v[86:87], v[22:23], v[8:9], v[86:87] op_sel_hi:[1,0,1]
    v_pk_fma_f32 v[88:89], v[16:17], v[8:9], v[88:89] op_sel:[0,1,0] op_sel_hi:[1,1,1]
    v_pk_fma_f32 v[90:91], v[18:19], v[8:9], v[90:91] op_sel:[0,1,0] op_sel_hi:[1,1,1]
    v_pk_fma_f32 v[92:93], v[20:21], v[8:9], v[92:93] op_sel:[0,1,0] op_sel_hi:[1,1,1]
    v_pk_fma_f32 v[94:95], v[22:23], v[8:9], v[94:95] op_sel:[0,1,0] op_sel_hi:[1,1,1]
    v_pk_fma_f32 v[96:97], v[16:17], v[10:11], v[96:97] op_sel_hi:[1,0,1]
    v_pk_fma_f32 v[98:99], v[18:19], v[10:11], v[98:99] op_sel_hi:[1,0,1]
    v_pk_fma_f32 v[100:101], v[20:21], v[10:11], v[100:101] op_sel_hi:[1,0,1]
    v_pk_fma_f32 v[102:103], v[22:23], v[10:11], v[102:103] op_sel_hi:[1,0,1]
    v_pk_fma_f32 v[104:105], v[16:17], v[10:11], v[104:105] op_sel:[0,1,0] op_sel_hi:[1,1,1]
    v_pk_fma_f32 v[106:107], v[18:19], v[10:11], v[106:107] op_sel:[0,1,0] op_sel_hi:[1,1,1]
    v_pk_fma_f32 v[108:109], v[20:21], v[10:11], v[108:109] op_sel:[0,1,0] op_sel_hi:[1,1,1]
    v_pk_fma_f32 v[110:111], v[22:23], v[10:11], v[110:111] op_sel:[0,1,0] op_sel_hi:[1,1,1]
    v_pk_fma_f32 v[112:113], v[24:25], v[8:9], v[112:113] op_sel_hi:[1,0,1]
    v_pk_fma_f32 v[114:115], v[26:27], v[8:9], v[114:115] op_sel_hi:[1,0,1]
    v_pk_fma_f32 v[116:117], v[28:29], v[8:9], v[116:117] op_sel_hi:[1,0,1]
    v_pk_fma_f32 v[118:119], v[30:31], v[8:9], v[118:119] op_sel_hi:[1,0,1]
    v_pk_fma_f32 v[120:121], v[24:25], v[8:9], v[120:121] op_sel:[0,1,0] op_sel_hi:[1,1,1]
    v_pk_fma_f32 v[122:123], v[26:27], v[8:9], v[122:123] op_sel:[0,1,0] op_sel_hi:[1,1,1]
    v_pk_fma_f32 v[124:125], v[28:29], v[8:9], v[124:125] op_sel:[0,1,0] op_sel_hi:[1,1,1]
    v_pk_fma_f32 v[126:127], v[30:31], v[8:9], v[126:127] op_sel:[0,1,0] op_sel_hi:[1,1,1]
    v_pk_fma_f32 v[128:129], v[24:25], v[10:11], v[128:129] op_sel_hi:[1,0,1]
    v_pk_fma_f32 v[130:131], v[26:27], v[10:11], v[130:131] op_sel_hi:[1,0,1]
    v_pk_fma_f32 v[132:133], v[28:29], v[10:11], v[132:133] op_sel_hi:[1,0,1]
    v_pk_fma_f32 v[134:135], v[30:31], v[10:11], v[134:135] op_sel_hi:[1,0,1]
    v_pk_fma_f32 v[136:137], v[24:25], v[10:11], v[136:137] op_sel:[0,1,0] op_sel_hi:[1,1,1]
    v_pk_fma_f32 v[138:139], v[26:27], v[10:11], v[138:139] op_sel:[0,1,0] op_sel_hi:[1,1,1]
    v_pk_fma_f32 v[140:141], v[28:29], v[10:11], v[140:141] op_sel:[0,1,0] op_sel_hi:[1,1,1]
    v_pk_fma_f32 v[142:143], v[30:31], v[10:11], v[142:143] op_sel:[0,1,0] op_sel_hi:[1,1,1]
    ds_read_b128 v[8:11], v7 offset:20992
    s_waitcnt vmcnt(4) lgkmcnt(1)
    v_lshlrev_b32 v16, 16, v40
    v_and_b32 v17, s60, v40
    v_lshlrev_b32 v18, 16, v41
    v_and_b32 v19, s60, v41
    v_lshlrev_b32 v20, 16, v42
    v_and_b32 v21, s60, v42
    v_lshlrev_b32 v22, 16, v43
    v_and_b32 v23, s60, v43
    v_lshlrev_b32 v24, 16, v44
    v_and_b32 v25, s60, v44
    v_lshlrev_b32 v26, 16, v45
    v_and_b32 v27, s60, v45
    v_lshlrev_b32 v28, 16, v46
    v_and_b32 v29, s60, v46
    v_lshlrev_b32 v30, 16, v47
    v_and_b32 v31, s60, v47
    v_pk_fma_f32 v[80:81], v[16:17], v[12:13], v[80:81] op_sel_hi:[1,0,1]
    v_pk_fma_f32 v[82:83], v[18:19], v[12:13], v[82:83] op_sel_hi:[1,0,1]
    v_pk_fma_f32 v[84:85], v[20:21], v[12:13], v[84:85] op_sel_hi:[1,0,1]
    v_pk_fma_f32 v[86:87], v[22:23], v[12:13], v[86:87] op_sel_hi:[1,0,1]
    v_pk_fma_f32 v[88:89], v[16:17], v[12:13], v[88:89] op_sel:[0,1,0] op_sel_hi:[1,1,1]
    v_pk_fma_f32 v[90:91], v[18:19], v[12:13], v[90:91] op_sel:[0,1,0] op_sel_hi:[1,1,1]
    v_pk_fma_f32 v[92:93], v[20:21], v[12:13], v[92:93] op_sel:[0,1,0] op_sel_hi:[1,1,1]
    v_pk_fma_f32 v[94:95], v[22:23], v[12:13], v[94:95] op_sel:[0,1,0] op_sel_hi:[1,1,1]
    v_pk_fma_f32 v[96:97], v[16:17], v[14:15], v[96:97] op_sel_hi:[1,0,1]
    v_pk_fma_f32 v[98:99], v[18:19], v[14:15], v[98:99] op_sel_hi:[1,0,1]
    v_pk_fma_f32 v[100:101], v[20:21], v[14:15], v[100:101] op_sel_hi:[1,0,1]
    v_pk_fma_f32 v[102:103], v[22:23], v[14:15], v[102:103] op_sel_hi:[1,0,1]
    v_pk_fma_f32 v[104:105], v[16:17], v[14:15], v[104:105] op_sel:[0,1,0] op_sel_hi:[1,1,1]
    v_pk_fma_f32 v[106:107], v[18:19], v[14:15], v[106:107] op_sel:[0,1,0] op_sel_hi:[1,1,1]
    v_pk_fma_f32 v[108:109], v[20:21], v[14:15], v[108:109] op_sel:[0,1,0] op_sel_hi:[1,1,1]
    v_pk_fma_f32 v[110:111], v[22:23], v[14:15], v[110:111] op_sel:[0,1,0] op_sel_hi:[1,1,1]
    v_pk_fma_f32 v[112:113], v[24:25], v[12:13], v[112:113] op_sel_hi:[1,0,1]
    v_pk_fma_f32 v[114:115], v[26:27], v[12:13], v[114:115] op_sel_hi:[1,0,1]
    v_pk_fma_f32 v[116:117], v[28:29], v[12:13], v[116:117] op_sel_hi:[1,0,1]
    v_pk_fma_f32 v[118:119], v[30:31], v[12:13], v[118:119] op_sel_hi:[1,0,1]
    v_pk_fma_f32 v[120:121], v[24:25], v[12:13], v[120:121] op_sel:[0,1,0] op_sel_hi:[1,1,1]
    v_pk_fma_f32 v[122:123], v[26:27], v[12:13], v[122:123] op_sel:[0,1,0] op_sel_hi:[1,1,1]
    v_pk_fma_f32 v[124:125], v[28:29], v[12:13], v[124:125] op_sel:[0,1,0] op_sel_hi:[1,1,1]
    v_pk_fma_f32 v[126:127], v[30:31], v[12:13], v[126:127] op_sel:[0,1,0] op_sel_hi:[1,1,1]
    v_pk_fma_f32 v[128:129], v[24:25], v[14:15], v[128:129] op_sel_hi:[1,0,1]
    v_pk_fma_f32 v[130:131], v[26:27], v[14:15], v[130:131] op_sel_hi:[1,0,1]
    v_pk_fma_f32 v[132:133], v[28:29], v[14:15], v[132:133] op_sel_hi:[1,0,1]
    v_pk_fma_f32 v[134:135], v[30:31], v[14:15], v[134:135] op_sel_hi:[1,0,1]
    v_pk_fma_f32 v[136:137], v[24:25], v[14:15], v[136:137] op_sel:[0,1,0] op_sel_hi:[1,1,1]
    v_pk_fma_f32 v[138:139], v[26:27], v[14:15], v[138:139] op_sel:[0,1,0] op_sel_hi:[1,1,1]
    v_pk_fma_f32 v[140:141], v[28:29], v[14:15], v[140:141] op_sel:[0,1,0] op_sel_hi:[1,1,1]
    v_pk_fma_f32 v[142:143], v[30:31], v[14:15], v[142:143] op_sel:[0,1,0] op_sel_hi:[1,1,1]
    s_cmp_eq_u32 s18, 0
    s_cbranch_scc1 L_nb20
    s_sub_u32 s18, s18, 1
    s_barrier
L_nb20:
    s_mov_b32 s57, 880640
    buffer_load_dwordx4 v[32:35], v3, s[32:35], s57 offen
    buffer_load_dwordx4 v[36:39], v3, s[36:39], s57 offen
    s_mov_b32 s57, 924672
    buffer_load_dwordx4 v[40:43], v3, s[32:35], s57 offen
    buffer_load_dwordx4 v[44:47], v3, s[36:39], s57 offen
    ds_read_b128 v[12:15], v7 offset:21248
    s_waitcnt vmcnt(6) lgkmcnt(1)
    v_lshlrev_b32 v16, 16, v48
    v_and_b32 v17, s60, v48
    v_lshlrev_b32 v18, 16, v49
    v_and_b32 v19, s60, v49
    v_lshlrev_b32 v20, 16, v50
    v_and_b32 v21, s60, v50
    v_lshlrev_b32 v22, 16, v51
    v_and_b32 v23, s60, v51
    v_lshlrev_b32 v24, 16, v52
    v_and_b32 v25, s60, v52
    v_lshlrev_b32 v26, 16, v53
    v_and_b32 v27, s60, v53
    v_lshlrev_b32 v28, 16, v54
    v_and_b32 v29, s60, v54
    v_lshlrev_b32 v30, 16, v55
    v_and_b32 v31, s60, v55
    v_pk_fma_f32 v[80:81], v[16:17], v[8:9], v[80:81] op_sel_hi:[1,0,1]
    v_pk_fma_f32 v[82:83], v[18:19], v[8:9], v[82:83] op_sel_hi:[1,0,1]
    v_pk_fma_f32 v[84:85], v[20:21], v[8:9], v[84:85] op_sel_hi:[1,0,1]
    v_pk_fma_f32 v[86:87], v[22:23], v[8:9], v[86:87] op_sel_hi:[1,0,1]
    v_pk_fma_f32 v[88:89], v[16:17], v[8:9], v[88:89] op_sel:[0,1,0] op_sel_hi:[1,1,1]
    v_pk_fma_f32 v[90:91], v[18:19], v[8:9], v[90:91] op_sel:[0,1,0] op_sel_hi:[1,1,1]
    v_pk_fma_f32 v[92:93], v[20:21], v[8:9], v[92:93] op_sel:[0,1,0] op_sel_hi:[1,1,1]
    v_pk_fma_f32 v[94:95], v[22:23], v[8:9], v[94:95] op_sel:[0,1,0] op_sel_hi:[1,1,1]
    v_pk_fma_f32 v[96:97], v[16:17], v[10:11], v[96:97] op_sel_hi:[1,0,1]
    v_pk_fma_f32 v[98:99], v[18:19], v[10:11], v[98:99] op_sel_hi:[1,0,1]
    v_pk_fma_f32 v[100:101], v[20:21], v[10:11], v[100:101] op_sel_hi:[1,0,1]
    v_pk_fma_f32 v[102:103], v[22:23], v[10:11], v[102:103] op_sel_hi:[1,0,1]
    v_pk_fma_f32 v[104:105], v[16:17], v[10:11], v[104:105] op_sel:[0,1,0] op_sel_hi:[1,1,1]
    v_pk_fma_f32 v[106:107], v[18:19], v[10:11], v[106:107] op_sel:[0,1,0] op_sel_hi:[1,1,1]
    v_pk_fma_f32 v[108:109], v[20:21], v[10:11], v[108:109] op_sel:[0,1,0] op_sel_hi:[1,1,1]
    v_pk_fma_f32 v[110:111], v[22:23], v[10:11], v[110:111] op_sel:[0,1,0] op_sel_hi:[1,1,1]
    v_pk_fma_f32 v[112:113], v[24:25], v[8:9], v[112:113] op_sel_hi:[1,0,1]
    v_pk_fma_f32 v[114:115], v[26:27], v[8:9], v[114:115] op_sel_hi:[1,0,1]
    v_pk_fma_f32 v[116:117], v[28:29], v[8:9], v[116:117] op_sel_hi:[1,0,1]
    v_pk_fma_f32 v[118:119], v[30:31], v[8:9], v[118:119] op_sel_hi:[1,0,1]
    v_pk_fma_f32 v[120:121], v[24:25], v[8:9], v[120:121] op_sel:[0,1,0] op_sel_hi:[1,1,1]
    v_pk_fma_f32 v[122:123], v[26:27], v[8:9], v[122:123] op_sel:[0,1,0] op_sel_hi:[1,1,1]
    v_pk_fma_f32 v[124:125], v[28:29], v[8:9], v[124:125] op_sel:[0,1,0] op_sel_hi:[1,1,1]
    v_pk_fma_f32 v[126:127], v[30:31], v[8:9], v[126:127] op_sel:[0,1,0] op_sel_hi:[1,1,1]
    v_pk_fma_f32 v[128:129], v[24:25], v[10:11], v[128:129] op_sel_hi:[1,0,1]
    v_pk_fma_f32 v[130:131], v[26:27], v[10:11], v[130:131] op_sel_hi:[1,0,1]
    v_pk_fma_f32 v[132:133], v[28:29], v[10:11], v[132:133] op_sel_hi:[1,0,1]
    v_pk_fma_f32 v[134:135], v[30:31], v[10:11], v[134:135] op_sel_hi:[1,0,1]
    v_pk_fma_f32 v[136:137], v[24:25], v[10:11], v[136:137] op_sel:[0,1,0] op_sel_hi:[1,1,1]
    v_pk_fma_f32 v[138:139], v[26:27], v[10:11], v[138:139] op_sel:[0,1,0] op_sel_hi:[1,1,1]
    v_pk_fma_f32 v[140:141], v[28:29], v[10:11], v[140:141] op_sel:[0,1,0] op_sel_hi:[1,1,1]
    v_pk_fma_f32 v[142:143], v[30:31], v[10:11], v[142:143] op_sel:[0,1,0] op_sel_hi:[1,1,1]
    ds_read_b128 v[8:11], v7 offset:21504
    s_waitcnt vmcnt(4) lgkmcnt(1)
    v_lshlrev_b32 v16, 16, v56
    v_and_b32 v17, s60, v56
    v_lshlrev_b32 v18, 16, v57
    v_and_b32 v19, s60, v57
    v_lshlrev_b32 v20, 16, v58
    v_and_b32 v21, s60, v58
    v_lshlrev_b32 v22, 16, v59
    v_and_b32 v23, s60, v59
    v_lshlrev_b32 v24, 16, v60
    v_and_b32 v25, s60, v60
    v_lshlrev_b32 v26, 16, v61
    v_and_b32 v27, s60, v61
    v_lshlrev_b32 v28, 16, v62
    v_and_b32 v29, s60, v62
    v_lshlrev_b32 v30, 16, v63
    v_and_b32 v31, s60, v63
    v_pk_fma_f32 v[80:81], v[16:17], v[12:13], v[80:81] op_sel_hi:[1,0,1]
    v_pk_fma_f32 v[82:83], v[18:19], v[12:13], v[82:83] op_sel_hi:[1,0,1]
    v_pk_fma_f32 v[84:85], v[20:21], v[12:13], v[84:85] op_sel_hi:[1,0,1]
    v_pk_fma_f32 v[86:87], v[22:23], v[12:13], v[86:87] op_sel_hi:[1,0,1]
    v_pk_fma_f32 v[88:89], v[16:17], v[12:13], v[88:89] op_sel:[0,1,0] op_sel_hi:[1,1,1]
    v_pk_fma_f32 v[90:91], v[18:19], v[12:13], v[90:91] op_sel:[0,1,0] op_sel_hi:[1,1,1]
    v_pk_fma_f32 v[92:93], v[20:21], v[12:13], v[92:93] op_sel:[0,1,0] op_sel_hi:[1,1,1]
    v_pk_fma_f32 v[94:95], v[22:23], v[12:13], v[94:95] op_sel:[0,1,0] op_sel_hi:[1,1,1]
    v_pk_fma_f32 v[96:97], v[16:17], v[14:15], v[96:97] op_sel_hi:[1,0,1]
    v_pk_fma_f32 v[98:99], v[18:19], v[14:15], v[98:99] op_sel_hi:[1,0,1]
    v_pk_fma_f32 v[100:101], v[20:21], v[14:15], v[100:101] op_sel_hi:[1,0,1]
    v_pk_fma_f32 v[102:103], v[22:23], v[14:15], v[102:103] op_sel_hi:[1,0,1]
    v_pk_fma_f32 v[104:105], v[16:17], v[14:15], v[104:105] op_sel:[0,1,0] op_sel_hi:[1,1,1]
    v_pk_fma_f32 v[106:107], v[18:19], v[14:15], v[106:107] op_sel:[0,1,0] op_sel_hi:[1,1,1]
    v_pk_fma_f32 v[108:109], v[20:21], v[14:15], v[108:109] op_sel:[0,1,0] op_sel_hi:[1,1,1]
    v_pk_fma_f32 v[110:111], v[22:23], v[14:15], v[110:111] op_sel:[0,1,0] op_sel_hi:[1,1,1]
    v_pk_fma_f32 v[112:113], v[24:25], v[12:13], v[112:113] op_sel_hi:[1,0,1]
    v_pk_fma_f32 v[114:115], v[26:27], v[12:13], v[114:115] op_sel_hi:[1,0,1]
    v_pk_fma_f32 v[116:117], v[28:29], v[12:13], v[116:117] op_sel_hi:[1,0,1]
    v_pk_fma_f32 v[118:119], v[30:31], v[12:13], v[118:119] op_sel_hi:[1,0,1]
    v_pk_fma_f32 v[120:121], v[24:25], v[12:13], v[120:121] op_sel:[0,1,0] op_sel_hi:[1,1,1]
    v_pk_fma_f32 v[122:123], v[26:27], v[12:13], v[122:123] op_sel:[0,1,0] op_sel_hi:[1,1,1]
    v_pk_fma_f32 v[124:125], v[28:29], v[12:13], v[124:125] op_sel:[0,1,0] op_sel_hi:[1,1,1]
    v_pk_fma_f32 v[126:127], v[30:31], v[12:13], v[126:127] op_sel:[0,1,0] op_sel_hi:[1,1,1]
    v_pk_fma_f32 v[128:129], v[24:25], v[14:15], v[128:129] op_sel_hi:[1,0,1]
    v_pk_fma_f32 v[130:131], v[26:27], v[14:15], v[130:131] op_sel_hi:[1,0,1]
    v_pk_fma_f32 v[132:133], v[28:29], v[14:15], v[132:133] op_sel_hi:[1,0,1]
    v_pk_fma_f32 v[134:135], v[30:31], v[14:15], v[134:135] op_sel_hi:[1,0,1]
    v_pk_fma_f32 v[136:137], v[24:25], v[14:15], v[136:137] op_sel:[0,1,0] op_sel_hi:[1,1,1]
    v_pk_fma_f32 v[138:139], v[26:27], v[14:15], v[138:139] op_sel:[0,1,0] op_sel_hi:[1,1,1]
    v_pk_fma_f32 v[140:141], v[28:29], v[14:15], v[140:141] op_sel:[0,1,0] op_sel_hi:[1,1,1]
    v_pk_fma_f32 v[142:143], v[30:31], v[14:15], v[142:143] op_sel:[0,1,0] op_sel_hi:[1,1,1]
    s_cmp_eq_u32 s18, 0
    s_cbranch_scc1 L_nb21
    s_sub_u32 s18, s18, 1
    s_barrier
L_nb21:
    s_mov_b32 s57, 968704
    buffer_load_dwordx4 v[48:51], v3, s[32:35], s57 offen
    buffer_load_dwordx4 v[52:55], v3, s[36:39], s57 offen
    s_mov_b32 s57, 1012736
    buffer_load_dwordx4 v[56:59], v3, s[32:35], s57 offen
    buffer_load_dwordx4 v[60:63], v3, s[36:39], s57 offen
    ds_read_b128 v[12:15], v7 offset:21760
    s_waitcnt vmcnt(6) lgkmcnt(1)
    v_lshlrev_b32 v16, 16, v32
    v_and_b32 v17, s60, v32
    v_lshlrev_b32 v18, 16, v33
    v_and_b32 v19, s60, v33
    v_lshlrev_b32 v20, 16, v34
    v_and_b32 v21, s60, v34
    v_lshlrev_b32 v22, 16, v35
    v_and_b32 v23, s60, v35
    v_lshlrev_b32 v24, 16, v36
    v_and_b32 v25, s60, v36
    v_lshlrev_b32 v26, 16, v37
    v_and_b32 v27, s60, v37
    v_lshlrev_b32 v28, 16, v38
    v_and_b32 v29, s60, v38
    v_lshlrev_b32 v30, 16, v39
    v_and_b32 v31, s60, v39
    v_pk_fma_f32 v[80:81], v[16:17], v[8:9], v[80:81] op_sel_hi:[1,0,1]
    v_pk_fma_f32 v[82:83], v[18:19], v[8:9], v[82:83] op_sel_hi:[1,0,1]
    v_pk_fma_f32 v[84:85], v[20:21], v[8:9], v[84:85] op_sel_hi:[1,0,1]
    v_pk_fma_f32 v[86:87], v[22:23], v[8:9], v[86:87] op_sel_hi:[1,0,1]
    v_pk_fma_f32 v[88:89], v[16:17], v[8:9], v[88:89] op_sel:[0,1,0] op_sel_hi:[1,1,1]
    v_pk_fma_f32 v[90:91], v[18:19], v[8:9], v[90:91] op_sel:[0,1,0] op_sel_hi:[1,1,1]
    v_pk_fma_f32 v[92:93], v[20:21], v[8:9], v[92:93] op_sel:[0,1,0] op_sel_hi:[1,1,1]
    v_pk_fma_f32 v[94:95], v[22:23], v[8:9], v[94:95] op_sel:[0,1,0] op_sel_hi:[1,1,1]
    v_pk_fma_f32 v[96:97], v[16:17], v[10:11], v[96:97] op_sel_hi:[1,0,1]
    v_pk_fma_f32 v[98:99], v[18:19], v[10:11], v[98:99] op_sel_hi:[1,0,1]
    v_pk_fma_f32 v[100:101], v[20:21], v[10:11], v[100:101] op_sel_hi:[1,0,1]
    v_pk_fma_f32 v[102:103], v[22:23], v[10:11], v[102:103] op_sel_hi:[1,0,1]
    v_pk_fma_f32 v[104:105], v[16:17], v[10:11], v[104:105] op_sel:[0,1,0] op_sel_hi:[1,1,1]
    v_pk_fma_f32 v[106:107], v[18:19], v[10:11], v[106:107] op_sel:[0,1,0] op_sel_hi:[1,1,1]
    v_pk_fma_f32 v[108:109], v[20:21], v[10:11], v[108:109] op_sel:[0,1,0] op_sel_hi:[1,1,1]
    v_pk_fma_f32 v[110:111], v[22:23], v[10:11], v[110:111] op_sel:[0,1,0] op_sel_hi:[1,1,1]
    v_pk_fma_f32 v[112:113], v[24:25], v[8:9], v[112:113] op_sel_hi:[1,0,1]
    v_pk_fma_f32 v[114:115], v[26:27], v[8:9], v[114:115] op_sel_hi:[1,0,1]
    v_pk_fma_f32 v[116:117], v[28:29], v[8:9], v[116:117] op_sel_hi:[1,0,1]
    v_pk_fma_f32 v[118:119], v[30:31], v[8:9], v[118:119] op_sel_hi:[1,0,1]
    v_pk_fma_f32 v[120:121], v[24:25], v[8:9], v[120:121] op_sel:[0,1,0] op_sel_hi:[1,1,1]
    v_pk_fma_f32 v[122:123], v[26:27], v[8:9], v[122:123] op_sel:[0,1,0] op_sel_hi:[1,1,1]
    v_pk_fma_f32 v[124:125], v[28:29], v[8:9], v[124:125] op_sel:[0,1,0] op_sel_hi:[1,1,1]
    v_pk_fma_f32 v[126:127], v[30:31], v[8:9], v[126:127] op_sel:[0,1,0] op_sel_hi:[1,1,1]
    v_pk_fma_f32 v[128:129], v[24:25], v[10:11], v[128:129] op_sel_hi:[1,0,1]
    v_pk_fma_f32 v[130:131], v[26:27], v[10:11], v[130:131] op_sel_hi:[1,0,1]
    v_pk_fma_f32 v[132:133], v[28:29], v[10:11], v[132:133] op_sel_hi:[1,0,1]
    v_pk_fma_f32 v[134:135], v[30:31], v[10:11], v[134:135] op_sel_hi:[1,0,1]
    v_pk_fma_f32 v[136:137], v[24:25], v[10:11], v[136:137] op_sel:[0,1,0] op_sel_hi:[1,1,1]
    v_pk_fma_f32 v[138:139], v[26:27], v[10:11], v[138:139] op_sel:[0,1,0] op_sel_hi:[1,1,1]
    v_pk_fma_f32 v[140:141], v[28:29], v[10:11], v[140:141] op_sel:[0,1,0] op_sel_hi:[1,1,1]
    v_pk_fma_f32 v[142:143], v[30:31], v[10:11], v[142:143] op_sel:[0,1,0] op_sel_hi:[1,1,1]
    ds_read_b128 v[8:11], v7 offset:22016
    s_waitcnt vmcnt(4) lgkmcnt(1)
    v_lshlrev_b32 v16, 16, v40
    v_and_b32 v17, s60, v40
    v_lshlrev_b32 v18, 16, v41
    v_and_b32 v19, s60, v41
    v_lshlrev_b32 v20, 16, v42
    v_and_b32 v21, s60, v42
    v_lshlrev_b32 v22, 16, v43
    v_and_b32 v23, s60, v43
    v_lshlrev_b32 v24, 16, v44
    v_and_b32 v25, s60, v44
    v_lshlrev_b32 v26, 16, v45
    v_and_b32 v27, s60, v45
    v_lshlrev_b32 v28, 16, v46
    v_and_b32 v29, s60, v46
    v_lshlrev_b32 v30, 16, v47
    v_and_b32 v31, s60, v47
    v_pk_fma_f32 v[80:81], v[16:17], v[12:13], v[80:81] op_sel_hi:[1,0,1]
    v_pk_fma_f32 v[82:83], v[18:19], v[12:13], v[82:83] op_sel_hi:[1,0,1]
    v_pk_fma_f32 v[84:85], v[20:21], v[12:13], v[84:85] op_sel_hi:[1,0,1]
    v_pk_fma_f32 v[86:87], v[22:23], v[12:13], v[86:87] op_sel_hi:[1,0,1]
    v_pk_fma_f32 v[88:89], v[16:17], v[12:13], v[88:89] op_sel:[0,1,0] op_sel_hi:[1,1,1]
    v_pk_fma_f32 v[90:91], v[18:19], v[12:13], v[90:91] op_sel:[0,1,0] op_sel_hi:[1,1,1]
    v_pk_fma_f32 v[92:93], v[20:21], v[12:13], v[92:93] op_sel:[0,1,0] op_sel_hi:[1,1,1]
    v_pk_fma_f32 v[94:95], v[22:23], v[12:13], v[94:95] op_sel:[0,1,0] op_sel_hi:[1,1,1]
    v_pk_fma_f32 v[96:97], v[16:17], v[14:15], v[96:97] op_sel_hi:[1,0,1]
    v_pk_fma_f32 v[98:99], v[18:19], v[14:15], v[98:99] op_sel_hi:[1,0,1]
    v_pk_fma_f32 v[100:101], v[20:21], v[14:15], v[100:101] op_sel_hi:[1,0,1]
    v_pk_fma_f32 v[102:103], v[22:23], v[14:15], v[102:103] op_sel_hi:[1,0,1]
    v_pk_fma_f32 v[104:105], v[16:17], v[14:15], v[104:105] op_sel:[0,1,0] op_sel_hi:[1,1,1]
    v_pk_fma_f32 v[106:107], v[18:19], v[14:15], v[106:107] op_sel:[0,1,0] op_sel_hi:[1,1,1]
    v_pk_fma_f32 v[108:109], v[20:21], v[14:15], v[108:109] op_sel:[0,1,0] op_sel_hi:[1,1,1]
    v_pk_fma_f32 v[110:111], v[22:23], v[14:15], v[110:111] op_sel:[0,1,0] op_sel_hi:[1,1,1]
    v_pk_fma_f32 v[112:113], v[24:25], v[12:13], v[112:113] op_sel_hi:[1,0,1]
    v_pk_fma_f32 v[114:115], v[26:27], v[12:13], v[114:115] op_sel_hi:[1,0,1]
    v_pk_fma_f32 v[116:117], v[28:29], v[12:13], v[116:117] op_sel_hi:[1,0,1]
    v_pk_fma_f32 v[118:119], v[30:31], v[12:13], v[118:119] op_sel_hi:[1,0,1]
    v_pk_fma_f32 v[120:121], v[24:25], v[12:13], v[120:121] op_sel:[0,1,0] op_sel_hi:[1,1,1]
    v_pk_fma_f32 v[122:123], v[26:27], v[12:13], v[122:123] op_sel:[0,1,0] op_sel_hi:[1,1,1]
    v_pk_fma_f32 v[124:125], v[28:29], v[12:13], v[124:125] op_sel:[0,1,0] op_sel_hi:[1,1,1]
    v_pk_fma_f32 v[126:127], v[30:31], v[12:13], v[126:127] op_sel:[0,1,0] op_sel_hi:[1,1,1]
    v_pk_fma_f32 v[128:129], v[24:25], v[14:15], v[128:129] op_sel_hi:[1,0,1]
    v_pk_fma_f32 v[130:131], v[26:27], v[14:15], v[130:131] op_sel_hi:[1,0,1]
    v_pk_fma_f32 v[132:133], v[28:29], v[14:15], v[132:133] op_sel_hi:[1,0,1]
    v_pk_fma_f32 v[134:135], v[30:31], v[14:15], v[134:135] op_sel_hi:[1,0,1]
    v_pk_fma_f32 v[136:137], v[24:25], v[14:15], v[136:137] op_sel:[0,1,0] op_sel_hi:[1,1,1]
    v_pk_fma_f32 v[138:139], v[26:27], v[14:15], v[138:139] op_sel:[0,1,0] op_sel_hi:[1,1,1]
    v_pk_fma_f32 v[140:141], v[28:29], v[14:15], v[140:141] op_sel:[0,1,0] op_sel_hi:[1,1,1]
    v_pk_fma_f32 v[142:143], v[30:31], v[14:15], v[142:143] op_sel:[0,1,0] op_sel_hi:[1,1,1]
    s_cmp_eq_u32 s18, 0
    s_cbranch_scc1 L_nb22
    s_sub_u32 s18, s18, 1
    s_barrier
L_nb22:
    s_mov_b32 s57, 1056768
    buffer_load_dwordx4 v[32:35], v3, s[32:35], s57 offen
    buffer_load_dwordx4 v[36:39], v3, s[36:39], s57 offen
    s_mov_b32 s57, 1100800
    buffer_load_dwordx4 v[40:43], v3, s[32:35], s57 offen
    buffer_load_dwordx4 v[44:47], v3, s[36:39], s57 offen
    ds_read_b128 v[12:15], v7 offset:22272
    s_waitcnt vmcnt(6) lgkmcnt(1)
    v_lshlrev_b32 v16, 16, v48
    v_and_b32 v17, s60, v48
    v_lshlrev_b32 v18, 16, v49
    v_and_b32 v19, s60, v49
    v_lshlrev_b32 v20, 16, v50
    v_and_b32 v21, s60, v50
    v_lshlrev_b32 v22, 16, v51
    v_and_b32 v23, s60, v51
    v_lshlrev_b32 v24, 16, v52
    v_and_b32 v25, s60, v52
    v_lshlrev_b32 v26, 16, v53
    v_and_b32 v27, s60, v53
    v_lshlrev_b32 v28, 16, v54
    v_and_b32 v29, s60, v54
    v_lshlrev_b32 v30, 16, v55
    v_and_b32 v31, s60, v55
    v_pk_fma_f32 v[80:81], v[16:17], v[8:9], v[80:81] op_sel_hi:[1,0,1]
    v_pk_fma_f32 v[82:83], v[18:19], v[8:9], v[82:83] op_sel_hi:[1,0,1]
    v_pk_fma_f32 v[84:85], v[20:21], v[8:9], v[84:85] op_sel_hi:[1,0,1]
    v_pk_fma_f32 v[86:87], v[22:23], v[8:9], v[86:87] op_sel_hi:[1,0,1]
    v_pk_fma_f32 v[88:89], v[16:17], v[8:9], v[88:89] op_sel:[0,1,0] op_sel_hi:[1,1,1]
    v_pk_fma_f32 v[90:91], v[18:19], v[8:9], v[90:91] op_sel:[0,1,0] op_sel_hi:[1,1,1]
    v_pk_fma_f32 v[92:93], v[20:21], v[8:9], v[92:93] op_sel:[0,1,0] op_sel_hi:[1,1,1]
    v_pk_fma_f32 v[94:95], v[22:23], v[8:9], v[94:95] op_sel:[0,1,0] op_sel_hi:[1,1,1]
    v_pk_fma_f32 v[96:97], v[16:17], v[10:11], v[96:97] op_sel_hi:[1,0,1]
    v_pk_fma_f32 v[98:99], v[18:19], v[10:11], v[98:99] op_sel_hi:[1,0,1]
    v_pk_fma_f32 v[100:101], v[20:21], v[10:11], v[100:101] op_sel_hi:[1,0,1]
    v_pk_fma_f32 v[102:103], v[22:23], v[10:11], v[102:103] op_sel_hi:[1,0,1]
    v_pk_fma_f32 v[104:105], v[16:17], v[10:11], v[104:105] op_sel:[0,1,0] op_sel_hi:[1,1,1]
    v_pk_fma_f32 v[106:107], v[18:19], v[10:11], v[106:107] op_sel:[0,1,0] op_sel_hi:[1,1,1]
    v_pk_fma_f32 v[108:109], v[20:21], v[10:11], v[108:109] op_sel:[0,1,0] op_sel_hi:[1,1,1]
    v_pk_fma_f32 v[110:111], v[22:23], v[10:11], v[110:111] op_sel:[0,1,0] op_sel_hi:[1,1,1]
    v_pk_fma_f32 v[112:113], v[24:25], v[8:9], v[112:113] op_sel_hi:[1,0,1]
    v_pk_fma_f32 v[114:115], v[26:27], v[8:9], v[114:115] op_sel_hi:[1,0,1]
    v_pk_fma_f32 v[116:117], v[28:29], v[8:9], v[116:117] op_sel_hi:[1,0,1]
    v_pk_fma_f32 v[118:119], v[30:31], v[8:9], v[118:119] op_sel_hi:[1,0,1]
    v_pk_fma_f32 v[120:121], v[24:25], v[8:9], v[120:121] op_sel:[0,1,0] op_sel_hi:[1,1,1]
    v_pk_fma_f32 v[122:123], v[26:27], v[8:9], v[122:123] op_sel:[0,1,0] op_sel_hi:[1,1,1]
    v_pk_fma_f32 v[124:125], v[28:29], v[8:9], v[124:125] op_sel:[0,1,0] op_sel_hi:[1,1,1]
    v_pk_fma_f32 v[126:127], v[30:31], v[8:9], v[126:127] op_sel:[0,1,0] op_sel_hi:[1,1,1]
    v_pk_fma_f32 v[128:129], v[24:25], v[10:11], v[128:129] op_sel_hi:[1,0,1]
    v_pk_fma_f32 v[130:131], v[26:27], v[10:11], v[130:131] op_sel_hi:[1,0,1]
    v_pk_fma_f32 v[132:133], v[28:29], v[10:11], v[132:133] op_sel_hi:[1,0,1]
    v_pk_fma_f32 v[134:135], v[30:31], v[10:11], v[134:135] op_sel_hi:[1,0,1]
    v_pk_fma_f32 v[136:137], v[24:25], v[10:11], v[136:137] op_sel:[0,1,0] op_sel_hi:[1,1,1]
    v_pk_fma_f32 v[138:139], v[26:27], v[10:11], v[138:139] op_sel:[0,1,0] op_sel_hi:[1,1,1]
    v_pk_fma_f32 v[140:141], v[28:29], v[10:11], v[140:141] op_sel:[0,1,0] op_sel_hi:[1,1,1]
    v_pk_fma_f32 v[142:143], v[30:31], v[10:11], v[142:143] op_sel:[0,1,0] op_sel_hi:[1,1,1]
    ds_read_b128 v[8:11], v7 offset:22528
    s_waitcnt vmcnt(4) lgkmcnt(1)
    v_lshlrev_b32 v16, 16, v56
    v_and_b32 v17, s60, v56
    v_lshlrev_b32 v18, 16, v57
    v_and_b32 v19, s60, v57
    v_lshlrev_b32 v20, 16, v58
    v_and_b32 v21, s60, v58
    v_lshlrev_b32 v22, 16, v59
    v_and_b32 v23, s60, v59
    v_lshlrev_b32 v24, 16, v60
    v_and_b32 v25, s60, v60
    v_lshlrev_b32 v26, 16, v61
    v_and_b32 v27, s60, v61
    v_lshlrev_b32 v28, 16, v62
    v_and_b32 v29, s60, v62
    v_lshlrev_b32 v30, 16, v63
    v_and_b32 v31, s60, v63
    v_pk_fma_f32 v[80:81], v[16:17], v[12:13], v[80:81] op_sel_hi:[1,0,1]
    v_pk_fma_f32 v[82:83], v[18:19], v[12:13], v[82:83] op_sel_hi:[1,0,1]
    v_pk_fma_f32 v[84:85], v[20:21], v[12:13], v[84:85] op_sel_hi:[1,0,1]
    v_pk_fma_f32 v[86:87], v[22:23], v[12:13], v[86:87] op_sel_hi:[1,0,1]
    v_pk_fma_f32 v[88:89], v[16:17], v[12:13], v[88:89] op_sel:[0,1,0] op_sel_hi:[1,1,1]
    v_pk_fma_f32 v[90:91], v[18:19], v[12:13], v[90:91] op_sel:[0,1,0] op_sel_hi:[1,1,1]
    v_pk_fma_f32 v[92:93], v[20:21], v[12:13], v[92:93] op_sel:[0,1,0] op_sel_hi:[1,1,1]
    v_pk_fma_f32 v[94:95], v[22:23], v[12:13], v[94:95] op_sel:[0,1,0] op_sel_hi:[1,1,1]
    v_pk_fma_f32 v[96:97], v[16:17], v[14:15], v[96:97] op_sel_hi:[1,0,1]
    v_pk_fma_f32 v[98:99], v[18:19], v[14:15], v[98:99] op_sel_hi:[1,0,1]
    v_pk_fma_f32 v[100:101], v[20:21], v[14:15], v[100:101] op_sel_hi:[1,0,1]
    v_pk_fma_f32 v[102:103], v[22:23], v[14:15], v[102:103] op_sel_hi:[1,0,1]
    v_pk_fma_f32 v[104:105], v[16:17], v[14:15], v[104:105] op_sel:[0,1,0] op_sel_hi:[1,1,1]
    v_pk_fma_f32 v[106:107], v[18:19], v[14:15], v[106:107] op_sel:[0,1,0] op_sel_hi:[1,1,1]
    v_pk_fma_f32 v[108:109], v[20:21], v[14:15], v[108:109] op_sel:[0,1,0] op_sel_hi:[1,1,1]
    v_pk_fma_f32 v[110:111], v[22:23], v[14:15], v[110:111] op_sel:[0,1,0] op_sel_hi:[1,1,1]
    v_pk_fma_f32 v[112:113], v[24:25], v[12:13], v[112:113] op_sel_hi:[1,0,1]
    v_pk_fma_f32 v[114:115], v[26:27], v[12:13], v[114:115] op_sel_hi:[1,0,1]
    v_pk_fma_f32 v[116:117], v[28:29], v[12:13], v[116:117] op_sel_hi:[1,0,1]
    v_pk_fma_f32 v[118:119], v[30:31], v[12:13], v[118:119] op_sel_hi:[1,0,1]
    v_pk_fma_f32 v[120:121], v[24:25], v[12:13], v[120:121] op_sel:[0,1,0] op_sel_hi:[1,1,1]
    v_pk_fma_f32 v[122:123], v[26:27], v[12:13], v[122:123] op_sel:[0,1,0] op_sel_hi:[1,1,1]
    v_pk_fma_f32 v[124:125], v[28:29], v[12:13], v[124:125] op_sel:[0,1,0] op_sel_hi:[1,1,1]
    v_pk_fma_f32 v[126:127], v[30:31], v[12:13], v[126:127] op_sel:[0,1,0] op_sel_hi:[1,1,1]
    v_pk_fma_f32 v[128:129], v[24:25], v[14:15], v[128:129] op_sel_hi:[1,0,1]
    v_pk_fma_f32 v[130:131], v[26:27], v[14:15], v[130:131] op_sel_hi:[1,0,1]
    v_pk_fma_f32 v[132:133], v[28:29], v[14:15], v[132:133] op_sel_hi:[1,0,1]
    v_pk_fma_f32 v[134:135], v[30:31], v[14:15], v[134:135] op_sel_hi:[1,0,1]
    v_pk_fma_f32 v[136:137], v[24:25], v[14:15], v[136:137] op_sel:[0,1,0] op_sel_hi:[1,1,1]
    v_pk_fma_f32 v[138:139], v[26:27], v[14:15], v[138:139] op_sel:[0,1,0] op_sel_hi:[1,1,1]
    v_pk_fma_f32 v[140:141], v[28:29], v[14:15], v[140:141] op_sel:[0,1,0] op_sel_hi:[1,1,1]
    v_pk_fma_f32 v[142:143], v[30:31], v[14:15], v[142:143] op_sel:[0,1,0] op_sel_hi:[1,1,1]
    s_cmp_eq_u32 s18, 0
    s_cbranch_scc1 L_nb23
    s_sub_u32 s18, s18, 1
    s_barrier
L_nb23:
    s_mov_b32 s57, 1144832
    buffer_load_dwordx4 v[48:51], v3, s[32:35], s57 offen
    buffer_load_dwordx4 v[52:55], v3, s[36:39], s57 offen
    s_mov_b32 s57, 1188864
    buffer_load_dwordx4 v[56:59], v3, s[32:35], s57 offen
    buffer_load_dwordx4 v[60:63], v3, s[36:39], s57 offen
    ds_read_b128 v[12:15], v7 offset:22784
    s_waitcnt vmcnt(6) lgkmcnt(1)
    v_lshlrev_b32 v16, 16, v32
    v_and_b32 v17, s60, v32
    v_lshlrev_b32 v18, 16, v33
    v_and_b32 v19, s60, v33
    v_lshlrev_b32 v20, 16, v34
    v_and_b32 v21, s60, v34
    v_lshlrev_b32 v22, 16, v35
    v_and_b32 v23, s60, v35
    v_lshlrev_b32 v24, 16, v36
    v_and_b32 v25, s60, v36
    v_lshlrev_b32 v26, 16, v37
    v_and_b32 v27, s60, v37
    v_lshlrev_b32 v28, 16, v38
    v_and_b32 v29, s60, v38
    v_lshlrev_b32 v30, 16, v39
    v_and_b32 v31, s60, v39
    v_pk_fma_f32 v[80:81], v[16:17], v[8:9], v[80:81] op_sel_hi:[1,0,1]
    v_pk_fma_f32 v[82:83], v[18:19], v[8:9], v[82:83] op_sel_hi:[1,0,1]
    v_pk_fma_f32 v[84:85], v[20:21], v[8:9], v[84:85] op_sel_hi:[1,0,1]
    v_pk_fma_f32 v[86:87], v[22:23], v[8:9], v[86:87] op_sel_hi:[1,0,1]
    v_pk_fma_f32 v[88:89], v[16:17], v[8:9], v[88:89] op_sel:[0,1,0] op_sel_hi:[1,1,1]
    v_pk_fma_f32 v[90:91], v[18:19], v[8:9], v[90:91] op_sel:[0,1,0] op_sel_hi:[1,1,1]
    v_pk_fma_f32 v[92:93], v[20:21], v[8:9], v[92:93] op_sel:[0,1,0] op_sel_hi:[1,1,1]
    v_pk_fma_f32 v[94:95], v[22:23], v[8:9], v[94:95] op_sel:[0,1,0] op_sel_hi:[1,1,1]
    v_pk_fma_f32 v[96:97], v[16:17], v[10:11], v[96:97] op_sel_hi:[1,0,1]
    v_pk_fma_f32 v[98:99], v[18:19], v[10:11], v[98:99] op_sel_hi:[1,0,1]
    v_pk_fma_f32 v[100:101], v[20:21], v[10:11], v[100:101] op_sel_hi:[1,0,1]
    v_pk_fma_f32 v[102:103], v[22:23], v[10:11], v[102:103] op_sel_hi:[1,0,1]
    v_pk_fma_f32 v[104:105], v[16:17], v[10:11], v[104:105] op_sel:[0,1,0] op_sel_hi:[1,1,1]
    v_pk_fma_f32 v[106:107], v[18:19], v[10:11], v[106:107] op_sel:[0,1,0] op_sel_hi:[1,1,1]
    v_pk_fma_f32 v[108:109], v[20:21], v[10:11], v[108:109] op_sel:[0,1,0] op_sel_hi:[1,1,1]
    v_pk_fma_f32 v[110:111], v[22:23], v[10:11], v[110:111] op_sel:[0,1,0] op_sel_hi:[1,1,1]
    v_pk_fma_f32 v[112:113], v[24:25], v[8:9], v[112:113] op_sel_hi:[1,0,1]
    v_pk_fma_f32 v[114:115], v[26:27], v[8:9], v[114:115] op_sel_hi:[1,0,1]
    v_pk_fma_f32 v[116:117], v[28:29], v[8:9], v[116:117] op_sel_hi:[1,0,1]
    v_pk_fma_f32 v[118:119], v[30:31], v[8:9], v[118:119] op_sel_hi:[1,0,1]
    v_pk_fma_f32 v[120:121], v[24:25], v[8:9], v[120:121] op_sel:[0,1,0] op_sel_hi:[1,1,1]
    v_pk_fma_f32 v[122:123], v[26:27], v[8:9], v[122:123] op_sel:[0,1,0] op_sel_hi:[1,1,1]
    v_pk_fma_f32 v[124:125], v[28:29], v[8:9], v[124:125] op_sel:[0,1,0] op_sel_hi:[1,1,1]
    v_pk_fma_f32 v[126:127], v[30:31], v[8:9], v[126:127] op_sel:[0,1,0] op_sel_hi:[1,1,1]
    v_pk_fma_f32 v[128:129], v[24:25], v[10:11], v[128:129] op_sel_hi:[1,0,1]
    v_pk_fma_f32 v[130:131], v[26:27], v[10:11], v[130:131] op_sel_hi:[1,0,1]
    v_pk_fma_f32 v[132:133], v[28:29], v[10:11], v[132:133] op_sel_hi:[1,0,1]
    v_pk_fma_f32 v[134:135], v[30:31], v[10:11], v[134:135] op_sel_hi:[1,0,1]
    v_pk_fma_f32 v[136:137], v[24:25], v[10:11], v[136:137] op_sel:[0,1,0] op_sel_hi:[1,1,1]
    v_pk_fma_f32 v[138:139], v[26:27], v[10:11], v[138:139] op_sel:[0,1,0] op_sel_hi:[1,1,1]
    v_pk_fma_f32 v[140:141], v[28:29], v[10:11], v[140:141] op_sel:[0,1,0] op_sel_hi:[1,1,1]
    v_pk_fma_f32 v[142:143], v[30:31], v[10:11], v[142:143] op_sel:[0,1,0] op_sel_hi:[1,1,1]
    ds_read_b128 v[8:11], v7 offset:23040
    s_waitcnt vmcnt(4) lgkmcnt(1)
    v_lshlrev_b32 v16, 16, v40
    v_and_b32 v17, s60, v40
    v_lshlrev_b32 v18, 16, v41
    v_and_b32 v19, s60, v41
    v_lshlrev_b32 v20, 16, v42
    v_and_b32 v21, s60, v42
    v_lshlrev_b32 v22, 16, v43
    v_and_b32 v23, s60, v43
    v_lshlrev_b32 v24, 16, v44
    v_and_b32 v25, s60, v44
    v_lshlrev_b32 v26, 16, v45
    v_and_b32 v27, s60, v45
    v_lshlrev_b32 v28, 16, v46
    v_and_b32 v29, s60, v46
    v_lshlrev_b32 v30, 16, v47
    v_and_b32 v31, s60, v47
    v_pk_fma_f32 v[80:81], v[16:17], v[12:13], v[80:81] op_sel_hi:[1,0,1]
    v_pk_fma_f32 v[82:83], v[18:19], v[12:13], v[82:83] op_sel_hi:[1,0,1]
    v_pk_fma_f32 v[84:85], v[20:21], v[12:13], v[84:85] op_sel_hi:[1,0,1]
    v_pk_fma_f32 v[86:87], v[22:23], v[12:13], v[86:87] op_sel_hi:[1,0,1]
    v_pk_fma_f32 v[88:89], v[16:17], v[12:13], v[88:89] op_sel:[0,1,0] op_sel_hi:[1,1,1]
    v_pk_fma_f32 v[90:91], v[18:19], v[12:13], v[90:91] op_sel:[0,1,0] op_sel_hi:[1,1,1]
    v_pk_fma_f32 v[92:93], v[20:21], v[12:13], v[92:93] op_sel:[0,1,0] op_sel_hi:[1,1,1]
    v_pk_fma_f32 v[94:95], v[22:23], v[12:13], v[94:95] op_sel:[0,1,0] op_sel_hi:[1,1,1]
    v_pk_fma_f32 v[96:97], v[16:17], v[14:15], v[96:97] op_sel_hi:[1,0,1]
    v_pk_fma_f32 v[98:99], v[18:19], v[14:15], v[98:99] op_sel_hi:[1,0,1]
    v_pk_fma_f32 v[100:101], v[20:21], v[14:15], v[100:101] op_sel_hi:[1,0,1]
    v_pk_fma_f32 v[102:103], v[22:23], v[14:15], v[102:103] op_sel_hi:[1,0,1]
    v_pk_fma_f32 v[104:105], v[16:17], v[14:15], v[104:105] op_sel:[0,1,0] op_sel_hi:[1,1,1]
    v_pk_fma_f32 v[106:107], v[18:19], v[14:15], v[106:107] op_sel:[0,1,0] op_sel_hi:[1,1,1]
    v_pk_fma_f32 v[108:109], v[20:21], v[14:15], v[108:109] op_sel:[0,1,0] op_sel_hi:[1,1,1]
    v_pk_fma_f32 v[110:111], v[22:23], v[14:15], v[110:111] op_sel:[0,1,0] op_sel_hi:[1,1,1]
    v_pk_fma_f32 v[112:113], v[24:25], v[12:13], v[112:113] op_sel_hi:[1,0,1]
    v_pk_fma_f32 v[114:115], v[26:27], v[12:13], v[114:115] op_sel_hi:[1,0,1]
    v_pk_fma_f32 v[116:117], v[28:29], v[12:13], v[116:117] op_sel_hi:[1,0,1]
    v_pk_fma_f32 v[118:119], v[30:31], v[12:13], v[118:119] op_sel_hi:[1,0,1]
    v_pk_fma_f32 v[120:121], v[24:25], v[12:13], v[120:121] op_sel:[0,1,0] op_sel_hi:[1,1,1]
    v_pk_fma_f32 v[122:123], v[26:27], v[12:13], v[122:123] op_sel:[0,1,0] op_sel_hi:[1,1,1]
    v_pk_fma_f32 v[124:125], v[28:29], v[12:13], v[124:125] op_sel:[0,1,0] op_sel_hi:[1,1,1]
    v_pk_fma_f32 v[126:127], v[30:31], v[12:13], v[126:127] op_sel:[0,1,0] op_sel_hi:[1,1,1]
    v_pk_fma_f32 v[128:129], v[24:25], v[14:15], v[128:129] op_sel_hi:[1,0,1]
    v_pk_fma_f32 v[130:131], v[26:27], v[14:15], v[130:131] op_sel_hi:[1,0,1]
    v_pk_fma_f32 v[132:133], v[28:29], v[14:15], v[132:133] op_sel_hi:[1,0,1]
    v_pk_fma_f32 v[134:135], v[30:31], v[14:15], v[134:135] op_sel_hi:[1,0,1]
    v_pk_fma_f32 v[136:137], v[24:25], v[14:15], v[136:137] op_sel:[0,1,0] op_sel_hi:[1,1,1]
    v_pk_fma_f32 v[138:139], v[26:27], v[14:15], v[138:139] op_sel:[0,1,0] op_sel_hi:[1,1,1]
    v_pk_fma_f32 v[140:141], v[28:29], v[14:15], v[140:141] op_sel:[0,1,0] op_sel_hi:[1,1,1]
    v_pk_fma_f32 v[142:143], v[30:31], v[14:15], v[142:143] op_sel:[0,1,0] op_sel_hi:[1,1,1]
    s_cmp_eq_u32 s18, 0
    s_cbranch_scc1 L_nb24
    s_sub_u32 s18, s18, 1
    s_barrier
L_nb24:
    s_mov_b32 s57, 1232896
    buffer_load_dwordx4 v[32:35], v3, s[32:35], s57 offen
    buffer_load_dwordx4 v[36:39], v3, s[36:39], s57 offen
    s_mov_b32 s57, 1276928
    buffer_load_dwordx4 v[40:43], v3, s[32:35], s57 offen
    buffer_load_dwordx4 v[44:47], v3, s[36:39], s57 offen
    ds_read_b128 v[12:15], v7 offset:23296
    s_waitcnt vmcnt(6) lgkmcnt(1)
    v_lshlrev_b32 v16, 16, v48
    v_and_b32 v17, s60, v48
    v_lshlrev_b32 v18, 16, v49
    v_and_b32 v19, s60, v49
    v_lshlrev_b32 v20, 16, v50
    v_and_b32 v21, s60, v50
    v_lshlrev_b32 v22, 16, v51
    v_and_b32 v23, s60, v51
    v_lshlrev_b32 v24, 16, v52
    v_and_b32 v25, s60, v52
    v_lshlrev_b32 v26, 16, v53
    v_and_b32 v27, s60, v53
    v_lshlrev_b32 v28, 16, v54
    v_and_b32 v29, s60, v54
    v_lshlrev_b32 v30, 16, v55
    v_and_b32 v31, s60, v55
    v_pk_fma_f32 v[80:81], v[16:17], v[8:9], v[80:81] op_sel_hi:[1,0,1]
    v_pk_fma_f32 v[82:83], v[18:19], v[8:9], v[82:83] op_sel_hi:[1,0,1]
    v_pk_fma_f32 v[84:85], v[20:21], v[8:9], v[84:85] op_sel_hi:[1,0,1]
    v_pk_fma_f32 v[86:87], v[22:23], v[8:9], v[86:87] op_sel_hi:[1,0,1]
    v_pk_fma_f32 v[88:89], v[16:17], v[8:9], v[88:89] op_sel:[0,1,0] op_sel_hi:[1,1,1]
    v_pk_fma_f32 v[90:91], v[18:19], v[8:9], v[90:91] op_sel:[0,1,0] op_sel_hi:[1,1,1]
    v_pk_fma_f32 v[92:93], v[20:21], v[8:9], v[92:93] op_sel:[0,1,0] op_sel_hi:[1,1,1]
    v_pk_fma_f32 v[94:95], v[22:23], v[8:9], v[94:95] op_sel:[0,1,0] op_sel_hi:[1,1,1]
    v_pk_fma_f32 v[96:97], v[16:17], v[10:11], v[96:97] op_sel_hi:[1,0,1]
    v_pk_fma_f32 v[98:99], v[18:19], v[10:11], v[98:99] op_sel_hi:[1,0,1]
    v_pk_fma_f32 v[100:101], v[20:21], v[10:11], v[100:101] op_sel_hi:[1,0,1]
    v_pk_fma_f32 v[102:103], v[22:23], v[10:11], v[102:103] op_sel_hi:[1,0,1]
    v_pk_fma_f32 v[104:105], v[16:17], v[10:11], v[104:105] op_sel:[0,1,0] op_sel_hi:[1,1,1]
    v_pk_fma_f32 v[106:107], v[18:19], v[10:11], v[106:107] op_sel:[0,1,0] op_sel_hi:[1,1,1]
    v_pk_fma_f32 v[108:109], v[20:21], v[10:11], v[108:109] op_sel:[0,1,0] op_sel_hi:[1,1,1]
    v_pk_fma_f32 v[110:111], v[22:23], v[10:11], v[110:111] op_sel:[0,1,0] op_sel_hi:[1,1,1]
    v_pk_fma_f32 v[112:113], v[24:25], v[8:9], v[112:113] op_sel_hi:[1,0,1]
    v_pk_fma_f32 v[114:115], v[26:27], v[8:9], v[114:115] op_sel_hi:[1,0,1]
    v_pk_fma_f32 v[116:117], v[28:29], v[8:9], v[116:117] op_sel_hi:[1,0,1]
    v_pk_fma_f32 v[118:119], v[30:31], v[8:9], v[118:119] op_sel_hi:[1,0,1]
    v_pk_fma_f32 v[120:121], v[24:25], v[8:9], v[120:121] op_sel:[0,1,0] op_sel_hi:[1,1,1]
    v_pk_fma_f32 v[122:123], v[26:27], v[8:9], v[122:123] op_sel:[0,1,0] op_sel_hi:[1,1,1]
    v_pk_fma_f32 v[124:125], v[28:29], v[8:9], v[124:125] op_sel:[0,1,0] op_sel_hi:[1,1,1]
    v_pk_fma_f32 v[126:127], v[30:31], v[8:9], v[126:127] op_sel:[0,1,0] op_sel_hi:[1,1,1]
    v_pk_fma_f32 v[128:129], v[24:25], v[10:11], v[128:129] op_sel_hi:[1,0,1]
    v_pk_fma_f32 v[130:131], v[26:27], v[10:11], v[130:131] op_sel_hi:[1,0,1]
    v_pk_fma_f32 v[132:133], v[28:29], v[10:11], v[132:133] op_sel_hi:[1,0,1]
    v_pk_fma_f32 v[134:135], v[30:31], v[10:11], v[134:135] op_sel_hi:[1,0,1]
    v_pk_fma_f32 v[136:137], v[24:25], v[10:11], v[136:137] op_sel:[0,1,0] op_sel_hi:[1,1,1]
    v_pk_fma_f32 v[138:139], v[26:27], v[10:11], v[138:139] op_sel:[0,1,0] op_sel_hi:[1,1,1]
    v_pk_fma_f32 v[140:141], v[28:29], v[10:11], v[140:141] op_sel:[0,1,0] op_sel_hi:[1,1,1]
    v_pk_fma_f32 v[142:143], v[30:31], v[10:11], v[142:143] op_sel:[0,1,0] op_sel_hi:[1,1,1]
    ds_read_b128 v[8:11], v7 offset:23552
    s_waitcnt vmcnt(4) lgkmcnt(1)
    v_lshlrev_b32 v16, 16, v56
    v_and_b32 v17, s60, v56
    v_lshlrev_b32 v18, 16, v57
    v_and_b32 v19, s60, v57
    v_lshlrev_b32 v20, 16, v58
    v_and_b32 v21, s60, v58
    v_lshlrev_b32 v22, 16, v59
    v_and_b32 v23, s60, v59
    v_lshlrev_b32 v24, 16, v60
    v_and_b32 v25, s60, v60
    v_lshlrev_b32 v26, 16, v61
    v_and_b32 v27, s60, v61
    v_lshlrev_b32 v28, 16, v62
    v_and_b32 v29, s60, v62
    v_lshlrev_b32 v30, 16, v63
    v_and_b32 v31, s60, v63
    v_pk_fma_f32 v[80:81], v[16:17], v[12:13], v[80:81] op_sel_hi:[1,0,1]
    v_pk_fma_f32 v[82:83], v[18:19], v[12:13], v[82:83] op_sel_hi:[1,0,1]
    v_pk_fma_f32 v[84:85], v[20:21], v[12:13], v[84:85] op_sel_hi:[1,0,1]
    v_pk_fma_f32 v[86:87], v[22:23], v[12:13], v[86:87] op_sel_hi:[1,0,1]
    v_pk_fma_f32 v[88:89], v[16:17], v[12:13], v[88:89] op_sel:[0,1,0] op_sel_hi:[1,1,1]
    v_pk_fma_f32 v[90:91], v[18:19], v[12:13], v[90:91] op_sel:[0,1,0] op_sel_hi:[1,1,1]
    v_pk_fma_f32 v[92:93], v[20:21], v[12:13], v[92:93] op_sel:[0,1,0] op_sel_hi:[1,1,1]
    v_pk_fma_f32 v[94:95], v[22:23], v[12:13], v[94:95] op_sel:[0,1,0] op_sel_hi:[1,1,1]
    v_pk_fma_f32 v[96:97], v[16:17], v[14:15], v[96:97] op_sel_hi:[1,0,1]
    v_pk_fma_f32 v[98:99], v[18:19], v[14:15], v[98:99] op_sel_hi:[1,0,1]
    v_pk_fma_f32 v[100:101], v[20:21], v[14:15], v[100:101] op_sel_hi:[1,0,1]
    v_pk_fma_f32 v[102:103], v[22:23], v[14:15], v[102:103] op_sel_hi:[1,0,1]
    v_pk_fma_f32 v[104:105], v[16:17], v[14:15], v[104:105] op_sel:[0,1,0] op_sel_hi:[1,1,1]
    v_pk_fma_f32 v[106:107], v[18:19], v[14:15], v[106:107] op_sel:[0,1,0] op_sel_hi:[1,1,1]
    v_pk_fma_f32 v[108:109], v[20:21], v[14:15], v[108:109] op_sel:[0,1,0] op_sel_hi:[1,1,1]
    v_pk_fma_f32 v[110:111], v[22:23], v[14:15], v[110:111] op_sel:[0,1,0] op_sel_hi:[1,1,1]
    v_pk_fma_f32 v[112:113], v[24:25], v[12:13], v[112:113] op_sel_hi:[1,0,1]
    v_pk_fma_f32 v[114:115], v[26:27], v[12:13], v[114:115] op_sel_hi:[1,0,1]
    v_pk_fma_f32 v[116:117], v[28:29], v[12:13], v[116:117] op_sel_hi:[1,0,1]
    v_pk_fma_f32 v[118:119], v[30:31], v[12:13], v[118:119] op_sel_hi:[1,0,1]
    v_pk_fma_f32 v[120:121], v[24:25], v[12:13], v[120:121] op_sel:[0,1,0] op_sel_hi:[1,1,1]
    v_pk_fma_f32 v[122:123], v[26:27], v[12:13], v[122:123] op_sel:[0,1,0] op_sel_hi:[1,1,1]
    v_pk_fma_f32 v[124:125], v[28:29], v[12:13], v[124:125] op_sel:[0,1,0] op_sel_hi:[1,1,1]
    v_pk_fma_f32 v[126:127], v[30:31], v[12:13], v[126:127] op_sel:[0,1,0] op_sel_hi:[1,1,1]
    v_pk_fma_f32 v[128:129], v[24:25], v[14:15], v[128:129] op_sel_hi:[1,0,1]
    v_pk_fma_f32 v[130:131], v[26:27], v[14:15], v[130:131] op_sel_hi:[1,0,1]
    v_pk_fma_f32 v[132:133], v[28:29], v[14:15], v[132:133] op_sel_hi:[1,0,1]
    v_pk_fma_f32 v[134:135], v[30:31], v[14:15], v[134:135] op_sel_hi:[1,0,1]
    v_pk_fma_f32 v[136:137], v[24:25], v[14:15], v[136:137] op_sel:[0,1,0] op_sel_hi:[1,1,1]
    v_pk_fma_f32 v[138:139], v[26:27], v[14:15], v[138:139] op_sel:[0,1,0] op_sel_hi:[1,1,1]
    v_pk_fma_f32 v[140:141], v[28:29], v[14:15], v[140:141] op_sel:[0,1,0] op_sel_hi:[1,1,1]
    v_pk_fma_f32 v[142:143], v[30:31], v[14:15], v[142:143] op_sel:[0,1,0] op_sel_hi:[1,1,1]
    s_cmp_eq_u32 s18, 0
    s_cbranch_scc1 L_nb25
    s_sub_u32 s18, s18, 1
    s_barrier
L_nb25:
    s_mov_b32 s57, 1320960
    buffer_load_dwordx4 v[48:51], v3, s[32:35], s57 offen
    buffer_load_dwordx4 v[52:55], v3, s[36:39], s57 offen
    s_mov_b32 s57, 1364992
    buffer_load_dwordx4 v[56:59], v3, s[32:35], s57 offen
    buffer_load_dwordx4 v[60:63], v3, s[36:39], s57 offen
    ds_read_b128 v[12:15], v7 offset:23808
    s_waitcnt vmcnt(6) lgkmcnt(1)
    v_lshlrev_b32 v16, 16, v32
    v_and_b32 v17, s60, v32
    v_lshlrev_b32 v18, 16, v33
    v_and_b32 v19, s60, v33
    v_lshlrev_b32 v20, 16, v34
    v_and_b32 v21, s60, v34
    v_lshlrev_b32 v22, 16, v35
    v_and_b32 v23, s60, v35
    v_lshlrev_b32 v24, 16, v36
    v_and_b32 v25, s60, v36
    v_lshlrev_b32 v26, 16, v37
    v_and_b32 v27, s60, v37
    v_lshlrev_b32 v28, 16, v38
    v_and_b32 v29, s60, v38
    v_lshlrev_b32 v30, 16, v39
    v_and_b32 v31, s60, v39
    v_pk_fma_f32 v[80:81], v[16:17], v[8:9], v[80:81] op_sel_hi:[1,0,1]
    v_pk_fma_f32 v[82:83], v[18:19], v[8:9], v[82:83] op_sel_hi:[1,0,1]
    v_pk_fma_f32 v[84:85], v[20:21], v[8:9], v[84:85] op_sel_hi:[1,0,1]
    v_pk_fma_f32 v[86:87], v[22:23], v[8:9], v[86:87] op_sel_hi:[1,0,1]
    v_pk_fma_f32 v[88:89], v[16:17], v[8:9], v[88:89] op_sel:[0,1,0] op_sel_hi:[1,1,1]
    v_pk_fma_f32 v[90:91], v[18:19], v[8:9], v[90:91] op_sel:[0,1,0] op_sel_hi:[1,1,1]
    v_pk_fma_f32 v[92:93], v[20:21], v[8:9], v[92:93] op_sel:[0,1,0] op_sel_hi:[1,1,1]
    v_pk_fma_f32 v[94:95], v[22:23], v[8:9], v[94:95] op_sel:[0,1,0] op_sel_hi:[1,1,1]
    v_pk_fma_f32 v[96:97], v[16:17], v[10:11], v[96:97] op_sel_hi:[1,0,1]
    v_pk_fma_f32 v[98:99], v[18:19], v[10:11], v[98:99] op_sel_hi:[1,0,1]
    v_pk_fma_f32 v[100:101], v[20:21], v[10:11], v[100:101] op_sel_hi:[1,0,1]
    v_pk_fma_f32 v[102:103], v[22:23], v[10:11], v[102:103] op_sel_hi:[1,0,1]
    v_pk_fma_f32 v[104:105], v[16:17], v[10:11], v[104:105] op_sel:[0,1,0] op_sel_hi:[1,1,1]
    v_pk_fma_f32 v[106:107], v[18:19], v[10:11], v[106:107] op_sel:[0,1,0] op_sel_hi:[1,1,1]
    v_pk_fma_f32 v[108:109], v[20:21], v[10:11], v[108:109] op_sel:[0,1,0] op_sel_hi:[1,1,1]
    v_pk_fma_f32 v[110:111], v[22:23], v[10:11], v[110:111] op_sel:[0,1,0] op_sel_hi:[1,1,1]
    v_pk_fma_f32 v[112:113], v[24:25], v[8:9], v[112:113] op_sel_hi:[1,0,1]
    v_pk_fma_f32 v[114:115], v[26:27], v[8:9], v[114:115] op_sel_hi:[1,0,1]
    v_pk_fma_f32 v[116:117], v[28:29], v[8:9], v[116:117] op_sel_hi:[1,0,1]
    v_pk_fma_f32 v[118:119], v[30:31], v[8:9], v[118:119] op_sel_hi:[1,0,1]
    v_pk_fma_f32 v[120:121], v[24:25], v[8:9], v[120:121] op_sel:[0,1,0] op_sel_hi:[1,1,1]
    v_pk_fma_f32 v[122:123], v[26:27], v[8:9], v[122:123] op_sel:[0,1,0] op_sel_hi:[1,1,1]
    v_pk_fma_f32 v[124:125], v[28:29], v[8:9], v[124:125] op_sel:[0,1,0] op_sel_hi:[1,1,1]
    v_pk_fma_f32 v[126:127], v[30:31], v[8:9], v[126:127] op_sel:[0,1,0] op_sel_hi:[1,1,1]
    v_pk_fma_f32 v[128:129], v[24:25], v[10:11], v[128:129] op_sel_hi:[1,0,1]
    v_pk_fma_f32 v[130:131], v[26:27], v[10:11], v[130:131] op_sel_hi:[1,0,1]
    v_pk_fma_f32 v[132:133], v[28:29], v[10:11], v[132:133] op_sel_hi:[1,0,1]
    v_pk_fma_f32 v[134:135], v[30:31], v[10:11], v[134:135] op_sel_hi:[1,0,1]
    v_pk_fma_f32 v[136:137], v[24:25], v[10:11], v[136:137] op_sel:[0,1,0] op_sel_hi:[1,1,1]
    v_pk_fma_f32 v[138:139], v[26:27], v[10:11], v[138:139] op_sel:[0,1,0] op_sel_hi:[1,1,1]
    v_pk_fma_f32 v[140:141], v[28:29], v[10:11], v[140:141] op_sel:[0,1,0] op_sel_hi:[1,1,1]
    v_pk_fma_f32 v[142:143], v[30:31], v[10:11], v[142:143] op_sel:[0,1,0] op_sel_hi:[1,1,1]
    ds_read_b128 v[8:11], v7 offset:24064
    s_waitcnt vmcnt(4) lgkmcnt(1)
    v_lshlrev_b32 v16, 16, v40
    v_and_b32 v17, s60, v40
    v_lshlrev_b32 v18, 16, v41
    v_and_b32 v19, s60, v41
    v_lshlrev_b32 v20, 16, v42
    v_and_b32 v21, s60, v42
    v_lshlrev_b32 v22, 16, v43
    v_and_b32 v23, s60, v43
    v_lshlrev_b32 v24, 16, v44
    v_and_b32 v25, s60, v44
    v_lshlrev_b32 v26, 16, v45
    v_and_b32 v27, s60, v45
    v_lshlrev_b32 v28, 16, v46
    v_and_b32 v29, s60, v46
    v_lshlrev_b32 v30, 16, v47
    v_and_b32 v31, s60, v47
    v_pk_fma_f32 v[80:81], v[16:17], v[12:13], v[80:81] op_sel_hi:[1,0,1]
    v_pk_fma_f32 v[82:83], v[18:19], v[12:13], v[82:83] op_sel_hi:[1,0,1]
    v_pk_fma_f32 v[84:85], v[20:21], v[12:13], v[84:85] op_sel_hi:[1,0,1]
    v_pk_fma_f32 v[86:87], v[22:23], v[12:13], v[86:87] op_sel_hi:[1,0,1]
    v_pk_fma_f32 v[88:89], v[16:17], v[12:13], v[88:89] op_sel:[0,1,0] op_sel_hi:[1,1,1]
    v_pk_fma_f32 v[90:91], v[18:19], v[12:13], v[90:91] op_sel:[0,1,0] op_sel_hi:[1,1,1]
    v_pk_fma_f32 v[92:93], v[20:21], v[12:13], v[92:93] op_sel:[0,1,0] op_sel_hi:[1,1,1]
    v_pk_fma_f32 v[94:95], v[22:23], v[12:13], v[94:95] op_sel:[0,1,0] op_sel_hi:[1,1,1]
    v_pk_fma_f32 v[96:97], v[16:17], v[14:15], v[96:97] op_sel_hi:[1,0,1]
    v_pk_fma_f32 v[98:99], v[18:19], v[14:15], v[98:99] op_sel_hi:[1,0,1]
    v_pk_fma_f32 v[100:101], v[20:21], v[14:15], v[100:101] op_sel_hi:[1,0,1]
    v_pk_fma_f32 v[102:103], v[22:23], v[14:15], v[102:103] op_sel_hi:[1,0,1]
    v_pk_fma_f32 v[104:105], v[16:17], v[14:15], v[104:105] op_sel:[0,1,0] op_sel_hi:[1,1,1]
    v_pk_fma_f32 v[106:107], v[18:19], v[14:15], v[106:107] op_sel:[0,1,0] op_sel_hi:[1,1,1]
    v_pk_fma_f32 v[108:109], v[20:21], v[14:15], v[108:109] op_sel:[0,1,0] op_sel_hi:[1,1,1]
    v_pk_fma_f32 v[110:111], v[22:23], v[14:15], v[110:111] op_sel:[0,1,0] op_sel_hi:[1,1,1]
    v_pk_fma_f32 v[112:113], v[24:25], v[12:13], v[112:113] op_sel_hi:[1,0,1]
    v_pk_fma_f32 v[114:115], v[26:27], v[12:13], v[114:115] op_sel_hi:[1,0,1]
    v_pk_fma_f32 v[116:117], v[28:29], v[12:13], v[116:117] op_sel_hi:[1,0,1]
    v_pk_fma_f32 v[118:119], v[30:31], v[12:13], v[118:119] op_sel_hi:[1,0,1]
    v_pk_fma_f32 v[120:121], v[24:25], v[12:13], v[120:121] op_sel:[0,1,0] op_sel_hi:[1,1,1]
    v_pk_fma_f32 v[122:123], v[26:27], v[12:13], v[122:123] op_sel:[0,1,0] op_sel_hi:[1,1,1]
    v_pk_fma_f32 v[124:125], v[28:29], v[12:13], v[124:125] op_sel:[0,1,0] op_sel_hi:[1,1,1]
    v_pk_fma_f32 v[126:127], v[30:31], v[12:13], v[126:127] op_sel:[0,1,0] op_sel_hi:[1,1,1]
    v_pk_fma_f32 v[128:129], v[24:25], v[14:15], v[128:129] op_sel_hi:[1,0,1]
    v_pk_fma_f32 v[130:131], v[26:27], v[14:15], v[130:131] op_sel_hi:[1,0,1]
    v_pk_fma_f32 v[132:133], v[28:29], v[14:15], v[132:133] op_sel_hi:[1,0,1]
    v_pk_fma_f32 v[134:135], v[30:31], v[14:15], v[134:135] op_sel_hi:[1,0,1]
    v_pk_fma_f32 v[136:137], v[24:25], v[14:15], v[136:137] op_sel:[0,1,0] op_sel_hi:[1,1,1]
    v_pk_fma_f32 v[138:139], v[26:27], v[14:15], v[138:139] op_sel:[0,1,0] op_sel_hi:[1,1,1]
    v_pk_fma_f32 v[140:141], v[28:29], v[14:15], v[140:141] op_sel:[0,1,0] op_sel_hi:[1,1,1]
    v_pk_fma_f32 v[142:143], v[30:31], v[14:15], v[142:143] op_sel:[0,1,0] op_sel_hi:[1,1,1]
    s_cmp_eq_u32 s18, 0
    s_cbranch_scc1 L_nb26
    s_sub_u32 s18, s18, 1
    s_barrier
L_nb26:
    ds_read_b128 v[12:15], v7 offset:24320
    s_waitcnt vmcnt(2) lgkmcnt(1)
    v_lshlrev_b32 v16, 16, v48
    v_and_b32 v17, s60, v48
    v_lshlrev_b32 v18, 16, v49
    v_and_b32 v19, s60, v49
    v_lshlrev_b32 v20, 16, v50
    v_and_b32 v21, s60, v50
    v_lshlrev_b32 v22, 16, v51
    v_and_b32 v23, s60, v51
    v_lshlrev_b32 v24, 16, v52
    v_and_b32 v25, s60, v52
    v_lshlrev_b32 v26, 16, v53
    v_and_b32 v27, s60, v53
    v_lshlrev_b32 v28, 16, v54
    v_and_b32 v29, s60, v54
    v_lshlrev_b32 v30, 16, v55
    v_and_b32 v31, s60, v55
    v_pk_fma_f32 v[80:81], v[16:17], v[8:9], v[80:81] op_sel_hi:[1,0,1]
    v_pk_fma_f32 v[82:83], v[18:19], v[8:9], v[82:83] op_sel_hi:[1,0,1]
    v_pk_fma_f32 v[84:85], v[20:21], v[8:9], v[84:85] op_sel_hi:[1,0,1]
    v_pk_fma_f32 v[86:87], v[22:23], v[8:9], v[86:87] op_sel_hi:[1,0,1]
    v_pk_fma_f32 v[88:89], v[16:17], v[8:9], v[88:89] op_sel:[0,1,0] op_sel_hi:[1,1,1]
    v_pk_fma_f32 v[90:91], v[18:19], v[8:9], v[90:91] op_sel:[0,1,0] op_sel_hi:[1,1,1]
    v_pk_fma_f32 v[92:93], v[20:21], v[8:9], v[92:93] op_sel:[0,1,0] op_sel_hi:[1,1,1]
    v_pk_fma_f32 v[94:95], v[22:23], v[8:9], v[94:95] op_sel:[0,1,0] op_sel_hi:[1,1,1]
    v_pk_fma_f32 v[96:97], v[16:17], v[10:11], v[96:97] op_sel_hi:[1,0,1]
    v_pk_fma_f32 v[98:99], v[18:19], v[10:11], v[98:99] op_sel_hi:[1,0,1]
    v_pk_fma_f32 v[100:101], v[20:21], v[10:11], v[100:101] op_sel_hi:[1,0,1]
    v_pk_fma_f32 v[102:103], v[22:23], v[10:11], v[102:103] op_sel_hi:[1,0,1]
    v_pk_fma_f32 v[104:105], v[16:17], v[10:11], v[104:105] op_sel:[0,1,0] op_sel_hi:[1,1,1]
    v_pk_fma_f32 v[106:107], v[18:19], v[10:11], v[106:107] op_sel:[0,1,0] op_sel_hi:[1,1,1]
    v_pk_fma_f32 v[108:109], v[20:21], v[10:11], v[108:109] op_sel:[0,1,0] op_sel_hi:[1,1,1]
    v_pk_fma_f32 v[110:111], v[22:23], v[10:11], v[110:111] op_sel:[0,1,0] op_sel_hi:[1,1,1]
    v_pk_fma_f32 v[112:113], v[24:25], v[8:9], v[112:113] op_sel_hi:[1,0,1]
    v_pk_fma_f32 v[114:115], v[26:27], v[8:9], v[114:115] op_sel_hi:[1,0,1]
    v_pk_fma_f32 v[116:117], v[28:29], v[8:9], v[116:117] op_sel_hi:[1,0,1]
    v_pk_fma_f32 v[118:119], v[30:31], v[8:9], v[118:119] op_sel_hi:[1,0,1]
    v_pk_fma_f32 v[120:121], v[24:25], v[8:9], v[120:121] op_sel:[0,1,0] op_sel_hi:[1,1,1]
    v_pk_fma_f32 v[122:123], v[26:27], v[8:9], v[122:123] op_sel:[0,1,0] op_sel_hi:[1,1,1]
    v_pk_fma_f32 v[124:125], v[28:29], v[8:9], v[124:125] op_sel:[0,1,0] op_sel_hi:[1,1,1]
    v_pk_fma_f32 v[126:127], v[30:31], v[8:9], v[126:127] op_sel:[0,1,0] op_sel_hi:[1,1,1]
    v_pk_fma_f32 v[128:129], v[24:25], v[10:11], v[128:129] op_sel_hi:[1,0,1]
    v_pk_fma_f32 v[130:131], v[26:27], v[10:11], v[130:131] op_sel_hi:[1,0,1]
    v_pk_fma_f32 v[132:133], v[28:29], v[10:11], v[132:133] op_sel_hi:[1,0,1]
    v_pk_fma_f32 v[134:135], v[30:31], v[10:11], v[134:135] op_sel_hi:[1,0,1]
    v_pk_fma_f32 v[136:137], v[24:25], v[10:11], v[136:137] op_sel:[0,1,0] op_sel_hi:[1,1,1]
    v_pk_fma_f32 v[138:139], v[26:27], v[10:11], v[138:139] op_sel:[0,1,0] op_sel_hi:[1,1,1]
    v_pk_fma_f32 v[140:141], v[28:29], v[10:11], v[140:141] op_sel:[0,1,0] op_sel_hi:[1,1,1]
    v_pk_fma_f32 v[142:143], v[30:31], v[10:11], v[142:143] op_sel:[0,1,0] op_sel_hi:[1,1,1]
    s_waitcnt vmcnt(0) lgkmcnt(0)
    v_lshlrev_b32 v16, 16, v56
    v_and_b32 v17, s60, v56
    v_lshlrev_b32 v18, 16, v57
    v_and_b32 v19, s60, v57
    v_lshlrev_b32 v20, 16, v58
    v_and_b32 v21, s60, v58
    v_lshlrev_b32 v22, 16, v59
    v_and_b32 v23, s60, v59
    v_lshlrev_b32 v24, 16, v60
    v_and_b32 v25, s60, v60
    v_lshlrev_b32 v26, 16, v61
    v_and_b32 v27, s60, v61
    v_lshlrev_b32 v28, 16, v62
    v_and_b32 v29, s60, v62
    v_lshlrev_b32 v30, 16, v63
    v_and_b32 v31, s60, v63
    v_pk_fma_f32 v[80:81], v[16:17], v[12:13], v[80:81] op_sel_hi:[1,0,1]
    v_pk_fma_f32 v[82:83], v[18:19], v[12:13], v[82:83] op_sel_hi:[1,0,1]
    v_pk_fma_f32 v[84:85], v[20:21], v[12:13], v[84:85] op_sel_hi:[1,0,1]
    v_pk_fma_f32 v[86:87], v[22:23], v[12:13], v[86:87] op_sel_hi:[1,0,1]
    v_pk_fma_f32 v[88:89], v[16:17], v[12:13], v[88:89] op_sel:[0,1,0] op_sel_hi:[1,1,1]
    v_pk_fma_f32 v[90:91], v[18:19], v[12:13], v[90:91] op_sel:[0,1,0] op_sel_hi:[1,1,1]
    v_pk_fma_f32 v[92:93], v[20:21], v[12:13], v[92:93] op_sel:[0,1,0] op_sel_hi:[1,1,1]
    v_pk_fma_f32 v[94:95], v[22:23], v[12:13], v[94:95] op_sel:[0,1,0] op_sel_hi:[1,1,1]
    v_pk_fma_f32 v[96:97], v[16:17], v[14:15], v[96:97] op_sel_hi:[1,0,1]
    v_pk_fma_f32 v[98:99], v[18:19], v[14:15], v[98:99] op_sel_hi:[1,0,1]
    v_pk_fma_f32 v[100:101], v[20:21], v[14:15], v[100:101] op_sel_hi:[1,0,1]
    v_pk_fma_f32 v[102:103], v[22:23], v[14:15], v[102:103] op_sel_hi:[1,0,1]
    v_pk_fma_f32 v[104:105], v[16:17], v[14:15], v[104:105] op_sel:[0,1,0] op_sel_hi:[1,1,1]
    v_pk_fma_f32 v[106:107], v[18:19], v[14:15], v[106:107] op_sel:[0,1,0] op_sel_hi:[1,1,1]
    v_pk_fma_f32 v[108:109], v[20:21], v[14:15], v[108:109] op_sel:[0,1,0] op_sel_hi:[1,1,1]
    v_pk_fma_f32 v[110:111], v[22:23], v[14:15], v[110:111] op_sel:[0,1,0] op_sel_hi:[1,1,1]
    v_pk_fma_f32 v[112:113], v[24:25], v[12:13], v[112:113] op_sel_hi:[1,0,1]
    v_pk_fma_f32 v[114:115], v[26:27], v[12:13], v[114:115] op_sel_hi:[1,0,1]
    v_pk_fma_f32 v[116:117], v[28:29], v[12:13], v[116:117] op_sel_hi:[1,0,1]
    v_pk_fma_f32 v[118:119], v[30:31], v[12:13], v[118:119] op_sel_hi:[1,0,1]
    v_pk_fma_f32 v[120:121], v[24:25], v[12:13], v[120:121] op_sel:[0,1,0] op_sel_hi:[1,1,1]
    v_pk_fma_f32 v[122:123], v[26:27], v[12:13], v[122:123] op_sel:[0,1,0] op_sel_hi:[1,1,1]
    v_pk_fma_f32 v[124:125], v[28:29], v[12:13], v[124:125] op_sel:[0,1,0] op_sel_hi:[1,1,1]
    v_pk_fma_f32 v[126:127], v[30:31], v[12:13], v[126:127] op_sel:[0,1,0] op_sel_hi:[1,1,1]
    v_pk_fma_f32 v[128:129], v[24:25], v[14:15], v[128:129] op_sel_hi:[1,0,1]
    v_pk_fma_f32 v[130:131], v[26:27], v[14:15], v[130:131] op_sel_hi:[1,0,1]
    v_pk_fma_f32 v[132:133], v[28:29], v[14:15], v[132:133] op_sel_hi:[1,0,1]
    v_pk_fma_f32 v[134:135], v[30:31], v[14:15], v[134:135] op_sel_hi:[1,0,1]
    v_pk_fma_f32 v[136:137], v[24:25], v[14:15], v[136:137] op_sel:[0,1,0] op_sel_hi:[1,1,1]
    v_pk_fma_f32 v[138:139], v[26:27], v[14:15], v[138:139] op_sel:[0,1,0] op_sel_hi:[1,1,1]
    v_pk_fma_f32 v[140:141], v[28:29], v[14:15], v[140:141] op_sel:[0,1,0] op_sel_hi:[1,1,1]
    v_pk_fma_f32 v[142:143], v[30:31], v[14:15], v[142:143] op_sel:[0,1,0] op_sel_hi:[1,1,1]
    s_cmp_eq_u32 s18, 0
    s_cbranch_scc1 L_nb27
    s_sub_u32 s18, s18, 1
    s_barrier
L_nb27:
    v_lshlrev_b32 v7, 10, v5
    v_lshl_add_u32 v7, v6, 5, v7
    ds_write_b128 v7, v[80:83] offset:24576
    ds_write_b128 v7, v[84:87] offset:24592
    ds_write_b128 v7, v[88:91] offset:24704
    ds_write_b128 v7, v[92:95] offset:24720
    ds_write_b128 v7, v[96:99] offset:24832
    ds_write_b128 v7, v[100:103] offset:24848
    ds_write_b128 v7, v[104:107] offset:24960
    ds_write_b128 v7, v[108:111] offset:24976
    ds_write_b128 v7, v[112:115] offset:25088
    ds_write_b128 v7, v[116:119] offset:25104
    ds_write_b128 v7, v[120:123] offset:25216
    ds_write_b128 v7, v[124:127] offset:25232
    ds_write_b128 v7, v[128:131] offset:25344
    ds_write_b128 v7, v[132:135] offset:25360
    ds_write_b128 v7, v[136:139] offset:25472
    ds_write_b128 v7, v[140:143] offset:25488
    v_lshlrev_b32 v7, 3, v0
    s_waitcnt lgkmcnt(0)
    ds_read_b64 v[80:81], v7 offset:24576
    ds_read_b64 v[82:83], v7 offset:25600
    ds_read_b64 v[84:85], v7 offset:26624
    ds_read_b64 v[86:87], v7 offset:27648
    ds_read_b64 v[88:89], v7 offset:28672
    ds_read_b64 v[90:91], v7 offset:29696
    ds_read_b64 v[92:93], v7 offset:30720
    ds_read_b64 v[94:95], v7 offset:31744
    ds_read_b64 v[96:97], v7 offset:32768
    ds_read_b64 v[98:99], v7 offset:33792
    ds_read_b64 v[100:101], v7 offset:34816
    ds_read_b64 v[102:103], v7 offset:35840
    ds_read_b64 v[104:105], v7 offset:36864
    ds_read_b64 v[106:107], v7 offset:37888
    ds_read_b64 v[108:109], v7 offset:38912
    ds_read_b64 v[110:111], v7 offset:39936
    ds_read_b64 v[112:113], v7 offset:25088
    ds_read_b64 v[114:115], v7 offset:26112
    ds_read_b64 v[116:117], v7 offset:27136
    ds_read_b64 v[118:119], v7 offset:28160
    ds_read_b64 v[120:121], v7 offset:29184
    ds_read_b64 v[122:123], v7 offset:30208
    ds_read_b64 v[124:125], v7 offset:31232
    ds_read_b64 v[126:127], v7 offset:32256
    ds_read_b64 v[128:129], v7 offset:33280
    ds_read_b64 v[130:131], v7 offset:34304
    ds_read_b64 v[132:133], v7 offset:35328
    ds_read_b64 v[134:135], v7 offset:36352
    ds_read_b64 v[136:137], v7 offset:37376
    ds_read_b64 v[138:139], v7 offset:38400
    ds_read_b64 v[140:141], v7 offset:39424
    ds_read_b64 v[142:143], v7 offset:40448
    s_waitcnt lgkmcnt(0)
    v_pk_add_f32 v[80:81], v[80:81], v[96:97]
    v_pk_add_f32 v[82:83], v[82:83], v[98:99]
    v_pk_add_f32 v[84:85], v[84:85], v[100:101]
    v_pk_add_f32 v[86:87], v[86:87], v[102:103]
    v_pk_add_f32 v[88:89], v[88:89], v[104:105]
    v_pk_add_f32 v[90:91], v[90:91], v[106:107]
    v_pk_add_f32 v[92:93], v[92:93], v[108:109]
    v_pk_add_f32 v[94:95], v[94:95], v[110:111]
    v_pk_add_f32 v[80:81], v[80:81], v[88:89]
    v_pk_add_f32 v[82:83], v[82:83], v[90:91]
    v_pk_add_f32 v[84:85], v[84:85], v[92:93]
    v_pk_add_f32 v[86:87], v[86:87], v[94:95]
    v_pk_add_f32 v[80:81], v[80:81], v[84:85]
    v_pk_add_f32 v[82:83], v[82:83], v[86:87]
    v_pk_add_f32 v[80:81], v[80:81], v[82:83]
    v_pk_add_f32 v[112:113], v[112:113], v[128:129]
    v_pk_add_f32 v[114:115], v[114:115], v[130:131]
    v_pk_add_f32 v[116:117], v[116:117], v[132:133]
    v_pk_add_f32 v[118:119], v[118:119], v[134:135]
    v_pk_add_f32 v[120:121], v[120:121], v[136:137]
    v_pk_add_f32 v[122:123], v[122:123], v[138:139]
    v_pk_add_f32 v[124:125], v[124:125], v[140:141]
    v_pk_add_f32 v[126:127], v[126:127], v[142:143]
    v_pk_add_f32 v[112:113], v[112:113], v[120:121]
    v_pk_add_f32 v[114:115], v[114:115], v[122:123]
    v_pk_add_f32 v[116:117], v[116:117], v[124:125]
    v_pk_add_f32 v[118:119], v[118:119], v[126:127]
    v_pk_add_f32 v[112:113], v[112:113], v[116:117]
    v_pk_add_f32 v[114:115], v[114:115], v[118:119]
    v_pk_add_f32 v[112:113], v[112:113], v[114:115]
    v_cvt_pk_bf16_f32 v8, v80, v81
    v_cvt_pk_bf16_f32 v9, v112, v113
    v_lshlrev_b32 v10, 16, v8
    v_and_b32 v11, s60, v8
    v_lshlrev_b32 v12, 16, v9
    v_and_b32 v13, s60, v9
    v_mul_f32 v14, s62, v10
    v_mul_f32 v15, s62, v11
    v_exp_f32 v14, -v14
    v_exp_f32 v15, -v15
    v_add_f32 v14, 1.0, v14
    v_add_f32 v15, 1.0, v15
    v_rcp_f32 v14, v14
    v_rcp_f32 v15, v15
    v_mul_f32 v10, v10, v14
    v_mul_f32 v11, v11, v15
    v_cvt_pk_bf16_f32 v8, v10, v11
    v_lshlrev_b32 v10, 16, v8
    v_and_b32 v11, s60, v8
    v_mul_f32 v10, v10, v12
    v_mul_f32 v11, v11, v13
    v_cvt_pk_bf16_f32 v8, v10, v11
    v_lshlrev_b32 v10, 16, v8
    v_and_b32 v11, s60, v8
    ds_write_b64 v7, v[10:11] offset:40960
    v_lshrrev_b32 v7, 3, v0
    v_mul_u32_u24 v7, 6144, v7
    v_and_b32 v8, 7, v0
    v_lshl_add_u32 v7, v8, 4, v7
    s_waitcnt lgkmcnt(0)
    ds_read_b128 v[16:19], v2 offset:40960
    s_lshl_b32 s9, s7, 7
    s_add_u32 s9, s9, 1048576
    s_waitcnt lgkmcnt(0)
    s_mov_b32 exec_hi, 0
    buffer_store_dwordx4 v[16:19], v7, s[52:55], s9 offen sc1
    s_cmp_eq_u32 s18, 0
    s_cbranch_scc1 L_nb28
    s_sub_u32 s18, s18, 1
    s_barrier
L_nb28:
    s_cmp_eq_u32 s18, 0
    s_cbranch_scc1 L_nb29
    s_sub_u32 s18, s18, 1
    s_barrier
L_nb29:
    s_branch L_rank
L_red:
    s_lshr_b32 s14, s10, 3
    v_lshlrev_b32 v26, 16, v16
    v_and_b32 v27, s60, v16
    v_lshlrev_b32 v28, 16, v20
    v_and_b32 v29, s60, v20
    v_pk_mul_f32 v[26:27], v[26:27], v[28:29]
    v_cvt_pk_bf16_f32 v26, v26, v27
    v_lshlrev_b32 v28, 16, v26
    v_and_b32 v29, s60, v26
    v_add_f32 v24, v28, v29
    v_lshlrev_b32 v26, 16, v17
    v_and_b32 v27, s60, v17
    v_lshlrev_b32 v28, 16, v21
    v_and_b32 v29, s60, v21
    v_pk_mul_f32 v[26:27], v[26:27], v[28:29]
    v_cvt_pk_bf16_f32 v26, v26, v27
    v_lshlrev_b32 v28, 16, v26
    v_and_b32 v29, s60, v26
    v_add_f32 v24, v24, v28
    v_add_f32 v24, v24, v29
    v_lshlrev_b32 v26, 16, v18
    v_and_b32 v27, s60, v18
    v_lshlrev_b32 v28, 16, v22
    v_and_b32 v29, s60, v22
    v_pk_mul_f32 v[26:27], v[26:27], v[28:29]
    v_cvt_pk_bf16_f32 v26, v26, v27
    v_lshlrev_b32 v28, 16, v26
    v_and_b32 v29, s60, v26
    v_add_f32 v24, v24, v28
    v_add_f32 v24, v24, v29
    v_lshlrev_b32 v26, 16, v19
    v_and_b32 v27, s60, v19
    v_lshlrev_b32 v28, 16, v23
    v_and_b32 v29, s60, v23
    v_pk_mul_f32 v[26:27], v[26:27], v[28:29]
    v_cvt_pk_bf16_f32 v26, v26, v27
    v_lshlrev_b32 v28, 16, v26
    v_and_b32 v29, s60, v26
    v_add_f32 v24, v24, v28
    v_add_f32 v24, v24, v29
    s_nop 1
    v_add_f32_dpp v24, v24, v24 quad_perm:[1,0,3,2] row_mask:0xf bank_mask:0xf
    s_nop 1
    v_add_f32_dpp v24, v24, v24 quad_perm:[2,3,0,1] row_mask:0xf bank_mask:0xf
    s_nop 1
    v_add_f32_dpp v24, v24, v24 row_ror:4 row_mask:0xf bank_mask:0xf
    s_nop 1
    v_add_f32_dpp v24, v24, v24 row_ror:8 row_mask:0xf bank_mask:0xf
    v_mov_b32 v25, v24
    s_nop 1
    v_permlane16_swap_b32 v24, v25
    v_add_f32 v24, v24, v25
    v_mov_b32 v25, v24
    s_nop 1
    v_permlane32_swap_b32 v24, v25
    v_add_f32 v24, v24, v25
    v_cvt_pk_bf16_f32 v24, v24, v24
    v_lshlrev_b32 v24, 16, v24
    v_mul_f32 v24, s62, v24
    v_exp_f32 v24, -v24
    s_nop 0
    v_add_f32 v24, 1.0, v24
    v_rcp_f32 v24, v24
    s_nop 0
    v_cvt_pk_bf16_f32 v24, v24, v24
    v_lshlrev_b32 v24, 16, v24
    v_sub_f32 v4, 1.0, v24
    v_cvt_pk_bf16_f32 v4, v4, v4
    v_lshlrev_b32 v4, 16, v4
    v_mov_b32 v26, 0
    s_mov_b64 exec, 1
    ds_write_b32 v26, v24 offset:12544
    s_mov_b64 exec, -1
    s_mul_i32 s9, s14, 6144
    s_add_u32 s9, s9, 1048576
    s_add_u32 s44, s12, s9
    s_addc_u32 s45, s13, 0
    s_mov_b32 s46, 5504
    s_movk_i32 s57, 4096
    s_mov_b32 s19, 5
L_bl30:
    s_cmp_eq_u32 s18, 0
    s_cbranch_scc1 L_nb31
    s_sub_u32 s18, s18, 1
    s_barrier
L_nb31:
    s_sub_u32 s19, s19, 1
    s_cmp_lg_u32 s19, 0
    s_cbranch_scc1 L_bl30
    s_mov_b64 exec, 1
    buffer_load_dword v30, off, s[64:67], 0 offset:0
    s_mov_b32 s11, 524288
L_ci2:
    s_cmp_eq_u32 s18, 0
    s_cbranch_scc1 L_nb32
    s_sub_u32 s18, s18, 1
    s_barrier
L_nb32:
    s_cmp_eq_u32 s18, 0
    s_cbranch_scc1 L_nb33
    s_sub_u32 s18, s18, 1
    s_barrier
L_nb33:
    s_waitcnt vmcnt(0)
    v_cmp_gt_u32 vcc, 32, v30
    s_sub_u32 s11, s11, 1
    s_cbranch_scc1 L_cid2
    s_cbranch_vccz L_cid2
    buffer_load_dword v30, off, s[64:67], 0 offset:0 sc1
    s_branch L_ci2
L_cid2:
    v_mov_b32 v30, 1
    v_mov_b32 v1, 0
    ds_write_b32 v1, v30 offset:12568
    s_waitcnt lgkmcnt(0)
    s_mov_b64 exec, -1
    s_mov_b32 s19, 15
L_bl34:
    s_cmp_eq_u32 s18, 0
    s_cbranch_scc1 L_nb35
    s_sub_u32 s18, s18, 1
    s_barrier
L_nb35:
    s_sub_u32 s19, s19, 1
    s_cmp_lg_u32 s19, 0
    s_cbranch_scc1 L_bl34
    s_mov_b32 s11, 524288
L_poll2:
    buffer_load_dwordx4 v[80:83], v2, s[44:47], 0 offen offset:0 sc1
    buffer_load_dwordx4 v[84:87], v2, s[44:47], 0 offen offset:1024 sc1
    buffer_load_dwordx4 v[88:91], v2, s[44:47], 0 offen offset:2048 sc1
    buffer_load_dwordx4 v[92:95], v2, s[44:47], 0 offen offset:3072 sc1
    buffer_load_dwordx4 v[96:99], v2, s[44:47], s57 offen offset:0 sc1
    buffer_load_dwordx4 v[100:103], v2, s[44:47], s57 offen offset:1024 sc1
    s_cmp_eq_u32 s18, 0
    s_cbranch_scc1 L_nb36
    s_sub_u32 s18, s18, 1
    s_barrier
L_nb36:
    s_cmp_eq_u32 s18, 0
    s_cbranch_scc1 L_nb37
    s_sub_u32 s18, s18, 1
    s_barrier
L_nb37:
    s_waitcnt vmcnt(0)
    v_max3_u32 v24, v80, v81, v82
    v_max3_u32 v24, v24, v83, v84
    v_max3_u32 v24, v24, v85, v86
    v_max3_u32 v24, v24, v87, v88
    v_max3_u32 v24, v24, v89, v90
    v_max3_u32 v24, v24, v91, v92
    v_max3_u32 v24, v24, v93, v94
    v_max3_u32 v24, v24, v95, v96
    v_max3_u32 v24, v24, v97, v98
    v_max3_u32 v24, v24, v99, v100
    v_max3_u32 v24, v24, v101, v102
    v_max_u32 v24, v24, v103
    v_cmp_eq_u32 vcc, -1, v24
    s_sub_u32 s11, s11, 1
    s_cbranch_scc1 L_polled2
    s_cbranch_vccnz L_poll2
L_polled2:
    ds_write_b128 v2, v[80:83] offset:16384
    ds_write_b128 v2, v[84:87] offset:17408
    ds_write_b128 v2, v[88:91] offset:18432
    ds_write_b128 v2, v[92:95] offset:19456
    ds_write_b128 v2, v[96:99] offset:20480
    ds_write_b128 v2, v[100:103] offset:21504
    v_lshrrev_b32 v5, 3, v0
    v_and_b32 v6, 7, v0
    v_mul_u32_u24 v3, 176128, v5
    v_lshl_add_u32 v3, v6, 4, v3
    s_lshl_b32 s9, s6, 7
    v_add_u32 v3, s9, v3
    v_mul_u32_u24 v7, 688, v5
    s_mov_b32 s56, 0
    s_waitcnt lgkmcnt(0)
    buffer_load_dwordx4 v[32:35], v3, s[40:43], s56 offen offset:0
    buffer_load_dwordx4 v[36:39], v3, s[40:43], s56 offen offset:1024
    buffer_load_dwordx4 v[40:43], v3, s[40:43], s56 offen offset:2048
    buffer_load_dwordx4 v[44:47], v3, s[40:43], s56 offen offset:3072
    s_add_u32 s56, s56, 4096
    buffer_load_dwordx4 v[48:51], v3, s[40:43], s56 offen offset:0
    buffer_load_dwordx4 v[52:55], v3, s[40:43], s56 offen offset:1024
    buffer_load_dwordx4 v[56:59], v3, s[40:43], s56 offen offset:2048
    buffer_load_dwordx4 v[60:63], v3, s[40:43], s56 offen offset:3072
    s_add_u32 s56, s56, 4096
    buffer_load_dwordx4 v[64:67], v3, s[40:43], s56 offen offset:0
    buffer_load_dwordx4 v[68:71], v3, s[40:43], s56 offen offset:1024
    buffer_load_dwordx4 v[72:75], v3, s[40:43], s56 offen offset:2048
    buffer_load_dwordx4 v[76:79], v3, s[40:43], s56 offen offset:3072
    s_add_u32 s56, s56, 4096
    v_mov_b32 v16, 0
    v_mov_b32 v17, 0
    v_mov_b32 v18, 0
    v_mov_b32 v19, 0
    v_mov_b32 v20, 0
    v_mov_b32 v21, 0
    v_mov_b32 v22, 0
    v_mov_b32 v23, 0
    s_mov_b32 s63, 13
L_d:
    ds_read_b128 v[8:11], v7 offset:16384
    ds_read_b128 v[12:15], v7 offset:16400
    ds_read_b128 v[24:27], v7 offset:16416
    s_cmp_eq_u32 s18, 0
    s_cbranch_scc1 L_nb38
    s_sub_u32 s18, s18, 1
    s_barrier
L_nb38:
    s_waitcnt vmcnt(8) lgkmcnt(0)
    v_lshlrev_b32 v104, 16, v32
    v_and_b32 v105, s60, v32
    v_lshlrev_b32 v106, 16, v33
    v_and_b32 v107, s60, v33
    v_lshlrev_b32 v108, 16, v34
    v_and_b32 v109, s60, v34
    v_lshlrev_b32 v110, 16, v35
    v_and_b32 v111, s60, v35
    v_pk_fma_f32 v[16:17], v[104:105], v[8:9], v[16:17] op_sel_hi:[1,0,1]
    v_pk_fma_f32 v[18:19], v[106:107], v[8:9], v[18:19] op_sel_hi:[1,0,1]
    v_pk_fma_f32 v[20:21], v[108:109], v[8:9], v[20:21] op_sel_hi:[1,0,1]
    v_pk_fma_f32 v[22:23], v[110:111], v[8:9], v[22:23] op_sel_hi:[1,0,1]
    v_lshlrev_b32 v104, 16, v36
    v_and_b32 v105, s60, v36
    v_lshlrev_b32 v106, 16, v37
    v_and_b32 v107, s60, v37
    v_lshlrev_b32 v108, 16, v38
    v_and_b32 v109, s60, v38
    v_lshlrev_b32 v110, 16, v39
    v_and_b32 v111, s60, v39
    v_pk_fma_f32 v[16:17], v[104:105], v[8:9], v[16:17] op_sel:[0,1,0] op_sel_hi:[1,1,1]
    v_pk_fma_f32 v[18:19], v[106:107], v[8:9], v[18:19] op_sel:[0,1,0] op_sel_hi:[1,1,1]
    v_pk_fma_f32 v[20:21], v[108:109], v[8:9], v[20:21] op_sel:[0,1,0] op_sel_hi:[1,1,1]
    v_pk_fma_f32 v[22:23], v[110:111], v[8:9], v[22:23] op_sel:[0,1,0] op_sel_hi:[1,1,1]
    v_lshlrev_b32 v104, 16, v40
    v_and_b32 v105, s60, v40
    v_lshlrev_b32 v106, 16, v41
    v_and_b32 v107, s60, v41
    v_lshlrev_b32 v108, 16, v42
    v_and_b32 v109, s60, v42
    v_lshlrev_b32 v110, 16, v43
    v_and_b32 v111, s60, v43
    v_pk_fma_f32 v[16:17], v[104:105], v[10:11], v[16:17] op_sel_hi:[1,0,1]
    v_pk_fma_f32 v[18:19], v[106:107], v[10:11], v[18:19] op_sel_hi:[1,0,1]
    v_pk_fma_f32 v[20:21], v[108:109], v[10:11], v[20:21] op_sel_hi:[1,0,1]
    v_pk_fma_f32 v[22:23], v[110:111], v[10:11], v[22:23] op_sel_hi:[1,0,1]
    v_lshlrev_b32 v104, 16, v44
    v_and_b32 v105, s60, v44
    v_lshlrev_b32 v106, 16, v45
    v_and_b32 v107, s60, v45
    v_lshlrev_b32 v108, 16, v46
    v_and_b32 v109, s60, v46
    v_lshlrev_b32 v110, 16, v47
    v_and_b32 v111, s60, v47
    v_pk_fma_f32 v[16:17], v[104:105], v[10:11], v[16:17] op_sel:[0,1,0] op_sel_hi:[1,1,1]
    v_pk_fma_f32 v[18:19], v[106:107], v[10:11], v[18:19] op_sel:[0,1,0] op_sel_hi:[1,1,1]
    v_pk_fma_f32 v[20:21], v[108:109], v[10:11], v[20:21] op_sel:[0,1,0] op_sel_hi:[1,1,1]
    v_pk_fma_f32 v[22:23], v[110:111], v[10:11], v[22:23] op_sel:[0,1,0] op_sel_hi:[1,1,1]
    buffer_load_dwordx4 v[32:35], v3, s[40:43], s56 offen offset:0
    buffer_load_dwordx4 v[36:39], v3, s[40:43], s56 offen offset:1024
    buffer_load_dwordx4 v[40:43], v3, s[40:43], s56 offen offset:2048
    buffer_load_dwordx4 v[44:47], v3, s[40:43], s56 offen offset:3072
    s_add_u32 s56, s56, 4096
    s_waitcnt vmcnt(8) lgkmcnt(0)
    v_lshlrev_b32 v104, 16, v48
    v_and_b32 v105, s60, v48
    v_lshlrev_b32 v106, 16, v49
    v_and_b32 v107, s60, v49
    v_lshlrev_b32 v108, 16, v50
    v_and_b32 v109, s60, v50
    v_lshlrev_b32 v110, 16, v51
    v_and_b32 v111, s60, v51
    v_pk_fma_f32 v[16:17], v[104:105], v[12:13], v[16:17] op_sel_hi:[1,0,1]
    v_pk_fma_f32 v[18:19], v[106:107], v[12:13], v[18:19] op_sel_hi:[1,0,1]
    v_pk_fma_f32 v[20:21], v[108:109], v[12:13], v[20:21] op_sel_hi:[1,0,1]
    v_pk_fma_f32 v[22:23], v[110:111], v[12:13], v[22:23] op_sel_hi:[1,0,1]
    v_lshlrev_b32 v104, 16, v52
    v_and_b32 v105, s60, v52
    v_lshlrev_b32 v106, 16, v53
    v_and_b32 v107, s60, v53
    v_lshlrev_b32 v108, 16, v54
    v_and_b32 v109, s60, v54
    v_lshlrev_b32 v110, 16, v55
    v_and_b32 v111, s60, v55
    v_pk_fma_f32 v[16:17], v[104:105], v[12:13], v[16:17] op_sel:[0,1,0] op_sel_hi:[1,1,1]
    v_pk_fma_f32 v[18:19], v[106:107], v[12:13], v[18:19] op_sel:[0,1,0] op_sel_hi:[1,1,1]
    v_pk_fma_f32 v[20:21], v[108:109], v[12:13], v[20:21] op_sel:[0,1,0] op_sel_hi:[1,1,1]
    v_pk_fma_f32 v[22:23], v[110:111], v[12:13], v[22:23] op_sel:[0,1,0] op_sel_hi:[1,1,1]
    v_lshlrev_b32 v104, 16, v56
    v_and_b32 v105, s60, v56
    v_lshlrev_b32 v106, 16, v57
    v_and_b32 v107, s60, v57
    v_lshlrev_b32 v108, 16, v58
    v_and_b32 v109, s60, v58
    v_lshlrev_b32 v110, 16, v59
    v_and_b32 v111, s60, v59
    v_pk_fma_f32 v[16:17], v[104:105], v[14:15], v[16:17] op_sel_hi:[1,0,1]
    v_pk_fma_f32 v[18:19], v[106:107], v[14:15], v[18:19] op_sel_hi:[1,0,1]
    v_pk_fma_f32 v[20:21], v[108:109], v[14:15], v[20:21] op_sel_hi:[1,0,1]
    v_pk_fma_f32 v[22:23], v[110:111], v[14:15], v[22:23] op_sel_hi:[1,0,1]
    v_lshlrev_b32 v104, 16, v60
    v_and_b32 v105, s60, v60
    v_lshlrev_b32 v106, 16, v61
    v_and_b32 v107, s60, v61
    v_lshlrev_b32 v108, 16, v62
    v_and_b32 v109, s60, v62
    v_lshlrev_b32 v110, 16, v63
    v_and_b32 v111, s60, v63
    v_pk_fma_f32 v[16:17], v[104:105], v[14:15], v[16:17] op_sel:[0,1,0] op_sel_hi:[1,1,1]
    v_pk_fma_f32 v[18:19], v[106:107], v[14:15], v[18:19] op_sel:[0,1,0] op_sel_hi:[1,1,1]
    v_pk_fma_f32 v[20:21], v[108:109], v[14:15], v[20:21] op_sel:[0,1,0] op_sel_hi:[1,1,1]
    v_pk_fma_f32 v[22:23], v[110:111], v[14:15], v[22:23] op_sel:[0,1,0] op_sel_hi:[1,1,1]
    buffer_load_dwordx4 v[48:51], v3, s[40:43], s56 offen offset:0
    buffer_load_dwordx4 v[52:55], v3, s[40:43], s56 offen offset:1024
    buffer_load_dwordx4 v[56:59], v3, s[40:43], s56 offen offset:2048
    buffer_load_dwordx4 v[60:63], v3, s[40:43], s56 offen offset:3072
    s_add_u32 s56, s56, 4096
    s_waitcnt vmcnt(8) lgkmcnt(0)
    v_lshlrev_b32 v104, 16, v64
    v_and_b32 v105, s60, v64
    v_lshlrev_b32 v106, 16, v65
    v_and_b32 v107, s60, v65
    v_lshlrev_b32 v108, 16, v66
    v_and_b32 v109, s60, v66
    v_lshlrev_b32 v110, 16, v67
    v_and_b32 v111, s60, v67
    v_pk_fma_f32 v[16:17], v[104:105], v[24:25], v[16:17] op_sel_hi:[1,0,1]
    v_pk_fma_f32 v[18:19], v[106:107], v[24:25], v[18:19] op_sel_hi:[1,0,1]
    v_pk_fma_f32 v[20:21], v[108:109], v[24:25], v[20:21] op_sel_hi:[1,0,1]
    v_pk_fma_f32 v[22:23], v[110:111], v[24:25], v[22:23] op_sel_hi:[1,0,1]
    v_lshlrev_b32 v104, 16, v68
    v_and_b32 v105, s60, v68
    v_lshlrev_b32 v106, 16, v69
    v_and_b32 v107, s60, v69
    v_lshlrev_b32 v108, 16, v70
    v_and_b32 v109, s60, v70
    v_lshlrev_b32 v110, 16, v71
    v_and_b32 v111, s60, v71
    v_pk_fma_f32 v[16:17], v[104:105], v[24:25], v[16:17] op_sel:[0,1,0] op_sel_hi:[1,1,1]
    v_pk_fma_f32 v[18:19], v[106:107], v[24:25], v[18:19] op_sel:[0,1,0] op_sel_hi:[1,1,1]
    v_pk_fma_f32 v[20:21], v[108:109], v[24:25], v[20:21] op_sel:[0,1,0] op_sel_hi:[1,1,1]
    v_pk_fma_f32 v[22:23], v[110:111], v[24:25], v[22:23] op_sel:[0,1,0] op_sel_hi:[1,1,1]
    v_lshlrev_b32 v104, 16, v72
    v_and_b32 v105, s60, v72
    v_lshlrev_b32 v106, 16, v73
    v_and_b32 v107, s60, v73
    v_lshlrev_b32 v108, 16, v74
    v_and_b32 v109, s60, v74
    v_lshlrev_b32 v110, 16, v75
    v_and_b32 v111, s60, v75
    v_pk_fma_f32 v[16:17], v[104:105], v[26:27], v[16:17] op_sel_hi:[1,0,1]
    v_pk_fma_f32 v[18:19], v[106:107], v[26:27], v[18:19] op_sel_hi:[1,0,1]
    v_pk_fma_f32 v[20:21], v[108:109], v[26:27], v[20:21] op_sel_hi:[1,0,1]
    v_pk_fma_f32 v[22:23], v[110:111], v[26:27], v[22:23] op_sel_hi:[1,0,1]
    v_lshlrev_b32 v104, 16, v76
    v_and_b32 v105, s60, v76
    v_lshlrev_b32 v106, 16, v77
    v_and_b32 v107, s60, v77
    v_lshlrev_b32 v108, 16, v78
    v_and_b32 v109, s60, v78
    v_lshlrev_b32 v110, 16, v79
    v_and_b32 v111, s60, v79
    v_pk_fma_f32 v[16:17], v[104:105], v[26:27], v[16:17] op_sel:[0,1,0] op_sel_hi:[1,1,1]
    v_pk_fma_f32 v[18:19], v[106:107], v[26:27], v[18:19] op_sel:[0,1,0] op_sel_hi:[1,1,1]
    v_pk_fma_f32 v[20:21], v[108:109], v[26:27], v[20:21] op_sel:[0,1,0] op_sel_hi:[1,1,1]
    v_pk_fma_f32 v[22:23], v[110:111], v[26:27], v[22:23] op_sel:[0,1,0] op_sel_hi:[1,1,1]
    buffer_load_dwordx4 v[64:67], v3, s[40:43], s56 offen offset:0
    buffer_load_dwordx4 v[68:71], v3, s[40:43], s56 offen offset:1024
    buffer_load_dwordx4 v[72:75], v3, s[40:43], s56 offen offset:2048
    buffer_load_dwordx4 v[76:79], v3, s[40:43], s56 offen offset:3072
    s_add_u32 s56, s56, 4096
    v_add_u32 v7, 48, v7
    s_sub_u32 s63, s63, 1
    s_cmp_lg_u32 s63, 0
    s_cbranch_scc1 L_d
    ds_read_b128 v[8:11], v7 offset:16384
    ds_read_b128 v[12:15], v7 offset:16400
    ds_read_b128 v[24:27], v7 offset:16416
    s_cmp_eq_u32 s18, 0
    s_cbranch_scc1 L_nb39
    s_sub_u32 s18, s18, 1
    s_barrier
L_nb39:
    s_waitcnt vmcnt(8) lgkmcnt(0)
    v_lshlrev_b32 v104, 16, v32
    v_and_b32 v105, s60, v32
    v_lshlrev_b32 v106, 16, v33
    v_and_b32 v107, s60, v33
    v_lshlrev_b32 v108, 16, v34
    v_and_b32 v109, s60, v34
    v_lshlrev_b32 v110, 16, v35
    v_and_b32 v111, s60, v35
    v_pk_fma_f32 v[16:17], v[104:105], v[8:9], v[16:17] op_sel_hi:[1,0,1]
    v_pk_fma_f32 v[18:19], v[106:107], v[8:9], v[18:19] op_sel_hi:[1,0,1]
    v_pk_fma_f32 v[20:21], v[108:109], v[8:9], v[20:21] op_sel_hi:[1,0,1]
    v_pk_fma_f32 v[22:23], v[110:111], v[8:9], v[22:23] op_sel_hi:[1,0,1]
    v_lshlrev_b32 v104, 16, v36
    v_and_b32 v105, s60, v36
    v_lshlrev_b32 v106, 16, v37
    v_and_b32 v107, s60, v37
    v_lshlrev_b32 v108, 16, v38
    v_and_b32 v109, s60, v38
    v_lshlrev_b32 v110, 16, v39
    v_and_b32 v111, s60, v39
    v_pk_fma_f32 v[16:17], v[104:105], v[8:9], v[16:17] op_sel:[0,1,0] op_sel_hi:[1,1,1]
    v_pk_fma_f32 v[18:19], v[106:107], v[8:9], v[18:19] op_sel:[0,1,0] op_sel_hi:[1,1,1]
    v_pk_fma_f32 v[20:21], v[108:109], v[8:9], v[20:21] op_sel:[0,1,0] op_sel_hi:[1,1,1]
    v_pk_fma_f32 v[22:23], v[110:111], v[8:9], v[22:23] op_sel:[0,1,0] op_sel_hi:[1,1,1]
    v_lshlrev_b32 v104, 16, v40
    v_and_b32 v105, s60, v40
    v_lshlrev_b32 v106, 16, v41
    v_and_b32 v107, s60, v41
    v_lshlrev_b32 v108, 16, v42
    v_and_b32 v109, s60, v42
    v_lshlrev_b32 v110, 16, v43
    v_and_b32 v111, s60, v43
    v_pk_fma_f32 v[16:17], v[104:105], v[10:11], v[16:17] op_sel_hi:[1,0,1]
    v_pk_fma_f32 v[18:19], v[106:107], v[10:11], v[18:19] op_sel_hi:[1,0,1]
    v_pk_fma_f32 v[20:21], v[108:109], v[10:11], v[20:21] op_sel_hi:[1,0,1]
    v_pk_fma_f32 v[22:23], v[110:111], v[10:11], v[22:23] op_sel_hi:[1,0,1]
    v_lshlrev_b32 v104, 16, v44
    v_and_b32 v105, s60, v44
    v_lshlrev_b32 v106, 16, v45
    v_and_b32 v107, s60, v45
    v_lshlrev_b32 v108, 16, v46
    v_and_b32 v109, s60, v46
    v_lshlrev_b32 v110, 16, v47
    v_and_b32 v111, s60, v47
    v_pk_fma_f32 v[16:17], v[104:105], v[10:11], v[16:17] op_sel:[0,1,0] op_sel_hi:[1,1,1]
    v_pk_fma_f32 v[18:19], v[106:107], v[10:11], v[18:19] op_sel:[0,1,0] op_sel_hi:[1,1,1]
    v_pk_fma_f32 v[20:21], v[108:109], v[10:11], v[20:21] op_sel:[0,1,0] op_sel_hi:[1,1,1]
    v_pk_fma_f32 v[22:23], v[110:111], v[10:11], v[22:23] op_sel:[0,1,0] op_sel_hi:[1,1,1]
    buffer_load_dwordx4 v[32:35], v3, s[40:43], s56 offen offset:0
    buffer_load_dwordx4 v[36:39], v3, s[40:43], s56 offen offset:1024
    buffer_load_dwordx4 v[40:43], v3, s[40:43], s56 offen offset:2048
    buffer_load_dwordx4 v[44:47], v3, s[40:43], s56 offen offset:3072
    s_add_u32 s56, s56, 4096
    s_waitcnt vmcnt(8) lgkmcnt(0)
    v_lshlrev_b32 v104, 16, v48
    v_and_b32 v105, s60, v48
    v_lshlrev_b32 v106, 16, v49
    v_and_b32 v107, s60, v49
    v_lshlrev_b32 v108, 16, v50
    v_and_b32 v109, s60, v50
    v_lshlrev_b32 v110, 16, v51
    v_and_b32 v111, s60, v51
    v_pk_fma_f32 v[16:17], v[104:105], v[12:13], v[16:17] op_sel_hi:[1,0,1]
    v_pk_fma_f32 v[18:19], v[106:107], v[12:13], v[18:19] op_sel_hi:[1,0,1]
    v_pk_fma_f32 v[20:21], v[108:109], v[12:13], v[20:21] op_sel_hi:[1,0,1]
    v_pk_fma_f32 v[22:23], v[110:111], v[12:13], v[22:23] op_sel_hi:[1,0,1]
    v_lshlrev_b32 v104, 16, v52
    v_and_b32 v105, s60, v52
    v_lshlrev_b32 v106, 16, v53
    v_and_b32 v107, s60, v53
    v_lshlrev_b32 v108, 16, v54
    v_and_b32 v109, s60, v54
    v_lshlrev_b32 v110, 16, v55
    v_and_b32 v111, s60, v55
    v_pk_fma_f32 v[16:17], v[104:105], v[12:13], v[16:17] op_sel:[0,1,0] op_sel_hi:[1,1,1]
    v_pk_fma_f32 v[18:19], v[106:107], v[12:13], v[18:19] op_sel:[0,1,0] op_sel_hi:[1,1,1]
    v_pk_fma_f32 v[20:21], v[108:109], v[12:13], v[20:21] op_sel:[0,1,0] op_sel_hi:[1,1,1]
    v_pk_fma_f32 v[22:23], v[110:111], v[12:13], v[22:23] op_sel:[0,1,0] op_sel_hi:[1,1,1]
    v_lshlrev_b32 v104, 16, v56
    v_and_b32 v105, s60, v56
    v_lshlrev_b32 v106, 16, v57
    v_and_b32 v107, s60, v57
    v_lshlrev_b32 v108, 16, v58
    v_and_b32 v109, s60, v58
    v_lshlrev_b32 v110, 16, v59
    v_and_b32 v111, s60, v59
    v_pk_fma_f32 v[16:17], v[104:105], v[14:15], v[16:17] op_sel_hi:[1,0,1]
    v_pk_fma_f32 v[18:19], v[106:107], v[14:15], v[18:19] op_sel_hi:[1,0,1]
    v_pk_fma_f32 v[20:21], v[108:109], v[14:15], v[20:21] op_sel_hi:[1,0,1]
    v_pk_fma_f32 v[22:23], v[110:111], v[14:15], v[22:23] op_sel_hi:[1,0,1]
    v_lshlrev_b32 v104, 16, v60
    v_and_b32 v105, s60, v60
    v_lshlrev_b32 v106, 16, v61
    v_and_b32 v107, s60, v61
    v_lshlrev_b32 v108, 16, v62
    v_and_b32 v109, s60, v62
    v_lshlrev_b32 v110, 16, v63
    v_and_b32 v111, s60, v63
    v_pk_fma_f32 v[16:17], v[104:105], v[14:15], v[16:17] op_sel:[0,1,0] op_sel_hi:[1,1,1]
    v_pk_fma_f32 v[18:19], v[106:107], v[14:15], v[18:19] op_sel:[0,1,0] op_sel_hi:[1,1,1]
    v_pk_fma_f32 v[20:21], v[108:109], v[14:15], v[20:21] op_sel:[0,1,0] op_sel_hi:[1,1,1]
    v_pk_fma_f32 v[22:23], v[110:111], v[14:15], v[22:23] op_sel:[0,1,0] op_sel_hi:[1,1,1]
    s_waitcnt vmcnt(4) lgkmcnt(0)
    v_lshlrev_b32 v104, 16, v64
    v_and_b32 v105, s60, v64
    v_lshlrev_b32 v106, 16, v65
    v_and_b32 v107, s60, v65
    v_lshlrev_b32 v108, 16, v66
    v_and_b32 v109, s60, v66
    v_lshlrev_b32 v110, 16, v67
    v_and_b32 v111, s60, v67
    v_pk_fma_f32 v[16:17], v[104:105], v[24:25], v[16:17] op_sel_hi:[1,0,1]
    v_pk_fma_f32 v[18:19], v[106:107], v[24:25], v[18:19] op_sel_hi:[1,0,1]
    v_pk_fma_f32 v[20:21], v[108:109], v[24:25], v[20:21] op_sel_hi:[1,0,1]
    v_pk_fma_f32 v[22:23], v[110:111], v[24:25], v[22:23] op_sel_hi:[1,0,1]
    v_lshlrev_b32 v104, 16, v68
    v_and_b32 v105, s60, v68
    v_lshlrev_b32 v106, 16, v69
    v_and_b32 v107, s60, v69
    v_lshlrev_b32 v108, 16, v70
    v_and_b32 v109, s60, v70
    v_lshlrev_b32 v110, 16, v71
    v_and_b32 v111, s60, v71
    v_pk_fma_f32 v[16:17], v[104:105], v[24:25], v[16:17] op_sel:[0,1,0] op_sel_hi:[1,1,1]
    v_pk_fma_f32 v[18:19], v[106:107], v[24:25], v[18:19] op_sel:[0,1,0] op_sel_hi:[1,1,1]
    v_pk_fma_f32 v[20:21], v[108:109], v[24:25], v[20:21] op_sel:[0,1,0] op_sel_hi:[1,1,1]
    v_pk_fma_f32 v[22:23], v[110:111], v[24:25], v[22:23] op_sel:[0,1,0] op_sel_hi:[1,1,1]
    v_lshlrev_b32 v104, 16, v72
    v_and_b32 v105, s60, v72
    v_lshlrev_b32 v106, 16, v73
    v_and_b32 v107, s60, v73
    v_lshlrev_b32 v108, 16, v74
    v_and_b32 v109, s60, v74
    v_lshlrev_b32 v110, 16, v75
    v_and_b32 v111, s60, v75
    v_pk_fma_f32 v[16:17], v[104:105], v[26:27], v[16:17] op_sel_hi:[1,0,1]
    v_pk_fma_f32 v[18:19], v[106:107], v[26:27], v[18:19] op_sel_hi:[1,0,1]
    v_pk_fma_f32 v[20:21], v[108:109], v[26:27], v[20:21] op_sel_hi:[1,0,1]
    v_pk_fma_f32 v[22:23], v[110:111], v[26:27], v[22:23] op_sel_hi:[1,0,1]
    v_lshlrev_b32 v104, 16, v76
    v_and_b32 v105, s60, v76
    v_lshlrev_b32 v106, 16, v77
    v_and_b32 v107, s60, v77
    v_lshlrev_b32 v108, 16, v78
    v_and_b32 v109, s60, v78
    v_lshlrev_b32 v110, 16, v79
    v_and_b32 v111, s60, v79
    v_pk_fma_f32 v[16:17], v[104:105], v[26:27], v[16:17] op_sel:[0,1,0] op_sel_hi:[1,1,1]
    v_pk_fma_f32 v[18:19], v[106:107], v[26:27], v[18:19] op_sel:[0,1,0] op_sel_hi:[1,1,1]
    v_pk_fma_f32 v[20:21], v[108:109], v[26:27], v[20:21] op_sel:[0,1,0] op_sel_hi:[1,1,1]
    v_pk_fma_f32 v[22:23], v[110:111], v[26:27], v[22:23] op_sel:[0,1,0] op_sel_hi:[1,1,1]
    ds_read_b128 v[8:11], v7 offset:16432
    s_cmp_eq_u32 s18, 0
    s_cbranch_scc1 L_nb40
    s_sub_u32 s18, s18, 1
    s_barrier
L_nb40:
    s_waitcnt vmcnt(0) lgkmcnt(0)
    v_lshlrev_b32 v104, 16, v32
    v_and_b32 v105, s60, v32
    v_lshlrev_b32 v106, 16, v33
    v_and_b32 v107, s60, v33
    v_lshlrev_b32 v108, 16, v34
    v_and_b32 v109, s60, v34
    v_lshlrev_b32 v110, 16, v35
    v_and_b32 v111, s60, v35
    v_pk_fma_f32 v[16:17], v[104:105], v[8:9], v[16:17] op_sel_hi:[1,0,1]
    v_pk_fma_f32 v[18:19], v[106:107], v[8:9], v[18:19] op_sel_hi:[1,0,1]
    v_pk_fma_f32 v[20:21], v[108:109], v[8:9], v[20:21] op_sel_hi:[1,0,1]
    v_pk_fma_f32 v[22:23], v[110:111], v[8:9], v[22:23] op_sel_hi:[1,0,1]
    v_lshlrev_b32 v104, 16, v36
    v_and_b32 v105, s60, v36
    v_lshlrev_b32 v106, 16, v37
    v_and_b32 v107, s60, v37
    v_lshlrev_b32 v108, 16, v38
    v_and_b32 v109, s60, v38
    v_lshlrev_b32 v110, 16, v39
    v_and_b32 v111, s60, v39
    v_pk_fma_f32 v[16:17], v[104:105], v[8:9], v[16:17] op_sel:[0,1,0] op_sel_hi:[1,1,1]
    v_pk_fma_f32 v[18:19], v[106:107], v[8:9], v[18:19] op_sel:[0,1,0] op_sel_hi:[1,1,1]
    v_pk_fma_f32 v[20:21], v[108:109], v[8:9], v[20:21] op_sel:[0,1,0] op_sel_hi:[1,1,1]
    v_pk_fma_f32 v[22:23], v[110:111], v[8:9], v[22:23] op_sel:[0,1,0] op_sel_hi:[1,1,1]
    v_lshlrev_b32 v104, 16, v40
    v_and_b32 v105, s60, v40
    v_lshlrev_b32 v106, 16, v41
    v_and_b32 v107, s60, v41
    v_lshlrev_b32 v108, 16, v42
    v_and_b32 v109, s60, v42
    v_lshlrev_b32 v110, 16, v43
    v_and_b32 v111, s60, v43
    v_pk_fma_f32 v[16:17], v[104:105], v[10:11], v[16:17] op_sel_hi:[1,0,1]
    v_pk_fma_f32 v[18:19], v[106:107], v[10:11], v[18:19] op_sel_hi:[1,0,1]
    v_pk_fma_f32 v[20:21], v[108:109], v[10:11], v[20:21] op_sel_hi:[1,0,1]
    v_pk_fma_f32 v[22:23], v[110:111], v[10:11], v[22:23] op_sel_hi:[1,0,1]
    v_lshlrev_b32 v104, 16, v44
    v_and_b32 v105, s60, v44
    v_lshlrev_b32 v106, 16, v45
    v_and_b32 v107, s60, v45
    v_lshlrev_b32 v108, 16, v46
    v_and_b32 v109, s60, v46
    v_lshlrev_b32 v110, 16, v47
    v_and_b32 v111, s60, v47
    v_pk_fma_f32 v[16:17], v[104:105], v[10:11], v[16:17] op_sel:[0,1,0] op_sel_hi:[1,1,1]
    v_pk_fma_f32 v[18:19], v[106:107], v[10:11], v[18:19] op_sel:[0,1,0] op_sel_hi:[1,1,1]
    v_pk_fma_f32 v[20:21], v[108:109], v[10:11], v[20:21] op_sel:[0,1,0] op_sel_hi:[1,1,1]
    v_pk_fma_f32 v[22:23], v[110:111], v[10:11], v[22:23] op_sel:[0,1,0] op_sel_hi:[1,1,1]
    s_mov_b32 s96, s88
    s_mov_b32 s97, s89
    s_mov_b32 s98, 4096
    s_mov_b32 s99, 0x20000
    s_mov_b64 exec, 1
    buffer_load_dword v30, off, s[96:99], 0 sc1
    s_mov_b64 exec, -1
    v_permlane32_swap_b32 v16, v20
    v_permlane32_swap_b32 v17, v21
    v_permlane32_swap_b32 v18, v22
    v_permlane32_swap_b32 v19, v23
    v_pk_add_f32 v[16:17], v[16:17], v[20:21]
    v_pk_add_f32 v[18:19], v[18:19], v[22:23]
    s_nop 1
    v_permlane16_swap_b32 v16, v18
    v_permlane16_swap_b32 v17, v19
    v_pk_add_f32 v[16:17], v[16:17], v[18:19]
    s_nop 1
    v_add_f32_dpp v16, v16, v16 row_ror:8 row_mask:0xf bank_mask:0xf
    v_add_f32_dpp v17, v17, v17 row_ror:8 row_mask:0xf bank_mask:0xf
    v_cvt_pk_bf16_f32 v16, v16, v17
    v_and_b32 v17, s60, v16
    v_lshlrev_b32 v16, 16, v16
    v_mul_f32 v16, v16, v4
    v_mul_f32 v17, v17, v4
    v_cvt_pk_bf16_f32 v16, v16, v17
    v_and_b32 v17, s60, v16
    v_lshlrev_b32 v16, 16, v16
    v_lshrrev_b32 v5, 4, v0
    v_lshlrev_b32 v5, 3, v5
    v_lshl_add_u32 v5, v6, 5, v5
    ds_write_b64 v5, v[16:17] offset:12608
    s_waitcnt lgkmcnt(0)
    s_cmp_eq_u32 s18, 0
    s_cbranch_scc1 L_nb41
    s_sub_u32 s18, s18, 1
    s_barrier
L_nb41:
    s_cmp_eq_u32 s18, 0
    s_cbranch_scc1 L_nb42
    s_sub_u32 s18, s18, 1
    s_barrier
L_nb42:
    s_branch L_rank
.section .rodata,"a"
.p2align 6
.amdhsa_kernel gated_mix__mha_block_cached__swiglu_ffn__decode_kernel
  .amdhsa_next_free_vgpr 168
  .amdhsa_next_free_sgpr 102
  .amdhsa_accum_offset 168
  .amdhsa_group_segment_fixed_size 0
  .amdhsa_kernarg_size 104
  .amdhsa_user_sgpr_count 2
  .amdhsa_user_sgpr_kernarg_segment_ptr 1
  .amdhsa_system_sgpr_workgroup_id_x 1
.end_amdhsa_kernel
```
